```python
import torch

def _softmax(x, axis=-1):
    return torch.softmax(x, dim=axis)
def _gelu(x):
    return torch.nn.functional.gelu(x, approximate="tanh")
def _silu(x):
    return torch.nn.functional.silu(x)
def _sigmoid(x):
    return torch.sigmoid(x)
def _layernorm(x, axis=-1, eps=1e-5):
    m = x.mean(dim=axis, keepdim=True)
    v = x.var(dim=axis, keepdim=True, unbiased=False)
    return (x - m) / torch.sqrt(v + eps)
def _scatter_add(tgt, idx, src, axis=0):
    return tgt.clone().index_add_(axis, idx, src)
def _segment_sum(src, seg, n):
    out = torch.zeros((n,) + src.shape[1:], dtype=src.dtype)
    return out.index_add_(0, seg, src)
def _pad(x, pw):
    flat = tuple(v for pair in reversed(pw) for v in pair)
    return torch.nn.functional.pad(x, flat)

kernel_name = 'recurrent_scan__linear_kernel_hedgehog__dense_activation_squared_relu__prompt'

def setup_inputs():

    _w = (lambda a: (lambda t: t.to(torch.bfloat16) if t.is_floating_point() else t)(torch.as_tensor(a)))
    def _A_setup():
        B, S, D, H = 1, 2048, 448, 16
        Dh = D // H
        return {
            "x": _w((lambda *s: torch.randn(*s, dtype=torch.bfloat16) * 0.05)(B, S, D)),
            "wqkv": _w((lambda *s: torch.randn(*s, dtype=torch.bfloat16) * 0.2)(D, 3 * D)),
            "w_phi": _w((lambda *s: torch.randn(*s, dtype=torch.bfloat16) * 0.2)(H, Dh, Dh) * (Dh ** -0.5)),
            "wo": _w((lambda *s: torch.randn(*s, dtype=torch.bfloat16) * 0.05)(D, D)),
        }
    _A_in = _A_setup()

    def _B_setup():
        B, S, D, F = 1, 2048, 448, 1792
        return {
            "x": _w((lambda *s: torch.randn(*s, dtype=torch.bfloat16) * 0.05)(B, S, D)),
            "w1": _w((lambda *s: torch.randn(*s, dtype=torch.bfloat16) * 0.05)(D, F)),
            "b1": _w((lambda *s: torch.randn(*s, dtype=torch.bfloat16) * 0.2)(F)),
            "w2": _w((lambda *s: torch.randn(*s, dtype=torch.bfloat16) * 0.05)(F, D)),
            "b2": _w((lambda *s: torch.randn(*s, dtype=torch.bfloat16) * 0.8)(D)),
        }
    _B_in = _B_setup()

    return {
        "A_x": _A_in["x"],
        "A_wqkv": _A_in["wqkv"],
        "A_w_phi": _A_in["w_phi"],
        "A_wo": _A_in["wo"],
        "B_x": _B_in["x"],
        "B_w1": _B_in["w1"],
        "B_b1": _B_in["b1"],
        "B_w2": _B_in["w2"],
        "B_b2": _B_in["b2"],
    }

def reference(A_x, A_wqkv, A_w_phi, A_wo, B_x, B_w1, B_b1, B_w2, B_b2):
    def _A_ref(x, wqkv, w_phi, wo):
        B, S, D = x.shape
        H = 16; Dh = D // H
        qkv = (lambda x, *d: x.permute(*d))((x @ wqkv).reshape(B, S, 3, H, Dh), 2, 0, 3, 1, 4)
        q, k, v = qkv[0], qkv[1], qkv[2]
        pq = torch.einsum("bhsd,hdf->bhsf", q, w_phi)
        pk = torch.einsum("bhsd,hdf->bhsf", k, w_phi)
        phi_q = torch.concatenate([_softmax(pq, axis=-1), _softmax(-pq, axis=-1)], axis=-1)
        phi_k = torch.concatenate([_softmax(pk, axis=-1), _softmax(-pk, axis=-1)], axis=-1)
        kv = torch.einsum("bhsf,bhsd->bhfd", phi_k, v)
        z  = torch.einsum("bhsf->bhf", phi_k)
        num = torch.einsum("bhqf,bhfd->bhqd", phi_q, kv)
        den = torch.einsum("bhqf,bhf->bhq", phi_q, z)[..., None] + 1e-6
        o = num / den
        return (lambda x, *d: x.permute(*d))(o, 0, 2, 1, 3).reshape(B, S, D) @ wo

    def _B_ref(x, w1, b1, w2, b2):
        h = torch.einsum("bsd,df->bsf", x, w1) + b1
        zero = torch.zeros_like(h)
        r = torch.where(h > zero, h, zero)
        h = r * r
        out = torch.einsum("bsf,fd->bsd", h, w2) + b2
        return out

    x = A_x
    xn = _layernorm(x, axis=-1)
    s = _A_ref(xn, A_wqkv, A_w_phi, A_wo)
    g = _silu(_B_ref(xn, B_w1, B_b1, B_w2, B_b2))
    return x + s * g
```

```asm
; @launch grid=(256,1,1) block=(512,1,1) lds=163840
.amdgcn_target "amdgcn-amd-amdhsa--gfx950"
.text
.globl recurrent_scan__linear_kernel_hedgehog__dense_activation_squared_relu__prompt_kernel
.p2align 8
.type recurrent_scan__linear_kernel_hedgehog__dense_activation_squared_relu__prompt_kernel,@function
recurrent_scan__linear_kernel_hedgehog__dense_activation_squared_relu__prompt_kernel:
  s_cmp_ge_u32 s2, 256
  s_cbranch_scc1 L_END
  s_load_dwordx16 s[4:19], s[0:1], 0
  s_load_dwordx8 s[20:27], s[0:1], 64
  s_getpc_b64 s[94:95]
L_PC:
  v_and_b32 v1, 63, v0
  v_lshrrev_b32 v124, 6, v0
  v_lshlrev_b32 v125, 4, v0
  s_lshr_b32 s91, s2, 3
  v_readfirstlane_b32 s70, v124
  s_and_b32 s92, s91, 3
  s_mul_i32 s92, s92, 14336
  s_mov_b32 s56, s94
  s_and_b32 s57, s95, 0xffff
  s_mov_b32 s58, L_CODE_END-L_PC
  s_mov_b32 s59, 0x20000
  s_mov_b32 m0, 160000
  s_and_b32 s90, s2, 7
  buffer_load_dwordx4 v125, s[56:59], s92 offen lds
  .if 14336 > 8192
  s_add_u32 s92, s92, 8192
  buffer_load_dwordx4 v125, s[56:59], s92 offen lds
  .endif
  s_lshr_b32 s92, s91, 3
  s_lshr_b32 s68, s90, 1
  s_lshl_b32 s68, s68, 2
  s_add_u32 s68, s68, s92
  s_and_b32 s69, s90, 1
  s_lshl_b32 s69, s69, 3
  s_and_b32 s92, s91, 7
  s_add_u32 s69, s69, s92
  s_and_b32 s73, s69, 7
  s_and_b32 s71, s70, 3
  v_and_b32 v2, 31, v1
  v_lshrrev_b32 v3, 5, v1
  s_and_b32 s90, s68, 3
  s_lshl_b32 s90, s90, 1
  s_add_u32 s90, s90, s69
  s_cmp_ge_u32 s90, 14
  s_cselect_b32 s91, 14, 0
  s_sub_u32 s90, s90, s91
  s_cmp_ge_u32 s90, 7
  s_cselect_b32 s91, 7, 0
  s_sub_u32 s76, s90, s91
  s_and_b32 s76, s68, 1
  s_mul_i32 s76, s76, 3
  s_mov_b32 s78, 0
  s_mul_i32 s90, s73, 160
  s_add_u32 s90, s90, 512
  s_and_b32 s91, s73, 1
  s_lshl_b32 s92, s91, 5
  s_add_u32 s92, s92, s90
  s_xor_b32 s93, s91, 1
  s_lshl_b32 s93, s93, 7
  s_add_u32 s93, s93, s90
  s_lshl_b32 s92, s92, 1
  s_lshl_b32 s84, s93, 1
  s_mul_i32 s90, s73, 112
  s_add_u32 s90, s90, 896
  s_cmp_lt_u32 s69, 8
  s_mov_b32 s72, 36864
  s_cselect_b32 s72, 32768, s72
  s_mov_b32 s95, 3584
  s_cselect_b32 s95, 2688, s95
  s_cselect_b32 s94, 6, 7
  s_cselect_b32 s90, s90, s92
  s_mov_b32 s91, 128
  s_cselect_b32 s91, 896, s91
  s_cselect_b32 s79, 4, 5
  s_mul_i32 s92, s71, s95
  s_lshl_b32 s92, s92, 4
  s_add_u32 s84, s84, s92
  s_add_u32 s90, s90, s92
  s_add_u32 s91, s91, s90
  v_lshrrev_b32 v6, 3, v1
  v_and_b32 v124, 7, v1
  v_lshrrev_b32 v125, 4, v1
  v_xor_b32 v4, v124, v125
  v_and_b32 v125, 1, v125
  v_lshlrev_b32 v125, 2, v125
  v_xor_b32 v124, v124, v125
  v_min_u32 v124, s94, v124
  v_lshlrev_b32 v124, 4, v124
  v_mad_u32_u24 v7, v6, s95, v124
  s_movk_i32 s94, 896
  v_mul_u32_u24 v125, s94, v6
  v_xor_b32 v5, 4, v4
  v_lshl_add_u32 v4, v4, 4, v125
  v_lshl_add_u32 v5, v5, 4, v125
  v_lshrrev_b32 v124, 2, v1
  s_movk_i32 s94, 3584
  v_mul_u32_u24 v124, s94, v124
  v_and_b32 v125, 3, v1
  v_lshl_add_u32 v6, v125, 4, v124
  s_mul_i32 s92, s68, 114688
  s_mul_i32 s93, s71, 28672
  s_add_u32 s92, s92, s93
  s_add_u32 s93, s92, 14336
  s_lshl_b32 s94, s95, 3
  s_lshl_b32 s95, s95, 6
  s_lshl_b32 s89, s71, 10
  s_add_u32 s89, s89, 32768
  s_cmp_ge_u32 s70, 4
  s_cselect_b64 vcc, -1, 0
  s_cselect_b32 s80, s90, s92
  s_cselect_b32 s82, s91, s93
  s_cselect_b32 s94, s94, 7168
  s_cselect_b32 s77, s95, 128
  s_cselect_b32 s79, s79, 4
  s_cselect_b32 s90, 11, 12
  s_cselect_b32 s91, 16384, 0
  s_mov_b32 s92, 2048
  s_cselect_b32 s92, 8192, s92
  s_cselect_b32 s93, 2, 0
  v_cndmask_b32 v4, v4, v7, vcc
  v_cndmask_b32 v5, v5, v7, vcc
  s_add_u32 s81, s80, s94
  s_add_u32 s83, s82, s94
  s_lshl_b32 s85, s71, s90
  s_add_u32 s85, s85, s91
  s_add_u32 s86, s85, 1024
  s_add_u32 s87, s85, s92
  s_add_u32 s88, s87, 1024
  s_add_u32 s75, s71, s93
  s_and_b32 s75, s75, 3
  s_lshl_b32 s94, s68, 4
  s_add_u32 s94, s94, s69
  s_lshl_b32 s94, s94, 3
  s_add_u32 s94, s94, s70
  s_mul_i32 s95, s94, 896
  v_lshlrev_b32 v18, 4, v1
  v_mov_b32 v19, 0x7ffffff0
  v_cmp_gt_u32 vcc, 56, v1
  s_nop 1
  v_cndmask_b32 v18, v19, v18, vcc
  s_lshl_b32 s3, s94, 3
  s_add_u32 s3, s3, 184320
  s_waitcnt lgkmcnt(0)
  s_cmp_lt_u32 s69, 8
  s_cselect_b32 s64, s6, s14
  s_cselect_b32 s65, s7, s15
  s_mov_b32 s66, 1605632
  s_cselect_b32 s66, 1204224, s66
  s_cmp_ge_u32 s70, 4
  s_cselect_b32 s64, s64, s4
  s_cselect_b32 s65, s65, s5
  s_cselect_b32 s66, s66, 1835008
  s_and_b32 s65, s65, 0xffff
  s_mov_b32 s67, 0x20000
  s_mov_b32 s93, s76
  s_call_b64 s[96:97], L_DMA
  s_mov_b32 s28, s4
  s_and_b32 s29, s5, 0xffff
  s_mov_b32 s30, 1835008
  s_mov_b32 s31, 0x20000
  buffer_load_dwordx4 v[240:243], v18, s[28:31], s95 offen
  s_call_b64 s[96:97], L_DMA
  s_call_b64 s[96:97], L_DMA
  s_cmp_lt_u32 s69, 8
  s_cbranch_scc1 L_KV
  s_cmp_lt_u32 s70, 4
  s_cbranch_scc1 L_TOQ0
  s_branch L_Q1
L_TOQ0:
  s_branch L_Q0
L_KV:
  s_cmp_lt_u32 s70, 4
  s_cbranch_scc1 L_TOKV0
  s_branch L_KV1
L_TOKV0:
  s_branch L_KV0
L_DMA:
  s_mul_i32 s90, s76, s77
  s_add_u32 m0, s85, s78
  s_add_u32 s91, s80, s90
  buffer_load_dwordx4 v4, s[64:67], s91 offen lds
  s_add_u32 m0, s86, s78
  s_add_u32 s91, s81, s90
  buffer_load_dwordx4 v5, s[64:67], s91 offen lds
  s_add_u32 m0, s87, s78
  s_add_u32 s91, s82, s90
  buffer_load_dwordx4 v4, s[64:67], s91 offen lds
  s_add_u32 m0, s88, s78
  s_add_u32 s91, s83, s90
  buffer_load_dwordx4 v5, s[64:67], s91 offen lds
  s_cmp_eq_u32 s79, 5
  s_cbranch_scc0 L_DMA_4
  s_add_u32 m0, s89, s78
  s_add_u32 s91, s84, s90
  buffer_load_dwordx4 v6, s[64:67], s91 offen lds
L_DMA_4:
  s_add_u32 s76, s76, 1
  s_cmp_eq_u32 s76, 7
  s_cselect_b32 s76, 0, s76
  s_add_u32 s78, s78, s72
  s_lshl_b32 s91, s72, 2
  s_cmp_eq_u32 s78, s91
  s_cselect_b32 s78, 0, s78
  s_setpc_b64 s[96:97]
L_DMA2:
  s_mul_i32 s90, s22, s11
  s_mov_b32 m0, s23
  s_add_u32 s91, s10, s90
  buffer_load_dwordx4 v7, s[56:59], s91 offen lds
  s_add_u32 s22, s22, 1
  s_cmp_eq_u32 s22, 7
  s_cselect_b32 s22, 0, s22
  s_add_u32 s23, s23, 8192
  s_sub_u32 s24, s24, 1
  s_cmp_lg_u32 s24, 0
  s_cbranch_scc1 L_DMA2
  s_setpc_b64 s[96:97]
L_KV0:
  s_mov_b32 s94, s93
  s_mul_i32 s92, s73, 3136
  s_lshl_b32 s93, s71, 10
  s_add_u32 s92, s92, s93
  v_lshlrev_b32 v244, 4, v1
  s_mov_b32 s56, s8
  s_and_b32 s57, s9, 0xffff
  s_mov_b32 s58, 25088
  s_mov_b32 s59, 0x20000
  s_add_u32 m0, s93, 147456
  s_nop 0
  buffer_load_dwordx4 v244, s[56:59], s92 offen lds
  s_mov_b32 s40, s18
  s_and_b32 s41, s19, 0xffff
  s_mov_b32 s42, 1605632
  s_mov_b32 s43, 0x20000
  s_mov_b32 s32, s6
  s_and_b32 s33, s7, 0xffff
  s_mov_b32 s34, 1204224
  s_mov_b32 s35, 0x20000
  s_mov_b32 s36, s14
  s_and_b32 s37, s15, 0xffff
  s_mov_b32 s38, 1605632
  s_mov_b32 s39, 0x20000
  s_mov_b32 s7, s94
  s_mov_b32 s44, s10
  s_and_b32 s45, s11, 0xffff
  s_mov_b32 s46, 401408
  s_mov_b32 s47, 0x20000
  s_mov_b32 s48, s26
  s_and_b32 s49, s27, 0xffff
  s_mov_b32 s50, 16121856
  s_mov_b32 s51, 0x20000
  s_mov_b32 s52, s22
  s_and_b32 s53, s23, 0xffff
  s_mov_b32 s54, 1835008
  s_mov_b32 s55, 0x20000
  s_mov_b32 s60, s24
  s_and_b32 s61, s25, 0xffff
  s_mov_b32 s62, 256
  s_mov_b32 s63, 0x20000
  v_cmp_eq_u32 s[4:5], 1, v3
  s_mov_b32 s6, 0xffff0000
  s_lshl_b32 s10, s73, 7
  s_mul_i32 s90, s70, 28672
  s_add_u32 s10, s10, s90
  s_mov_b32 s11, 229376
  s_lshl_b32 s12, s73, 2
  s_mov_b32 s22, s7
  s_lshl_b32 s90, s68, 2
  s_add_u32 s90, s90, s71
  s_mul_i32 s15, s90, 114688
  s_add_u32 s15, s15, 4587520
  v_and_b32 v124, 7, v1
  v_lshrrev_b32 v125, 2, v1
  v_and_b32 v125, 4, v125
  v_xor_b32 v124, v124, v125
  v_lshlrev_b32 v124, 4, v124
  v_lshrrev_b32 v125, 3, v1
  s_movk_i32 s90, 3584
  v_mad_u32_u24 v7, v125, s90, v124
  v_lshlrev_b32 v124, 4, v1
  s_mul_i32 s90, s2, 6272
  s_lshl_b32 s91, s71, 10
  s_add_u32 s90, s90, s91
  s_mov_b32 m0, 160000
  s_nop 0
  buffer_load_dwordx4 v124, s[40:43], s90 offen lds
  v_mov_b32 v125, 0
  v_lshlrev_b32 v124, 2, v2
  v_add_u32 v124, 151552, v124
  ds_write_b32 v124, v125
  s_or_b32 s90, s2, s70
  s_cmp_lg_u32 s90, 0
  s_cbranch_scc1 L_nonce_1
  s_load_dword s91, s[26:27], 0
  s_waitcnt lgkmcnt(0)
  s_add_u32 s91, s91, 0x9E3779B8
  s_or_b32 s91, s91, 1
  v_mov_b32 v124, 0
  v_mov_b32 v125, s91
  s_mov_b64 s[100:101], exec
  s_mov_b64 exec, 1
  buffer_store_dword v125, v124, s[60:63], 0 offen sc1
  buffer_store_dword v125, v124, s[48:51], 0 offen sc1
  s_mov_b64 exec, s[100:101]
L_nonce_1:
  s_lshl_b32 s90, s71, 12
  v_lshrrev_b32 v124, 1, v2
  v_and_b32 v124, 7, v124
  v_xor_b32 v124, v124, v3
  v_lshlrev_b32 v124, 4, v124
  v_lshl_add_u32 v124, v2, 7, v124
  v_add_u32 v8, s90, v124
  v_xor_b32 v9, 32, v8
  v_xor_b32 v10, 64, v8
  v_xor_b32 v11, 96, v8
  v_lshrrev_b32 v124, 4, v1
  v_and_b32 v124, 1, v124
  v_lshlrev_b32 v124, 5, v124
  v_and_b32 v125, 3, v1
  v_lshl_add_u32 v124, v125, 3, v124
  v_lshlrev_b32 v125, 3, v1
  v_and_b32 v125, 64, v125
  v_xor_b32 v124, v124, v125
  v_lshrrev_b32 v125, 2, v1
  v_and_b32 v125, 3, v125
  v_mad_u32_u24 v12, v3, 8, v125
  v_lshl_add_u32 v12, v12, 7, v124
  v_lshrrev_b32 v124, 4, v1
  v_and_b32 v124, 1, v124
  v_lshlrev_b32 v124, 5, v124
  v_and_b32 v125, 3, v1
  v_lshl_add_u32 v124, v125, 3, v124
  v_lshlrev_b32 v125, 3, v1
  v_and_b32 v125, 64, v125
  v_xor_b32 v124, v124, v125
  v_lshrrev_b32 v125, 2, v1
  v_and_b32 v125, 3, v125
  v_mad_u32_u24 v15, v3, 8, v125
  v_lshl_add_u32 v15, v15, 7, v124
  v_mov_b32 v16, 0x3f803f80
  v_mov_b32 v17, 0x3f803f80
  s_mov_b32 s56, s36
  s_mov_b32 s57, s37
  s_mov_b32 s58, s38
  s_mov_b32 s59, s39
  s_lshl_b32 s90, s71, 12
  v_lshrrev_b32 v124, 2, v2
  v_and_b32 v124, 3, v124
  v_lshlrev_b32 v124, 1, v124
  v_and_b32 v125, 1, v2
  v_add_u32 v124, v124, v125
  v_xor_b32 v124, v124, v3
  v_lshlrev_b32 v124, 3, v124
  v_lshlrev_b32 v125, 5, v2
  v_and_b32 v125, 64, v125
  v_add_u32 v124, v124, v125
  v_lshl_add_u32 v124, v2, 7, v124
  v_add_u32 v124, s90, v124
  v_add_u32 v64, 32768, v124
  s_lshl_b32 s90, s71, 11
  v_lshrrev_b32 v65, 1, v2
  v_and_b32 v65, 7, v65
  v_xor_b32 v65, v65, v3
  v_lshlrev_b32 v65, 3, v65
  v_lshl_add_u32 v65, v2, 6, v65
  v_add_u32 v65, s90, v65
  v_add_u32 v65, 65536, v65
  v_lshrrev_b32 v124, 4, v1
  v_and_b32 v124, 1, v124
  v_and_b32 v125, 3, v1
  v_lshlrev_b32 v124, 2, v124
  v_add_u32 v124, v124, v125
  v_min_u32 v124, 6, v124
  v_lshlrev_b32 v124, 3, v124
  v_lshrrev_b32 v125, 2, v1
  v_and_b32 v125, 3, v125
  v_lshl_add_u32 v125, v3, 2, v125
  v_mul_u32_u24 v125, 56, v125
  v_add_u32 v124, v124, v125
  v_add_u32 v66, 147456, v124
  v_mov_b32 v125, 150208
  v_cndmask_b32 v67, v66, v125, s[4:5]
  v_lshrrev_b32 v120, 2, v1
  v_and_b32 v120, 4, v120
  v_and_b32 v124, 3, v1
  v_add_u32 v120, v120, v124
  v_lshrrev_b32 v121, 2, v1
  v_and_b32 v121, 3, v121
  v_lshlrev_b32 v124, 1, v3
  v_lshlrev_b32 v124, 1, v124
  v_and_b32 v125, 1, v121
  v_add_u32 v124, v124, v125
  v_xor_b32 v124, v124, v120
  v_lshlrev_b32 v124, 3, v124
  v_lshrrev_b32 v125, 1, v121
  v_xor_b32 v125, s71, v125
  v_lshl_add_u32 v124, v125, 6, v124
  v_lshl_add_u32 v125, v3, 3, v121
  v_lshl_add_u32 v26, v125, 7, v124
  v_add_u32 v26, 32768, v26
  v_lshrrev_b32 v124, 1, v121
  v_lshl_add_u32 v124, v3, 2, v124
  v_xor_b32 v124, v124, v120
  v_lshlrev_b32 v124, 3, v124
  v_lshl_add_u32 v28, v125, 6, v124
  v_add_u32 v28, 65536, v28
  v_lshlrev_b32 v124, 1, v3
  v_add_u32 v124, 1, v124
  v_lshlrev_b32 v124, 1, v124
  v_and_b32 v125, 1, v121
  v_add_u32 v124, v124, v125
  v_xor_b32 v124, v124, v120
  v_lshlrev_b32 v124, 3, v124
  v_lshrrev_b32 v125, 1, v121
  v_xor_b32 v125, s71, v125
  v_lshl_add_u32 v124, v125, 6, v124
  v_lshl_add_u32 v125, v3, 3, v121
  v_add_u32 v125, 4, v125
  v_lshl_add_u32 v27, v125, 7, v124
  v_add_u32 v27, 32768, v27
  v_lshrrev_b32 v124, 1, v121
  v_lshl_add_u32 v124, v3, 2, v124
  v_add_u32 v124, 2, v124
  v_xor_b32 v124, v124, v120
  v_lshlrev_b32 v124, 3, v124
  v_lshl_add_u32 v29, v125, 6, v124
  v_add_u32 v29, 65536, v29
  v_mov_b32 v116, 0
  v_mov_b32 v117, 0
  v_mov_b32 v118, 0
  v_mov_b32 v119, 0
  v_mov_b32 v120, 0
  v_mov_b32 v121, 0
  v_mov_b32 v122, 0
  v_mov_b32 v123, 0
  s_waitcnt vmcnt(6)
  s_waitcnt lgkmcnt(0)
  s_barrier
  ds_read_b128 v[128:131], v8
  ds_read_b64_tr_b16 v[32:33], v12 offset:16384
  ds_read_b64_tr_b16 v[34:35], v12 offset:16896
  ds_read_b64_tr_b16 v[36:37], v12 offset:24576
  ds_read_b64_tr_b16 v[38:39], v12 offset:25088
  ds_read_b128 v[132:135], v9
  ds_read_b64_tr_b16 v[40:41], v12 offset:18432
  ds_read_b64_tr_b16 v[42:43], v12 offset:18944
  ds_read_b64_tr_b16 v[44:45], v12 offset:26624
  ds_read_b64_tr_b16 v[46:47], v12 offset:27136
  ds_read_b128 v[136:139], v10
  ds_read_b64_tr_b16 v[48:49], v12 offset:20480
  ds_read_b64_tr_b16 v[50:51], v12 offset:20992
  ds_read_b64_tr_b16 v[52:53], v12 offset:28672
  ds_read_b64_tr_b16 v[54:55], v12 offset:29184
  v_mov_b32 v124, 0
  buffer_load_dword v126, v124, s[60:63], 0 offen sc1
  s_waitcnt lgkmcnt(10)
  v_mfma_f32_32x32x16_bf16 v[68:83], v[32:35], v[128:131], 0
  ds_read_b128 v[140:143], v11
  ds_read_b64_tr_b16 v[56:57], v12 offset:22528
  ds_read_b64_tr_b16 v[58:59], v12 offset:23040
  v_mfma_f32_32x32x16_bf16 v[84:99], v[36:39], v[128:131], 0
  ds_read_b64_tr_b16 v[60:61], v12 offset:30720
  ds_read_b64_tr_b16 v[62:63], v12 offset:31232
  s_cmp_lg_u32 s75, 0
  s_cbranch_scc1 L_skip_2
  s_call_b64 s[96:97], L_DMA
  v_mfma_f32_4x4x4_16b_bf16 v[116:119], v[16:17], v[32:33], v[116:119]
  v_mfma_f32_4x4x4_16b_bf16 v[120:123], v[16:17], v[36:37], v[120:123]
  s_nop 0
  v_mfma_f32_4x4x4_16b_bf16 v[116:119], v[16:17], v[34:35], v[116:119]
  v_mfma_f32_4x4x4_16b_bf16 v[120:123], v[16:17], v[38:39], v[120:123]
L_skip_2:
  s_waitcnt lgkmcnt(10)
  v_mfma_f32_32x32x16_bf16 v[68:83], v[40:43], v[132:135], v[68:83]
  v_add_u32 v8, 32768, v8
  v_add_u32 v9, 32768, v9
  v_add_u32 v10, 32768, v10
  v_add_u32 v11, 32768, v11
  v_add_u32 v12, 32768, v12
  ds_read_b128 v[144:147], v8
  ds_read_b64_tr_b16 v[32:33], v12 offset:16384
  ds_read_b64_tr_b16 v[34:35], v12 offset:16896
  v_mfma_f32_32x32x16_bf16 v[84:99], v[44:47], v[132:135], v[84:99]
  ds_read_b64_tr_b16 v[36:37], v12 offset:24576
  ds_read_b64_tr_b16 v[38:39], v12 offset:25088
  s_cmp_lg_u32 s75, 1
  s_cbranch_scc1 L_skip_3
  s_call_b64 s[96:97], L_DMA
  v_mfma_f32_4x4x4_16b_bf16 v[116:119], v[16:17], v[40:41], v[116:119]
  v_mfma_f32_4x4x4_16b_bf16 v[120:123], v[16:17], v[44:45], v[120:123]
  s_nop 0
  v_mfma_f32_4x4x4_16b_bf16 v[116:119], v[16:17], v[42:43], v[116:119]
  v_mfma_f32_4x4x4_16b_bf16 v[120:123], v[16:17], v[46:47], v[120:123]
L_skip_3:
  s_waitcnt lgkmcnt(10)
  v_mfma_f32_32x32x16_bf16 v[68:83], v[48:51], v[136:139], v[68:83]
  ds_read_b128 v[148:151], v9
  ds_read_b64_tr_b16 v[40:41], v12 offset:18432
  ds_read_b64_tr_b16 v[42:43], v12 offset:18944
  v_mfma_f32_32x32x16_bf16 v[84:99], v[52:55], v[136:139], v[84:99]
  ds_read_b64_tr_b16 v[44:45], v12 offset:26624
  ds_read_b64_tr_b16 v[46:47], v12 offset:27136
  s_cmp_lg_u32 s75, 2
  s_cbranch_scc1 L_skip_4
  s_call_b64 s[96:97], L_DMA
  v_mfma_f32_4x4x4_16b_bf16 v[116:119], v[16:17], v[48:49], v[116:119]
  v_mfma_f32_4x4x4_16b_bf16 v[120:123], v[16:17], v[52:53], v[120:123]
  s_nop 0
  v_mfma_f32_4x4x4_16b_bf16 v[116:119], v[16:17], v[50:51], v[116:119]
  v_mfma_f32_4x4x4_16b_bf16 v[120:123], v[16:17], v[54:55], v[120:123]
L_skip_4:
  s_waitcnt lgkmcnt(10)
  v_mfma_f32_32x32x16_bf16 v[68:83], v[56:59], v[140:143], v[68:83]
  ds_read_b128 v[152:155], v10
  ds_read_b64_tr_b16 v[48:49], v12 offset:20480
  ds_read_b64_tr_b16 v[50:51], v12 offset:20992
  v_mfma_f32_32x32x16_bf16 v[84:99], v[60:63], v[140:143], v[84:99]
  ds_read_b64_tr_b16 v[52:53], v12 offset:28672
  ds_read_b64_tr_b16 v[54:55], v12 offset:29184
  s_cmp_lg_u32 s75, 3
  s_cbranch_scc1 L_skip_5
  s_call_b64 s[96:97], L_DMA
  v_mfma_f32_4x4x4_16b_bf16 v[116:119], v[16:17], v[56:57], v[116:119]
  v_mfma_f32_4x4x4_16b_bf16 v[120:123], v[16:17], v[60:61], v[120:123]
  s_nop 0
  v_mfma_f32_4x4x4_16b_bf16 v[116:119], v[16:17], v[58:59], v[116:119]
  v_mfma_f32_4x4x4_16b_bf16 v[120:123], v[16:17], v[62:63], v[120:123]
L_skip_5:
  s_waitcnt vmcnt(7)
  s_barrier
  s_waitcnt lgkmcnt(10)
  v_mfma_f32_32x32x16_bf16 v[68:83], v[32:35], v[144:147], v[68:83]
  ds_read_b128 v[156:159], v11
  ds_read_b64_tr_b16 v[56:57], v12 offset:22528
  ds_read_b64_tr_b16 v[58:59], v12 offset:23040
  v_mfma_f32_32x32x16_bf16 v[84:99], v[36:39], v[144:147], v[84:99]
  ds_read_b64_tr_b16 v[60:61], v12 offset:30720
  ds_read_b64_tr_b16 v[62:63], v12 offset:31232
  s_waitcnt vmcnt(4)
  v_readfirstlane_b32 s74, v126
  s_nop 0
  s_cmp_lg_u32 s74, 0
  s_cbranch_scc1 L_tagok_6
  s_mov_b32 s95, 0
L_tagloop_7:
  v_mov_b32 v124, 0
  buffer_load_dword v125, v124, s[60:63], 0 offen sc1
  s_waitcnt vmcnt(0)
  v_readfirstlane_b32 s74, v125
  s_add_u32 s95, s95, 1
  s_cmp_lg_u32 s74, 0
  s_cbranch_scc1 L_tagok_6
  s_cmp_lt_u32 s95, 0x40000
  s_cbranch_scc1 L_tagloop_7
L_tagok_6:
  v_mov_b32 v22, 0
  v_mov_b32 v23, 0
  v_lshlrev_b32 v20, 16, v240
  v_and_b32 v21, s6, v240
  v_add_f32 v22, v22, v20
  v_fmac_f32 v23, v20, v20
  v_add_f32 v22, v22, v21
  v_fmac_f32 v23, v21, v21
  s_cmp_lg_u32 s75, 0
  s_cbranch_scc1 L_skip_8
  s_call_b64 s[96:97], L_DMA
  v_mfma_f32_4x4x4_16b_bf16 v[116:119], v[16:17], v[32:33], v[116:119]
  v_mfma_f32_4x4x4_16b_bf16 v[120:123], v[16:17], v[36:37], v[120:123]
  s_nop 0
  v_mfma_f32_4x4x4_16b_bf16 v[116:119], v[16:17], v[34:35], v[116:119]
  v_mfma_f32_4x4x4_16b_bf16 v[120:123], v[16:17], v[38:39], v[120:123]
L_skip_8:
  s_waitcnt lgkmcnt(10)
  v_mfma_f32_32x32x16_bf16 v[68:83], v[40:43], v[148:151], v[68:83]
  v_add_u32 v8, 32768, v8
  v_add_u32 v9, 32768, v9
  v_add_u32 v10, 32768, v10
  v_add_u32 v11, 32768, v11
  v_add_u32 v12, 32768, v12
  ds_read_b128 v[160:163], v8
  ds_read_b64_tr_b16 v[32:33], v12 offset:16384
  ds_read_b64_tr_b16 v[34:35], v12 offset:16896
  v_mfma_f32_32x32x16_bf16 v[84:99], v[44:47], v[148:151], v[84:99]
  ds_read_b64_tr_b16 v[36:37], v12 offset:24576
  ds_read_b64_tr_b16 v[38:39], v12 offset:25088
  v_lshlrev_b32 v20, 16, v241
  v_and_b32 v21, s6, v241
  v_add_f32 v22, v22, v20
  v_fmac_f32 v23, v20, v20
  v_add_f32 v22, v22, v21
  v_fmac_f32 v23, v21, v21
  v_lshlrev_b32 v20, 16, v242
  v_and_b32 v21, s6, v242
  v_add_f32 v22, v22, v20
  v_fmac_f32 v23, v20, v20
  v_add_f32 v22, v22, v21
  v_fmac_f32 v23, v21, v21
  s_cmp_lg_u32 s75, 1
  s_cbranch_scc1 L_skip_9
  s_call_b64 s[96:97], L_DMA
  v_mfma_f32_4x4x4_16b_bf16 v[116:119], v[16:17], v[40:41], v[116:119]
  v_mfma_f32_4x4x4_16b_bf16 v[120:123], v[16:17], v[44:45], v[120:123]
  s_nop 0
  v_mfma_f32_4x4x4_16b_bf16 v[116:119], v[16:17], v[42:43], v[116:119]
  v_mfma_f32_4x4x4_16b_bf16 v[120:123], v[16:17], v[46:47], v[120:123]
L_skip_9:
  s_waitcnt lgkmcnt(10)
  v_mfma_f32_32x32x16_bf16 v[68:83], v[48:51], v[152:155], v[68:83]
  ds_read_b128 v[164:167], v9
  ds_read_b64_tr_b16 v[40:41], v12 offset:18432
  ds_read_b64_tr_b16 v[42:43], v12 offset:18944
  v_mfma_f32_32x32x16_bf16 v[84:99], v[52:55], v[152:155], v[84:99]
  ds_read_b64_tr_b16 v[44:45], v12 offset:26624
  ds_read_b64_tr_b16 v[46:47], v12 offset:27136
  v_lshlrev_b32 v20, 16, v243
  v_and_b32 v21, s6, v243
  v_add_f32 v22, v22, v20
  v_fmac_f32 v23, v20, v20
  v_add_f32 v22, v22, v21
  v_fmac_f32 v23, v21, v21
  s_nop 0
  v_add_f32_dpp v22, v22, v22 quad_perm:[1,0,3,2] row_mask:0xf bank_mask:0xf
  v_add_f32_dpp v23, v23, v23 quad_perm:[1,0,3,2] row_mask:0xf bank_mask:0xf
  s_cmp_lg_u32 s75, 2
  s_cbranch_scc1 L_skip_10
  s_call_b64 s[96:97], L_DMA
  v_mfma_f32_4x4x4_16b_bf16 v[116:119], v[16:17], v[48:49], v[116:119]
  v_mfma_f32_4x4x4_16b_bf16 v[120:123], v[16:17], v[52:53], v[120:123]
  s_nop 0
  v_mfma_f32_4x4x4_16b_bf16 v[116:119], v[16:17], v[50:51], v[116:119]
  v_mfma_f32_4x4x4_16b_bf16 v[120:123], v[16:17], v[54:55], v[120:123]
L_skip_10:
  s_waitcnt lgkmcnt(10)
  v_mfma_f32_32x32x16_bf16 v[68:83], v[56:59], v[156:159], v[68:83]
  ds_read_b128 v[168:171], v10
  ds_read_b64_tr_b16 v[48:49], v12 offset:20480
  ds_read_b64_tr_b16 v[50:51], v12 offset:20992
  v_mfma_f32_32x32x16_bf16 v[84:99], v[60:63], v[156:159], v[84:99]
  ds_read_b64_tr_b16 v[52:53], v12 offset:28672
  ds_read_b64_tr_b16 v[54:55], v12 offset:29184
  v_add_f32_dpp v22, v22, v22 quad_perm:[2,3,0,1] row_mask:0xf bank_mask:0xf
  v_add_f32_dpp v23, v23, v23 quad_perm:[2,3,0,1] row_mask:0xf bank_mask:0xf
  s_nop 0
  v_add_f32_dpp v22, v22, v22 row_half_mirror row_mask:0xf bank_mask:0xf
  v_add_f32_dpp v23, v23, v23 row_half_mirror row_mask:0xf bank_mask:0xf
  s_cmp_lg_u32 s75, 3
  s_cbranch_scc1 L_skip_11
  s_call_b64 s[96:97], L_DMA
  v_mfma_f32_4x4x4_16b_bf16 v[116:119], v[16:17], v[56:57], v[116:119]
  v_mfma_f32_4x4x4_16b_bf16 v[120:123], v[16:17], v[60:61], v[120:123]
  s_nop 0
  v_mfma_f32_4x4x4_16b_bf16 v[116:119], v[16:17], v[58:59], v[116:119]
  v_mfma_f32_4x4x4_16b_bf16 v[120:123], v[16:17], v[62:63], v[120:123]
L_skip_11:
  s_waitcnt vmcnt(4)
  s_barrier
  s_waitcnt lgkmcnt(10)
  v_mfma_f32_32x32x16_bf16 v[68:83], v[32:35], v[160:163], v[68:83]
  ds_read_b128 v[172:175], v11
  ds_read_b64_tr_b16 v[56:57], v12 offset:22528
  ds_read_b64_tr_b16 v[58:59], v12 offset:23040
  v_mfma_f32_32x32x16_bf16 v[84:99], v[36:39], v[160:163], v[84:99]
  ds_read_b64_tr_b16 v[60:61], v12 offset:30720
  ds_read_b64_tr_b16 v[62:63], v12 offset:31232
  v_add_f32_dpp v22, v22, v22 row_mirror row_mask:0xf bank_mask:0xf
  v_add_f32_dpp v23, v23, v23 row_mirror row_mask:0xf bank_mask:0xf
  v_mov_b32 v20, v22
  s_nop 1
  v_permlane16_swap_b32 v22, v20
  v_add_f32 v22, v22, v20
  v_mov_b32 v20, v23
  s_nop 1
  v_permlane16_swap_b32 v23, v20
  v_add_f32 v23, v23, v20
  s_cmp_lg_u32 s75, 0
  s_cbranch_scc1 L_skip_12
  s_call_b64 s[96:97], L_DMA
  v_mfma_f32_4x4x4_16b_bf16 v[116:119], v[16:17], v[32:33], v[116:119]
  v_mfma_f32_4x4x4_16b_bf16 v[120:123], v[16:17], v[36:37], v[120:123]
  s_nop 0
  v_mfma_f32_4x4x4_16b_bf16 v[116:119], v[16:17], v[34:35], v[116:119]
  v_mfma_f32_4x4x4_16b_bf16 v[120:123], v[16:17], v[38:39], v[120:123]
L_skip_12:
  s_waitcnt lgkmcnt(10)
  v_mfma_f32_32x32x16_bf16 v[68:83], v[40:43], v[164:167], v[68:83]
  v_add_u32 v8, 32768, v8
  v_add_u32 v9, 32768, v9
  v_add_u32 v10, 32768, v10
  v_add_u32 v11, 32768, v11
  v_add_u32 v12, 32768, v12
  ds_read_b128 v[176:179], v8
  ds_read_b64_tr_b16 v[32:33], v12 offset:16384
  ds_read_b64_tr_b16 v[34:35], v12 offset:16896
  v_mfma_f32_32x32x16_bf16 v[84:99], v[44:47], v[164:167], v[84:99]
  ds_read_b64_tr_b16 v[36:37], v12 offset:24576
  ds_read_b64_tr_b16 v[38:39], v12 offset:25088
  v_mov_b32 v20, v22
  s_nop 1
  v_permlane32_swap_b32 v22, v20
  v_add_f32 v22, v22, v20
  v_mov_b32 v20, v23
  s_nop 1
  v_permlane32_swap_b32 v23, v20
  v_add_f32 v23, v23, v20
  v_mul_f32 v22, 0x3b124925, v22
  v_mul_f32 v23, 0x3b124925, v23
  v_fma_f32 v23, -v22, v22, v23
  v_max_f32 v23, 0, v23
  v_cvt_pk_bf16_f32 v23, v23, v23
  v_lshlrev_b32 v23, 16, v23
  v_add_f32 v23, 0x3727c5ac, v23
  v_cvt_pk_bf16_f32 v23, v23, v23
  v_lshlrev_b32 v23, 16, v23
  s_cmp_lg_u32 s75, 1
  s_cbranch_scc1 L_skip_13
  s_call_b64 s[96:97], L_DMA
  v_mfma_f32_4x4x4_16b_bf16 v[116:119], v[16:17], v[40:41], v[116:119]
  v_mfma_f32_4x4x4_16b_bf16 v[120:123], v[16:17], v[44:45], v[120:123]
  s_nop 0
  v_mfma_f32_4x4x4_16b_bf16 v[116:119], v[16:17], v[42:43], v[116:119]
  v_mfma_f32_4x4x4_16b_bf16 v[120:123], v[16:17], v[46:47], v[120:123]
L_skip_13:
  s_waitcnt lgkmcnt(10)
  v_mfma_f32_32x32x16_bf16 v[68:83], v[48:51], v[168:171], v[68:83]
  ds_read_b128 v[180:183], v9
  ds_read_b64_tr_b16 v[40:41], v12 offset:18432
  ds_read_b64_tr_b16 v[42:43], v12 offset:18944
  v_mfma_f32_32x32x16_bf16 v[84:99], v[52:55], v[168:171], v[84:99]
  ds_read_b64_tr_b16 v[44:45], v12 offset:26624
  ds_read_b64_tr_b16 v[46:47], v12 offset:27136
  v_sqrt_f32 v23, v23
  v_mov_b32 v20, 0
  v_mov_b32 v25, s74
  v_cvt_pk_bf16_f32 v24, v23, v22
  s_mov_b64 s[100:101], exec
  s_mov_b64 exec, 1
  buffer_store_dwordx2 v[24:25], v20, s[48:51], s3 offen sc1
  s_mov_b64 exec, s[100:101]
  s_cmp_lg_u32 s75, 2
  s_cbranch_scc1 L_skip_14
  s_call_b64 s[96:97], L_DMA
  v_mfma_f32_4x4x4_16b_bf16 v[116:119], v[16:17], v[48:49], v[116:119]
  v_mfma_f32_4x4x4_16b_bf16 v[120:123], v[16:17], v[52:53], v[120:123]
  s_nop 0
  v_mfma_f32_4x4x4_16b_bf16 v[116:119], v[16:17], v[50:51], v[116:119]
  v_mfma_f32_4x4x4_16b_bf16 v[120:123], v[16:17], v[54:55], v[120:123]
L_skip_14:
  s_waitcnt lgkmcnt(10)
  v_mfma_f32_32x32x16_bf16 v[68:83], v[56:59], v[172:175], v[68:83]
  ds_read_b128 v[184:187], v10
  ds_read_b64_tr_b16 v[48:49], v12 offset:20480
  ds_read_b64_tr_b16 v[50:51], v12 offset:20992
  v_mfma_f32_32x32x16_bf16 v[84:99], v[60:63], v[172:175], v[84:99]
  ds_read_b64_tr_b16 v[52:53], v12 offset:28672
  ds_read_b64_tr_b16 v[54:55], v12 offset:29184
  s_cmp_lg_u32 s75, 3
  s_cbranch_scc1 L_skip_15
  s_call_b64 s[96:97], L_DMA
  v_mfma_f32_4x4x4_16b_bf16 v[116:119], v[16:17], v[56:57], v[116:119]
  v_mfma_f32_4x4x4_16b_bf16 v[120:123], v[16:17], v[60:61], v[120:123]
  s_nop 0
  v_mfma_f32_4x4x4_16b_bf16 v[116:119], v[16:17], v[58:59], v[116:119]
  v_mfma_f32_4x4x4_16b_bf16 v[120:123], v[16:17], v[62:63], v[120:123]
L_skip_15:
  s_waitcnt vmcnt(4)
  s_barrier
  s_waitcnt lgkmcnt(10)
  v_mfma_f32_32x32x16_bf16 v[68:83], v[32:35], v[176:179], v[68:83]
  ds_read_b128 v[188:191], v11
  ds_read_b64_tr_b16 v[56:57], v12 offset:22528
  ds_read_b64_tr_b16 v[58:59], v12 offset:23040
  v_mfma_f32_32x32x16_bf16 v[84:99], v[36:39], v[176:179], v[84:99]
  ds_read_b64_tr_b16 v[60:61], v12 offset:30720
  ds_read_b64_tr_b16 v[62:63], v12 offset:31232
  s_cmp_lg_u32 s75, 0
  s_cbranch_scc1 L_skip_16
  s_call_b64 s[96:97], L_DMA
  v_mfma_f32_4x4x4_16b_bf16 v[116:119], v[16:17], v[32:33], v[116:119]
  v_mfma_f32_4x4x4_16b_bf16 v[120:123], v[16:17], v[36:37], v[120:123]
  s_nop 0
  v_mfma_f32_4x4x4_16b_bf16 v[116:119], v[16:17], v[34:35], v[116:119]
  v_mfma_f32_4x4x4_16b_bf16 v[120:123], v[16:17], v[38:39], v[120:123]
L_skip_16:
  s_waitcnt lgkmcnt(10)
  v_mfma_f32_32x32x16_bf16 v[68:83], v[40:43], v[180:183], v[68:83]
  v_subrev_u32 v8, 98304, v8
  v_subrev_u32 v9, 98304, v9
  v_subrev_u32 v10, 98304, v10
  v_subrev_u32 v11, 98304, v11
  v_subrev_u32 v12, 98304, v12
  ds_read_b128 v[192:195], v8
  ds_read_b64_tr_b16 v[32:33], v12 offset:16384
  ds_read_b64_tr_b16 v[34:35], v12 offset:16896
  v_mfma_f32_32x32x16_bf16 v[84:99], v[44:47], v[180:183], v[84:99]
  ds_read_b64_tr_b16 v[36:37], v12 offset:24576
  ds_read_b64_tr_b16 v[38:39], v12 offset:25088
  s_cmp_lg_u32 s75, 1
  s_cbranch_scc1 L_skip_17
  s_call_b64 s[96:97], L_DMA
  v_mfma_f32_4x4x4_16b_bf16 v[116:119], v[16:17], v[40:41], v[116:119]
  v_mfma_f32_4x4x4_16b_bf16 v[120:123], v[16:17], v[44:45], v[120:123]
  s_nop 0
  v_mfma_f32_4x4x4_16b_bf16 v[116:119], v[16:17], v[42:43], v[116:119]
  v_mfma_f32_4x4x4_16b_bf16 v[120:123], v[16:17], v[46:47], v[120:123]
L_skip_17:
  s_waitcnt lgkmcnt(10)
  v_mfma_f32_32x32x16_bf16 v[68:83], v[48:51], v[184:187], v[68:83]
  ds_read_b128 v[196:199], v9
  ds_read_b64_tr_b16 v[40:41], v12 offset:18432
  ds_read_b64_tr_b16 v[42:43], v12 offset:18944
  v_mfma_f32_32x32x16_bf16 v[84:99], v[52:55], v[184:187], v[84:99]
  ds_read_b64_tr_b16 v[44:45], v12 offset:26624
  ds_read_b64_tr_b16 v[46:47], v12 offset:27136
  s_cmp_lg_u32 s75, 2
  s_cbranch_scc1 L_skip_18
  s_call_b64 s[96:97], L_DMA
  v_mfma_f32_4x4x4_16b_bf16 v[116:119], v[16:17], v[48:49], v[116:119]
  v_mfma_f32_4x4x4_16b_bf16 v[120:123], v[16:17], v[52:53], v[120:123]
  s_nop 0
  v_mfma_f32_4x4x4_16b_bf16 v[116:119], v[16:17], v[50:51], v[116:119]
  v_mfma_f32_4x4x4_16b_bf16 v[120:123], v[16:17], v[54:55], v[120:123]
L_skip_18:
  s_waitcnt lgkmcnt(10)
  v_mfma_f32_32x32x16_bf16 v[68:83], v[56:59], v[188:191], v[68:83]
  ds_read_b128 v[200:203], v10
  ds_read_b64_tr_b16 v[48:49], v12 offset:20480
  ds_read_b64_tr_b16 v[50:51], v12 offset:20992
  v_mfma_f32_32x32x16_bf16 v[84:99], v[60:63], v[188:191], v[84:99]
  ds_read_b64_tr_b16 v[52:53], v12 offset:28672
  ds_read_b64_tr_b16 v[54:55], v12 offset:29184
  s_cmp_lg_u32 s75, 3
  s_cbranch_scc1 L_skip_19
  s_call_b64 s[96:97], L_DMA
  v_mfma_f32_4x4x4_16b_bf16 v[116:119], v[16:17], v[56:57], v[116:119]
  v_mfma_f32_4x4x4_16b_bf16 v[120:123], v[16:17], v[60:61], v[120:123]
  s_nop 0
  v_mfma_f32_4x4x4_16b_bf16 v[116:119], v[16:17], v[58:59], v[116:119]
  v_mfma_f32_4x4x4_16b_bf16 v[120:123], v[16:17], v[62:63], v[120:123]
L_skip_19:
  s_waitcnt vmcnt(4)
  s_barrier
  s_lshl_b32 s90, s68, 10
  s_lshl_b32 s91, s71, 8
  s_add_u32 s90, s90, s91
  s_add_u32 s3, s90, 184320
  v_lshlrev_b32 v24, 3, v2
  buffer_load_dwordx2 v[18:19], v24, s[48:51], s3 offen sc1
  s_mov_b32 s24, 4
  s_lshl_b32 s23, s70, 10
  s_add_u32 s23, s23, 98304
  s_waitcnt lgkmcnt(10)
  v_mfma_f32_32x32x16_bf16 v[68:83], v[32:35], v[192:195], v[68:83]
  ds_read_b128 v[204:207], v11
  ds_read_b64_tr_b16 v[56:57], v12 offset:22528
  ds_read_b64_tr_b16 v[58:59], v12 offset:23040
  v_mfma_f32_32x32x16_bf16 v[84:99], v[36:39], v[192:195], v[84:99]
  ds_read_b64_tr_b16 v[60:61], v12 offset:30720
  ds_read_b64_tr_b16 v[62:63], v12 offset:31232
  s_cmp_lg_u32 s75, 0
  s_cbranch_scc1 L_skip_20
  s_call_b64 s[96:97], L_DMA2
  v_mfma_f32_4x4x4_16b_bf16 v[116:119], v[16:17], v[32:33], v[116:119]
  v_mfma_f32_4x4x4_16b_bf16 v[120:123], v[16:17], v[36:37], v[120:123]
  s_nop 0
  v_mfma_f32_4x4x4_16b_bf16 v[116:119], v[16:17], v[34:35], v[116:119]
  v_mfma_f32_4x4x4_16b_bf16 v[120:123], v[16:17], v[38:39], v[120:123]
L_skip_20:
  s_waitcnt lgkmcnt(10)
  v_mfma_f32_32x32x16_bf16 v[68:83], v[40:43], v[196:199], v[68:83]
  v_add_u32 v8, 32768, v8
  v_add_u32 v9, 32768, v9
  v_add_u32 v10, 32768, v10
  v_add_u32 v11, 32768, v11
  v_add_u32 v12, 32768, v12
  ds_read_b128 v[208:211], v8
  ds_read_b64_tr_b16 v[32:33], v12 offset:16384
  ds_read_b64_tr_b16 v[34:35], v12 offset:16896
  v_mfma_f32_32x32x16_bf16 v[84:99], v[44:47], v[196:199], v[84:99]
  ds_read_b64_tr_b16 v[36:37], v12 offset:24576
  ds_read_b64_tr_b16 v[38:39], v12 offset:25088
  s_cmp_lg_u32 s75, 1
  s_cbranch_scc1 L_skip_21
  s_call_b64 s[96:97], L_DMA2
  v_mfma_f32_4x4x4_16b_bf16 v[116:119], v[16:17], v[40:41], v[116:119]
  v_mfma_f32_4x4x4_16b_bf16 v[120:123], v[16:17], v[44:45], v[120:123]
  s_nop 0
  v_mfma_f32_4x4x4_16b_bf16 v[116:119], v[16:17], v[42:43], v[116:119]
  v_mfma_f32_4x4x4_16b_bf16 v[120:123], v[16:17], v[46:47], v[120:123]
L_skip_21:
  s_waitcnt lgkmcnt(10)
  v_mfma_f32_32x32x16_bf16 v[68:83], v[48:51], v[200:203], v[68:83]
  ds_read_b128 v[212:215], v9
  ds_read_b64_tr_b16 v[40:41], v12 offset:18432
  ds_read_b64_tr_b16 v[42:43], v12 offset:18944
  v_mfma_f32_32x32x16_bf16 v[84:99], v[52:55], v[200:203], v[84:99]
  ds_read_b64_tr_b16 v[44:45], v12 offset:26624
  ds_read_b64_tr_b16 v[46:47], v12 offset:27136
  s_cmp_lg_u32 s75, 2
  s_cbranch_scc1 L_skip_22
  s_call_b64 s[96:97], L_DMA2
  v_mfma_f32_4x4x4_16b_bf16 v[116:119], v[16:17], v[48:49], v[116:119]
  v_mfma_f32_4x4x4_16b_bf16 v[120:123], v[16:17], v[52:53], v[120:123]
  s_nop 0
  v_mfma_f32_4x4x4_16b_bf16 v[116:119], v[16:17], v[50:51], v[116:119]
  v_mfma_f32_4x4x4_16b_bf16 v[120:123], v[16:17], v[54:55], v[120:123]
L_skip_22:
  s_waitcnt lgkmcnt(10)
  v_mfma_f32_32x32x16_bf16 v[68:83], v[56:59], v[204:207], v[68:83]
  ds_read_b128 v[216:219], v10
  ds_read_b64_tr_b16 v[48:49], v12 offset:20480
  ds_read_b64_tr_b16 v[50:51], v12 offset:20992
  v_mfma_f32_32x32x16_bf16 v[84:99], v[60:63], v[204:207], v[84:99]
  ds_read_b64_tr_b16 v[52:53], v12 offset:28672
  ds_read_b64_tr_b16 v[54:55], v12 offset:29184
  s_cmp_lg_u32 s75, 3
  s_cbranch_scc1 L_skip_23
  s_call_b64 s[96:97], L_DMA2
  v_mfma_f32_4x4x4_16b_bf16 v[116:119], v[16:17], v[56:57], v[116:119]
  v_mfma_f32_4x4x4_16b_bf16 v[120:123], v[16:17], v[60:61], v[120:123]
  s_nop 0
  v_mfma_f32_4x4x4_16b_bf16 v[116:119], v[16:17], v[58:59], v[116:119]
  v_mfma_f32_4x4x4_16b_bf16 v[120:123], v[16:17], v[62:63], v[120:123]
L_skip_23:
  s_waitcnt vmcnt(5)
  s_barrier
  s_mov_b32 s24, 3
  s_lshl_b32 s23, s70, 10
  s_waitcnt lgkmcnt(10)
  v_mfma_f32_32x32x16_bf16 v[68:83], v[32:35], v[208:211], v[68:83]
  ds_read_b128 v[220:223], v11
  ds_read_b64_tr_b16 v[56:57], v12 offset:22528
  ds_read_b64_tr_b16 v[58:59], v12 offset:23040
  v_mfma_f32_32x32x16_bf16 v[84:99], v[36:39], v[208:211], v[84:99]
  ds_read_b64_tr_b16 v[60:61], v12 offset:30720
  ds_read_b64_tr_b16 v[62:63], v12 offset:31232
  s_cmp_lg_u32 s75, 0
  s_cbranch_scc1 L_skip_24
  s_call_b64 s[96:97], L_DMA2
  v_mfma_f32_4x4x4_16b_bf16 v[116:119], v[16:17], v[32:33], v[116:119]
  v_mfma_f32_4x4x4_16b_bf16 v[120:123], v[16:17], v[36:37], v[120:123]
  s_nop 0
  v_mfma_f32_4x4x4_16b_bf16 v[116:119], v[16:17], v[34:35], v[116:119]
  v_mfma_f32_4x4x4_16b_bf16 v[120:123], v[16:17], v[38:39], v[120:123]
L_skip_24:
  s_waitcnt lgkmcnt(10)
  v_mfma_f32_32x32x16_bf16 v[68:83], v[40:43], v[212:215], v[68:83]
  v_add_u32 v8, 32768, v8
  v_add_u32 v9, 32768, v9
  v_add_u32 v10, 32768, v10
  v_add_u32 v11, 32768, v11
  v_add_u32 v12, 32768, v12
  ds_read_b128 v[224:227], v8
  ds_read_b64_tr_b16 v[32:33], v12 offset:16384
  ds_read_b64_tr_b16 v[34:35], v12 offset:16896
  v_mfma_f32_32x32x16_bf16 v[84:99], v[44:47], v[212:215], v[84:99]
  ds_read_b64_tr_b16 v[36:37], v12 offset:24576
  ds_read_b64_tr_b16 v[38:39], v12 offset:25088
  s_cmp_lg_u32 s75, 1
  s_cbranch_scc1 L_skip_25
  s_call_b64 s[96:97], L_DMA2
  v_mfma_f32_4x4x4_16b_bf16 v[116:119], v[16:17], v[40:41], v[116:119]
  v_mfma_f32_4x4x4_16b_bf16 v[120:123], v[16:17], v[44:45], v[120:123]
  s_nop 0
  v_mfma_f32_4x4x4_16b_bf16 v[116:119], v[16:17], v[42:43], v[116:119]
  v_mfma_f32_4x4x4_16b_bf16 v[120:123], v[16:17], v[46:47], v[120:123]
L_skip_25:
  s_waitcnt lgkmcnt(10)
  v_mfma_f32_32x32x16_bf16 v[68:83], v[48:51], v[216:219], v[68:83]
  ds_read_b128 v[228:231], v9
  ds_read_b64_tr_b16 v[40:41], v12 offset:18432
  ds_read_b64_tr_b16 v[42:43], v12 offset:18944
  v_mfma_f32_32x32x16_bf16 v[84:99], v[52:55], v[216:219], v[84:99]
  ds_read_b64_tr_b16 v[44:45], v12 offset:26624
  ds_read_b64_tr_b16 v[46:47], v12 offset:27136
  s_cmp_lg_u32 s75, 2
  s_cbranch_scc1 L_skip_26
  s_call_b64 s[96:97], L_DMA2
  v_mfma_f32_4x4x4_16b_bf16 v[116:119], v[16:17], v[48:49], v[116:119]
  v_mfma_f32_4x4x4_16b_bf16 v[120:123], v[16:17], v[52:53], v[120:123]
  s_nop 0
  v_mfma_f32_4x4x4_16b_bf16 v[116:119], v[16:17], v[50:51], v[116:119]
  v_mfma_f32_4x4x4_16b_bf16 v[120:123], v[16:17], v[54:55], v[120:123]
L_skip_26:
  s_waitcnt lgkmcnt(10)
  v_mfma_f32_32x32x16_bf16 v[68:83], v[56:59], v[220:223], v[68:83]
  ds_read_b128 v[232:235], v10
  ds_read_b64_tr_b16 v[48:49], v12 offset:20480
  ds_read_b64_tr_b16 v[50:51], v12 offset:20992
  v_mfma_f32_32x32x16_bf16 v[84:99], v[60:63], v[220:223], v[84:99]
  ds_read_b64_tr_b16 v[52:53], v12 offset:28672
  ds_read_b64_tr_b16 v[54:55], v12 offset:29184
  s_cmp_lg_u32 s75, 3
  s_cbranch_scc1 L_skip_27
  s_call_b64 s[96:97], L_DMA2
  v_mfma_f32_4x4x4_16b_bf16 v[116:119], v[16:17], v[56:57], v[116:119]
  v_mfma_f32_4x4x4_16b_bf16 v[120:123], v[16:17], v[60:61], v[120:123]
  s_nop 0
  v_mfma_f32_4x4x4_16b_bf16 v[116:119], v[16:17], v[58:59], v[116:119]
  v_mfma_f32_4x4x4_16b_bf16 v[120:123], v[16:17], v[62:63], v[120:123]
L_skip_27:
  s_barrier
  s_waitcnt lgkmcnt(10)
  v_mfma_f32_32x32x16_bf16 v[68:83], v[32:35], v[224:227], v[68:83]
  ds_read_b128 v[236:239], v11
  ds_read_b64_tr_b16 v[56:57], v12 offset:22528
  ds_read_b64_tr_b16 v[58:59], v12 offset:23040
  v_mfma_f32_32x32x16_bf16 v[84:99], v[36:39], v[224:227], v[84:99]
  ds_read_b64_tr_b16 v[60:61], v12 offset:30720
  ds_read_b64_tr_b16 v[62:63], v12 offset:31232
  s_cmp_lg_u32 s75, 0
  s_cbranch_scc1 L_skip_28
  v_mfma_f32_4x4x4_16b_bf16 v[116:119], v[16:17], v[32:33], v[116:119]
  v_mfma_f32_4x4x4_16b_bf16 v[120:123], v[16:17], v[36:37], v[120:123]
  s_nop 0
  v_mfma_f32_4x4x4_16b_bf16 v[116:119], v[16:17], v[34:35], v[116:119]
  v_mfma_f32_4x4x4_16b_bf16 v[120:123], v[16:17], v[38:39], v[120:123]
L_skip_28:
  s_waitcnt lgkmcnt(10)
  v_mfma_f32_32x32x16_bf16 v[68:83], v[40:43], v[228:231], v[68:83]
  v_mfma_f32_32x32x16_bf16 v[84:99], v[44:47], v[228:231], v[84:99]
  s_cmp_lg_u32 s75, 1
  s_cbranch_scc1 L_skip_29
  v_mfma_f32_4x4x4_16b_bf16 v[116:119], v[16:17], v[40:41], v[116:119]
  v_mfma_f32_4x4x4_16b_bf16 v[120:123], v[16:17], v[44:45], v[120:123]
  s_nop 0
  v_mfma_f32_4x4x4_16b_bf16 v[116:119], v[16:17], v[42:43], v[116:119]
  v_mfma_f32_4x4x4_16b_bf16 v[120:123], v[16:17], v[46:47], v[120:123]
L_skip_29:
  s_waitcnt lgkmcnt(5)
  v_mfma_f32_32x32x16_bf16 v[68:83], v[48:51], v[232:235], v[68:83]
  v_mfma_f32_32x32x16_bf16 v[84:99], v[52:55], v[232:235], v[84:99]
  s_cmp_lg_u32 s75, 2
  s_cbranch_scc1 L_skip_30
  v_mfma_f32_4x4x4_16b_bf16 v[116:119], v[16:17], v[48:49], v[116:119]
  v_mfma_f32_4x4x4_16b_bf16 v[120:123], v[16:17], v[52:53], v[120:123]
  s_nop 0
  v_mfma_f32_4x4x4_16b_bf16 v[116:119], v[16:17], v[50:51], v[116:119]
  v_mfma_f32_4x4x4_16b_bf16 v[120:123], v[16:17], v[54:55], v[120:123]
L_skip_30:
  s_waitcnt lgkmcnt(0)
  v_mfma_f32_32x32x16_bf16 v[68:83], v[56:59], v[236:239], v[68:83]
  v_mfma_f32_32x32x16_bf16 v[84:99], v[60:63], v[236:239], v[84:99]
  s_cmp_lg_u32 s75, 3
  s_cbranch_scc1 L_skip_31
  v_mfma_f32_4x4x4_16b_bf16 v[116:119], v[16:17], v[56:57], v[116:119]
  v_mfma_f32_4x4x4_16b_bf16 v[120:123], v[16:17], v[60:61], v[120:123]
  s_nop 0
  v_mfma_f32_4x4x4_16b_bf16 v[116:119], v[16:17], v[58:59], v[116:119]
  v_mfma_f32_4x4x4_16b_bf16 v[120:123], v[16:17], v[62:63], v[120:123]
L_skip_31:
  s_nop 4
  s_lshl_b32 s90, s71, 2
  v_lshlrev_b32 v125, 4, v2
  v_add_u32 v125, s90, v125
  v_add_u32 v125, 152320, v125
  v_mov_b32 v124, v116
  s_nop 1
  v_permlane32_swap_b32 v116, v124
  v_add_f32 v116, v116, v124
  ds_write_b32 v125, v116 offset:0
  v_mov_b32 v124, v120
  s_nop 1
  v_permlane32_swap_b32 v120, v124
  v_add_f32 v120, v120, v124
  ds_write_b32 v125, v120 offset:1024
  s_waitcnt lgkmcnt(0)
  s_waitcnt vmcnt(0)
  s_barrier
  s_mul_i32 s90, s70, 384
  v_lshlrev_b32 v8, 4, v3
  v_add_u32 v8, s90, v8
  v_add_u32 v8, 155904, v8
  v_lshlrev_b32 v125, 4, v2
  v_add_u32 v125, 152320, v125
  ds_read_b128 v[116:119], v125 offset:0
  ds_read_b128 v[120:123], v125 offset:1024
  s_mul_i32 s90, s70, 384
  v_lshlrev_b32 v124, 2, v2
  v_add_u32 v124, s90, v124
  v_add_u32 v124, 155904, v124
  s_waitcnt lgkmcnt(1)
  v_add_f32 v116, v116, v117
  v_add_f32 v118, v118, v119
  v_add_f32 v116, v116, v118
  ds_write_b32 v124, v116 offset:0
  s_waitcnt lgkmcnt(1)
  v_add_f32 v120, v120, v121
  v_add_f32 v122, v122, v123
  v_add_f32 v120, v120, v122
  ds_write_b32 v124, v120 offset:128
  s_waitcnt lgkmcnt(0)
  ds_read_b128 v[100:103], v8 offset:128
  ds_read_b128 v[104:107], v8 offset:160
  ds_read_b128 v[108:111], v8 offset:192
  ds_read_b128 v[112:115], v8 offset:224
  ds_read_b128 v[32:35], v8 offset:0
  ds_read_b128 v[36:39], v8 offset:32
  ds_read_b128 v[40:43], v8 offset:64
  ds_read_b128 v[44:47], v8 offset:96
  ds_read_b64_tr_b16 v[56:57], v66
  ds_read_b64_tr_b16 v[58:59], v66 offset:448
  ds_read_b64_tr_b16 v[60:61], v66 offset:896
  ds_read_b64_tr_b16 v[62:63], v67 offset:1344
  s_mov_b32 s95, 0
L_gr_32:
  v_cmp_ne_u32 vcc, s74, v19
  s_add_u32 s95, s95, 1
  s_cmp_eq_u64 vcc, 0
  s_cbranch_scc1 L_grdone_33
  buffer_load_dwordx2 v[18:19], v24, s[48:51], s3 offen sc1
  s_waitcnt vmcnt(0)
  s_cmp_lt_u32 s95, 0x20000
  s_cbranch_scc1 L_gr_32
L_grdone_33:
  v_and_b32 v30, s6, v18
  v_lshlrev_b32 v124, 16, v18
  v_xor_b32 v30, 0x80000000, v30
  v_rcp_f32 v31, v124
  s_waitcnt lgkmcnt(8)
  v_pk_fma_f32 v[84:85], v[100:101], v[30:31], v[84:85] op_sel:[0,0,0] op_sel_hi:[1,0,1]
  v_pk_fma_f32 v[86:87], v[102:103], v[30:31], v[86:87] op_sel:[0,0,0] op_sel_hi:[1,0,1]
  v_pk_fma_f32 v[88:89], v[104:105], v[30:31], v[88:89] op_sel:[0,0,0] op_sel_hi:[1,0,1]
  v_pk_fma_f32 v[90:91], v[106:107], v[30:31], v[90:91] op_sel:[0,0,0] op_sel_hi:[1,0,1]
  v_pk_fma_f32 v[92:93], v[108:109], v[30:31], v[92:93] op_sel:[0,0,0] op_sel_hi:[1,0,1]
  v_pk_fma_f32 v[94:95], v[110:111], v[30:31], v[94:95] op_sel:[0,0,0] op_sel_hi:[1,0,1]
  v_pk_fma_f32 v[96:97], v[112:113], v[30:31], v[96:97] op_sel:[0,0,0] op_sel_hi:[1,0,1]
  v_pk_fma_f32 v[98:99], v[114:115], v[30:31], v[98:99] op_sel:[0,0,0] op_sel_hi:[1,0,1]
  v_pk_mul_f32 v[84:85], v[84:85], v[30:31] op_sel:[0,1] op_sel_hi:[1,1]
  v_pk_mul_f32 v[86:87], v[86:87], v[30:31] op_sel:[0,1] op_sel_hi:[1,1]
  v_pk_mul_f32 v[88:89], v[88:89], v[30:31] op_sel:[0,1] op_sel_hi:[1,1]
  v_pk_mul_f32 v[90:91], v[90:91], v[30:31] op_sel:[0,1] op_sel_hi:[1,1]
  v_pk_mul_f32 v[92:93], v[92:93], v[30:31] op_sel:[0,1] op_sel_hi:[1,1]
  v_pk_mul_f32 v[94:95], v[94:95], v[30:31] op_sel:[0,1] op_sel_hi:[1,1]
  v_pk_mul_f32 v[96:97], v[96:97], v[30:31] op_sel:[0,1] op_sel_hi:[1,1]
  v_pk_mul_f32 v[98:99], v[98:99], v[30:31] op_sel:[0,1] op_sel_hi:[1,1]
  v_cvt_pk_bf16_f32 v100, v84, v85
  v_cvt_pk_bf16_f32 v101, v86, v87
  v_cvt_pk_bf16_f32 v102, v88, v89
  v_cvt_pk_bf16_f32 v103, v90, v91
  v_cvt_pk_bf16_f32 v104, v92, v93
  v_cvt_pk_bf16_f32 v105, v94, v95
  v_cvt_pk_bf16_f32 v106, v96, v97
  v_cvt_pk_bf16_f32 v107, v98, v99
  v_mov_b32 v124, 0x00003f80
  v_cndmask_b32 v106, v106, v124, s[4:5]
  v_mov_b32 v125, 0
  v_cndmask_b32 v107, v107, v125, s[4:5]
  ds_write_b64 v65, v[100:101]
  v_xor_b32 v11, 16, v65
  ds_write_b64 v11, v[102:103]
  v_xor_b32 v11, 32, v65
  ds_write_b64 v11, v[104:105]
  v_xor_b32 v11, 48, v65
  ds_write_b64 v11, v[106:107]
  s_waitcnt lgkmcnt(8)
  v_pk_fma_f32 v[68:69], v[32:33], v[30:31], v[68:69] op_sel:[0,0,0] op_sel_hi:[1,0,1]
  v_pk_fma_f32 v[70:71], v[34:35], v[30:31], v[70:71] op_sel:[0,0,0] op_sel_hi:[1,0,1]
  v_pk_fma_f32 v[72:73], v[36:37], v[30:31], v[72:73] op_sel:[0,0,0] op_sel_hi:[1,0,1]
  v_pk_fma_f32 v[74:75], v[38:39], v[30:31], v[74:75] op_sel:[0,0,0] op_sel_hi:[1,0,1]
  v_pk_fma_f32 v[76:77], v[40:41], v[30:31], v[76:77] op_sel:[0,0,0] op_sel_hi:[1,0,1]
  v_pk_fma_f32 v[78:79], v[42:43], v[30:31], v[78:79] op_sel:[0,0,0] op_sel_hi:[1,0,1]
  v_pk_fma_f32 v[80:81], v[44:45], v[30:31], v[80:81] op_sel:[0,0,0] op_sel_hi:[1,0,1]
  v_pk_fma_f32 v[82:83], v[46:47], v[30:31], v[82:83] op_sel:[0,0,0] op_sel_hi:[1,0,1]
  v_cvt_pk_bf16_f32 v48, v68, v69
  v_cvt_pk_bf16_f32 v49, v70, v71
  v_cvt_pk_bf16_f32 v50, v72, v73
  v_cvt_pk_bf16_f32 v51, v74, v75
  v_cvt_pk_bf16_f32 v52, v76, v77
  v_cvt_pk_bf16_f32 v53, v78, v79
  v_cvt_pk_bf16_f32 v54, v80, v81
  v_cvt_pk_bf16_f32 v55, v82, v83
  s_waitcnt lgkmcnt(4)
  v_mfma_f32_32x32x16_bf16 v[68:83], v[56:59], v[48:51], 0
  v_mfma_f32_32x32x16_bf16 v[68:83], v[60:63], v[52:55], v[68:83]
  v_mul_f32 v116, 0x3fb8aa3b, v31
  s_nop 10
  v_max3_f32 v22, v68, v69, v70
  v_min3_f32 v23, v68, v69, v70
  v_max3_f32 v22, v22, v71, v72
  v_min3_f32 v23, v23, v71, v72
  v_max3_f32 v22, v22, v73, v74
  v_min3_f32 v23, v23, v73, v74
  v_max3_f32 v22, v22, v75, v76
  v_min3_f32 v23, v23, v75, v76
  v_max3_f32 v22, v22, v77, v78
  v_min3_f32 v23, v23, v77, v78
  v_max3_f32 v22, v22, v79, v80
  v_min3_f32 v23, v23, v79, v80
  v_max3_f32 v22, v22, v81, v82
  v_min3_f32 v23, v23, v81, v82
  v_max_f32 v22, v22, v83
  v_min_f32 v23, v23, v83
  v_mov_b32 v24, v22
  s_nop 1
  v_permlane32_swap_b32 v22, v24
  v_max_f32 v22, v22, v24
  v_mov_b32 v24, v23
  s_nop 1
  v_permlane32_swap_b32 v23, v24
  v_min_f32 v23, v23, v24
  v_mul_f32 v118, -v22, v116
  v_mul_f32 v119, v23, v116
  v_pk_fma_f32 v[32:33], v[68:69], v[116:117], v[118:119] op_sel:[0,0,0] op_sel_hi:[1,0,0]
  v_pk_fma_f32 v[48:49], v[68:69], v[116:117], v[118:119] op_sel:[0,0,1] op_sel_hi:[1,0,1] neg_lo:[0,1,0] neg_hi:[0,1,0]
  v_pk_fma_f32 v[34:35], v[70:71], v[116:117], v[118:119] op_sel:[0,0,0] op_sel_hi:[1,0,0]
  v_pk_fma_f32 v[50:51], v[70:71], v[116:117], v[118:119] op_sel:[0,0,1] op_sel_hi:[1,0,1] neg_lo:[0,1,0] neg_hi:[0,1,0]
  v_pk_fma_f32 v[36:37], v[72:73], v[116:117], v[118:119] op_sel:[0,0,0] op_sel_hi:[1,0,0]
  v_pk_fma_f32 v[52:53], v[72:73], v[116:117], v[118:119] op_sel:[0,0,1] op_sel_hi:[1,0,1] neg_lo:[0,1,0] neg_hi:[0,1,0]
  v_pk_fma_f32 v[38:39], v[74:75], v[116:117], v[118:119] op_sel:[0,0,0] op_sel_hi:[1,0,0]
  v_pk_fma_f32 v[54:55], v[74:75], v[116:117], v[118:119] op_sel:[0,0,1] op_sel_hi:[1,0,1] neg_lo:[0,1,0] neg_hi:[0,1,0]
  v_pk_fma_f32 v[40:41], v[76:77], v[116:117], v[118:119] op_sel:[0,0,0] op_sel_hi:[1,0,0]
  v_pk_fma_f32 v[56:57], v[76:77], v[116:117], v[118:119] op_sel:[0,0,1] op_sel_hi:[1,0,1] neg_lo:[0,1,0] neg_hi:[0,1,0]
  v_pk_fma_f32 v[42:43], v[78:79], v[116:117], v[118:119] op_sel:[0,0,0] op_sel_hi:[1,0,0]
  v_pk_fma_f32 v[58:59], v[78:79], v[116:117], v[118:119] op_sel:[0,0,1] op_sel_hi:[1,0,1] neg_lo:[0,1,0] neg_hi:[0,1,0]
  v_pk_fma_f32 v[44:45], v[80:81], v[116:117], v[118:119] op_sel:[0,0,0] op_sel_hi:[1,0,0]
  v_pk_fma_f32 v[60:61], v[80:81], v[116:117], v[118:119] op_sel:[0,0,1] op_sel_hi:[1,0,1] neg_lo:[0,1,0] neg_hi:[0,1,0]
  v_pk_fma_f32 v[46:47], v[82:83], v[116:117], v[118:119] op_sel:[0,0,0] op_sel_hi:[1,0,0]
  v_pk_fma_f32 v[62:63], v[82:83], v[116:117], v[118:119] op_sel:[0,0,1] op_sel_hi:[1,0,1] neg_lo:[0,1,0] neg_hi:[0,1,0]
  v_exp_f32 v32, v32
  v_exp_f32 v48, v48
  v_exp_f32 v33, v33
  v_exp_f32 v49, v49
  v_exp_f32 v34, v34
  v_exp_f32 v50, v50
  v_exp_f32 v35, v35
  v_exp_f32 v51, v51
  v_exp_f32 v36, v36
  v_exp_f32 v52, v52
  v_exp_f32 v37, v37
  v_exp_f32 v53, v53
  v_exp_f32 v38, v38
  v_exp_f32 v54, v54
  v_exp_f32 v39, v39
  v_exp_f32 v55, v55
  v_exp_f32 v40, v40
  v_exp_f32 v56, v56
  v_exp_f32 v41, v41
  v_exp_f32 v57, v57
  v_exp_f32 v42, v42
  v_exp_f32 v58, v58
  v_exp_f32 v43, v43
  v_exp_f32 v59, v59
  v_exp_f32 v44, v44
  v_exp_f32 v60, v60
  v_exp_f32 v45, v45
  v_exp_f32 v61, v61
  v_exp_f32 v46, v46
  v_exp_f32 v62, v62
  v_exp_f32 v47, v47
  v_exp_f32 v63, v63
  v_cndmask_b32 v125, 1.0, 0, s[4:5]
  v_pk_add_f32 v[68:69], v[32:33], v[34:35]
  v_pk_add_f32 v[70:71], v[44:45], v[46:47]
  v_pk_add_f32 v[68:69], v[68:69], v[36:37]
  v_pk_add_f32 v[68:69], v[68:69], v[38:39]
  v_pk_add_f32 v[68:69], v[68:69], v[40:41]
  v_pk_add_f32 v[68:69], v[68:69], v[42:43]
  v_add_f32 v70, v70, v71
  v_add_f32 v120, v68, v69
  v_fmac_f32 v120, v70, v125
  v_pk_add_f32 v[72:73], v[48:49], v[50:51]
  v_pk_add_f32 v[74:75], v[60:61], v[62:63]
  v_pk_add_f32 v[72:73], v[72:73], v[52:53]
  v_pk_add_f32 v[72:73], v[72:73], v[54:55]
  v_pk_add_f32 v[72:73], v[72:73], v[56:57]
  v_pk_add_f32 v[72:73], v[72:73], v[58:59]
  v_add_f32 v74, v74, v75
  v_add_f32 v121, v72, v73
  v_fmac_f32 v121, v74, v125
  v_mov_b32 v24, v120
  s_nop 1
  v_permlane32_swap_b32 v120, v24
  v_add_f32 v120, v120, v24
  v_mov_b32 v24, v121
  s_nop 1
  v_permlane32_swap_b32 v121, v24
  v_add_f32 v121, v121, v24
  v_rcp_f32 v120, v120
  v_rcp_f32 v121, v121
  s_nop 0
  v_pk_mul_f32 v[32:33], v[32:33], v[120:121] op_sel:[0,0] op_sel_hi:[1,0]
  v_pk_mul_f32 v[48:49], v[48:49], v[120:121] op_sel:[0,1] op_sel_hi:[1,1]
  v_pk_mul_f32 v[34:35], v[34:35], v[120:121] op_sel:[0,0] op_sel_hi:[1,0]
  v_pk_mul_f32 v[50:51], v[50:51], v[120:121] op_sel:[0,1] op_sel_hi:[1,1]
  v_pk_mul_f32 v[36:37], v[36:37], v[120:121] op_sel:[0,0] op_sel_hi:[1,0]
  v_pk_mul_f32 v[52:53], v[52:53], v[120:121] op_sel:[0,1] op_sel_hi:[1,1]
  v_pk_mul_f32 v[38:39], v[38:39], v[120:121] op_sel:[0,0] op_sel_hi:[1,0]
  v_pk_mul_f32 v[54:55], v[54:55], v[120:121] op_sel:[0,1] op_sel_hi:[1,1]
  v_pk_mul_f32 v[40:41], v[40:41], v[120:121] op_sel:[0,0] op_sel_hi:[1,0]
  v_pk_mul_f32 v[56:57], v[56:57], v[120:121] op_sel:[0,1] op_sel_hi:[1,1]
  v_pk_mul_f32 v[42:43], v[42:43], v[120:121] op_sel:[0,0] op_sel_hi:[1,0]
  v_pk_mul_f32 v[58:59], v[58:59], v[120:121] op_sel:[0,1] op_sel_hi:[1,1]
  v_pk_mul_f32 v[44:45], v[44:45], v[120:121] op_sel:[0,0] op_sel_hi:[1,0]
  v_pk_mul_f32 v[60:61], v[60:61], v[120:121] op_sel:[0,1] op_sel_hi:[1,1]
  v_pk_mul_f32 v[46:47], v[46:47], v[120:121] op_sel:[0,0] op_sel_hi:[1,0]
  v_pk_mul_f32 v[62:63], v[62:63], v[120:121] op_sel:[0,1] op_sel_hi:[1,1]
  v_cvt_pk_bf16_f32 v240, v32, v33
  v_cvt_pk_bf16_f32 v248, v48, v49
  v_cvt_pk_bf16_f32 v241, v34, v35
  v_cvt_pk_bf16_f32 v249, v50, v51
  v_cvt_pk_bf16_f32 v242, v36, v37
  v_cvt_pk_bf16_f32 v250, v52, v53
  v_cvt_pk_bf16_f32 v243, v38, v39
  v_cvt_pk_bf16_f32 v251, v54, v55
  v_cvt_pk_bf16_f32 v244, v40, v41
  v_cvt_pk_bf16_f32 v252, v56, v57
  v_cvt_pk_bf16_f32 v245, v42, v43
  v_cvt_pk_bf16_f32 v253, v58, v59
  v_cvt_pk_bf16_f32 v246, v44, v45
  v_cvt_pk_bf16_f32 v254, v60, v61
  v_cvt_pk_bf16_f32 v247, v46, v47
  v_cvt_pk_bf16_f32 v255, v62, v63
  ds_write_b64 v64, v[240:241]
  v_xor_b32 v125, 16, v64
  ds_write_b64 v125, v[242:243]
  v_xor_b32 v125, 32, v64
  ds_write_b64 v125, v[244:245]
  v_xor_b32 v125, 48, v64
  ds_write_b64 v125, v[246:247]
  v_xor_b32 v125, 64, v64
  ds_write_b64 v125, v[248:249]
  v_xor_b32 v125, 80, v64
  ds_write_b64 v125, v[250:251]
  v_xor_b32 v125, 96, v64
  ds_write_b64 v125, v[252:253]
  v_xor_b32 v125, 112, v64
  ds_write_b64 v125, v[254:255]
  s_waitcnt lgkmcnt(0)
  s_barrier
  s_cmp_gt_u32 s71, 1
  s_cbranch_scc1 L_nopart_34
  ds_read_b64_tr_b16 v[32:33], v26 offset:0
  ds_read_b64_tr_b16 v[34:35], v27 offset:0
  ds_read_b64_tr_b16 v[36:37], v28 offset:0
  ds_read_b64_tr_b16 v[38:39], v29 offset:0
  ds_read_b64_tr_b16 v[40:41], v26 offset:2048
  ds_read_b64_tr_b16 v[42:43], v27 offset:2048
  ds_read_b64_tr_b16 v[44:45], v28 offset:1024
  ds_read_b64_tr_b16 v[46:47], v29 offset:1024
  ds_read_b64_tr_b16 v[48:49], v26 offset:4096
  ds_read_b64_tr_b16 v[50:51], v27 offset:4096
  ds_read_b64_tr_b16 v[52:53], v28 offset:2048
  ds_read_b64_tr_b16 v[54:55], v29 offset:2048
  s_waitcnt lgkmcnt(8)
  v_mfma_f32_32x32x16_bf16 v[68:83], v[32:35], v[36:39], 0
  ds_read_b64_tr_b16 v[32:33], v26 offset:6144
  ds_read_b64_tr_b16 v[34:35], v27 offset:6144
  ds_read_b64_tr_b16 v[36:37], v28 offset:3072
  ds_read_b64_tr_b16 v[38:39], v29 offset:3072
  s_waitcnt lgkmcnt(8)
  v_mfma_f32_32x32x16_bf16 v[68:83], v[40:43], v[44:47], v[68:83]
  ds_read_b64_tr_b16 v[40:41], v26 offset:8192
  ds_read_b64_tr_b16 v[42:43], v27 offset:8192
  ds_read_b64_tr_b16 v[44:45], v28 offset:4096
  ds_read_b64_tr_b16 v[46:47], v29 offset:4096
  s_waitcnt lgkmcnt(8)
  v_mfma_f32_32x32x16_bf16 v[68:83], v[48:51], v[52:55], v[68:83]
  ds_read_b64_tr_b16 v[48:49], v26 offset:10240
  ds_read_b64_tr_b16 v[50:51], v27 offset:10240
  ds_read_b64_tr_b16 v[52:53], v28 offset:5120
  ds_read_b64_tr_b16 v[54:55], v29 offset:5120
  s_waitcnt lgkmcnt(8)
  v_mfma_f32_32x32x16_bf16 v[68:83], v[32:35], v[36:39], v[68:83]
  ds_read_b64_tr_b16 v[32:33], v26 offset:12288
  ds_read_b64_tr_b16 v[34:35], v27 offset:12288
  ds_read_b64_tr_b16 v[36:37], v28 offset:6144
  ds_read_b64_tr_b16 v[38:39], v29 offset:6144
  s_waitcnt lgkmcnt(8)
  v_mfma_f32_32x32x16_bf16 v[68:83], v[40:43], v[44:47], v[68:83]
  ds_read_b64_tr_b16 v[40:41], v26 offset:14336
  ds_read_b64_tr_b16 v[42:43], v27 offset:14336
  ds_read_b64_tr_b16 v[44:45], v28 offset:7168
  ds_read_b64_tr_b16 v[46:47], v29 offset:7168
  s_waitcnt lgkmcnt(8)
  v_mfma_f32_32x32x16_bf16 v[68:83], v[48:51], v[52:55], v[68:83]
  s_waitcnt lgkmcnt(4)
  v_mfma_f32_32x32x16_bf16 v[68:83], v[32:35], v[36:39], v[68:83]
  s_waitcnt lgkmcnt(0)
  v_mfma_f32_32x32x16_bf16 v[68:83], v[40:43], v[44:47], v[68:83]
  s_lshl_b32 s90, s73, 1
  s_lshl_b32 s90, s90, 4
  s_add_u32 s90, s90, s68
  s_lshl_b32 s90, s90, 1
  s_add_u32 s90, s90, s71
  s_lshl_b32 s90, s90, 12
  s_add_u32 s90, s90, 262144
  v_lshlrev_b32 v124, 4, v1
  s_nop 3
  v_cvt_pk_bf16_f32 v68, v68, v69
  v_cvt_pk_bf16_f32 v70, v70, v71
  v_mov_b32 v69, s74
  v_mov_b32 v71, s74
  v_cvt_pk_bf16_f32 v72, v72, v73
  v_cvt_pk_bf16_f32 v74, v74, v75
  v_mov_b32 v73, s74
  v_mov_b32 v75, s74
  v_cvt_pk_bf16_f32 v76, v76, v77
  v_cvt_pk_bf16_f32 v78, v78, v79
  v_mov_b32 v77, s74
  v_mov_b32 v79, s74
  v_cvt_pk_bf16_f32 v80, v80, v81
  v_cvt_pk_bf16_f32 v82, v82, v83
  v_mov_b32 v81, s74
  v_mov_b32 v83, s74
  buffer_store_dwordx4 v[68:71], v124, s[48:51], s90 offen offset:0 sc1
  buffer_store_dwordx4 v[72:75], v124, s[48:51], s90 offen offset:1024 sc1
  buffer_store_dwordx4 v[76:79], v124, s[48:51], s90 offen offset:2048 sc1
  buffer_store_dwordx4 v[80:83], v124, s[48:51], s90 offen offset:3072 sc1
L_nopart_34:
  v_add_u32 v12, 98304, v15
  v_mov_b32 v116, 0
  v_mov_b32 v117, 0
  v_mov_b32 v118, 0
  v_mov_b32 v119, 0
  ds_read_b64_tr_b16 v[32:33], v12 offset:0
  ds_read_b64_tr_b16 v[34:35], v12 offset:512
  ds_read_b64_tr_b16 v[36:37], v12 offset:2048
  ds_read_b64_tr_b16 v[38:39], v12 offset:2560
  ds_read_b64_tr_b16 v[40:41], v12 offset:4096
  ds_read_b64_tr_b16 v[42:43], v12 offset:4608
  ds_read_b64_tr_b16 v[44:45], v12 offset:6144
  ds_read_b64_tr_b16 v[46:47], v12 offset:6656
  ds_read_b64_tr_b16 v[48:49], v12 offset:8192
  ds_read_b64_tr_b16 v[50:51], v12 offset:8704
  ds_read_b64_tr_b16 v[52:53], v12 offset:10240
  ds_read_b64_tr_b16 v[54:55], v12 offset:10752
  s_waitcnt lgkmcnt(10)
  v_mfma_f32_32x32x16_bf16 v[100:115], v[32:35], v[128:131], 0
  ds_read_b64_tr_b16 v[56:57], v12 offset:12288
  ds_read_b64_tr_b16 v[58:59], v12 offset:12800
  s_cmp_lg_u32 s71, 0
  s_cbranch_scc1 L_skip_35
  v_mfma_f32_4x4x4_16b_bf16 v[116:119], v[16:17], v[32:33], v[116:119]
  s_nop 1
  v_mfma_f32_4x4x4_16b_bf16 v[116:119], v[16:17], v[34:35], v[116:119]
L_skip_35:
  s_waitcnt lgkmcnt(10)
  v_mfma_f32_32x32x16_bf16 v[100:115], v[36:39], v[132:135], v[100:115]
  ds_read_b64_tr_b16 v[60:61], v12 offset:14336
  ds_read_b64_tr_b16 v[62:63], v12 offset:14848
  s_cmp_lg_u32 s71, 1
  s_cbranch_scc1 L_skip_36
  v_mfma_f32_4x4x4_16b_bf16 v[116:119], v[16:17], v[36:37], v[116:119]
  s_nop 1
  v_mfma_f32_4x4x4_16b_bf16 v[116:119], v[16:17], v[38:39], v[116:119]
L_skip_36:
  s_lshr_b32 s92, s2, 3
  s_mul_i32 s93, s92, 50176
  s_mul_i32 s94, s70, 6272
  s_add_u32 s80, s93, s94
  s_mul_i32 s93, s92, 12544
  s_mul_i32 s94, s70, 1568
  s_add_u32 s81, s93, s94
  v_lshlrev_b32 v6, 4, v1
  s_waitcnt lgkmcnt(10)
  v_mfma_f32_32x32x16_bf16 v[100:115], v[40:43], v[136:139], v[100:115]
  ds_read_b64_tr_b16 v[32:33], v12 offset:16384
  ds_read_b64_tr_b16 v[34:35], v12 offset:16896
  s_cmp_lg_u32 s71, 2
  s_cbranch_scc1 L_skip_37
  v_mfma_f32_4x4x4_16b_bf16 v[116:119], v[16:17], v[40:41], v[116:119]
  s_nop 1
  v_mfma_f32_4x4x4_16b_bf16 v[116:119], v[16:17], v[42:43], v[116:119]
L_skip_37:
  s_waitcnt lgkmcnt(10)
  v_mfma_f32_32x32x16_bf16 v[100:115], v[44:47], v[140:143], v[100:115]
  ds_read_b64_tr_b16 v[36:37], v12 offset:18432
  ds_read_b64_tr_b16 v[38:39], v12 offset:18944
  s_cmp_lg_u32 s71, 3
  s_cbranch_scc1 L_skip_38
  v_mfma_f32_4x4x4_16b_bf16 v[116:119], v[16:17], v[44:45], v[116:119]
  s_nop 1
  v_mfma_f32_4x4x4_16b_bf16 v[116:119], v[16:17], v[46:47], v[116:119]
L_skip_38:
  s_waitcnt lgkmcnt(10)
  v_mfma_f32_32x32x16_bf16 v[100:115], v[48:51], v[144:147], v[100:115]
  ds_read_b64_tr_b16 v[40:41], v12 offset:20480
  ds_read_b64_tr_b16 v[42:43], v12 offset:20992
  s_cmp_lg_u32 s71, 0
  s_cbranch_scc1 L_skip_39
  v_mfma_f32_4x4x4_16b_bf16 v[116:119], v[16:17], v[48:49], v[116:119]
  s_nop 1
  v_mfma_f32_4x4x4_16b_bf16 v[116:119], v[16:17], v[50:51], v[116:119]
L_skip_39:
  s_add_u32 s82, s80, 0
  s_mov_b32 m0, 160000
  s_nop 0
  buffer_load_dwordx4 v6, s[40:43], s82 offen lds
  s_waitcnt lgkmcnt(10)
  v_mfma_f32_32x32x16_bf16 v[100:115], v[52:55], v[148:151], v[100:115]
  ds_read_b64_tr_b16 v[44:45], v12 offset:22528
  ds_read_b64_tr_b16 v[46:47], v12 offset:23040
  s_cmp_lg_u32 s71, 1
  s_cbranch_scc1 L_skip_40
  v_mfma_f32_4x4x4_16b_bf16 v[116:119], v[16:17], v[52:53], v[116:119]
  s_nop 1
  v_mfma_f32_4x4x4_16b_bf16 v[116:119], v[16:17], v[54:55], v[116:119]
L_skip_40:
  s_waitcnt lgkmcnt(10)
  v_mfma_f32_32x32x16_bf16 v[100:115], v[56:59], v[152:155], v[100:115]
  ds_read_b64_tr_b16 v[48:49], v12 offset:24576
  ds_read_b64_tr_b16 v[50:51], v12 offset:25088
  s_cmp_lg_u32 s71, 2
  s_cbranch_scc1 L_skip_41
  v_mfma_f32_4x4x4_16b_bf16 v[116:119], v[16:17], v[56:57], v[116:119]
  s_nop 1
  v_mfma_f32_4x4x4_16b_bf16 v[116:119], v[16:17], v[58:59], v[116:119]
L_skip_41:
  s_waitcnt lgkmcnt(10)
  v_mfma_f32_32x32x16_bf16 v[100:115], v[60:63], v[156:159], v[100:115]
  ds_read_b64_tr_b16 v[52:53], v12 offset:26624
  ds_read_b64_tr_b16 v[54:55], v12 offset:27136
  s_cmp_lg_u32 s71, 3
  s_cbranch_scc1 L_skip_42
  v_mfma_f32_4x4x4_16b_bf16 v[116:119], v[16:17], v[60:61], v[116:119]
  s_nop 1
  v_mfma_f32_4x4x4_16b_bf16 v[116:119], v[16:17], v[62:63], v[116:119]
L_skip_42:
  s_add_u32 s82, s80, 1024
  s_mov_b32 m0, 160000
  s_nop 0
  buffer_load_dwordx4 v6, s[40:43], s82 offen lds
  s_waitcnt lgkmcnt(10)
  v_mfma_f32_32x32x16_bf16 v[100:115], v[32:35], v[160:163], v[100:115]
  ds_read_b64_tr_b16 v[56:57], v12 offset:28672
  ds_read_b64_tr_b16 v[58:59], v12 offset:29184
  s_cmp_lg_u32 s71, 0
  s_cbranch_scc1 L_skip_43
  v_mfma_f32_4x4x4_16b_bf16 v[116:119], v[16:17], v[32:33], v[116:119]
  s_nop 1
  v_mfma_f32_4x4x4_16b_bf16 v[116:119], v[16:17], v[34:35], v[116:119]
L_skip_43:
  s_waitcnt lgkmcnt(10)
  v_mfma_f32_32x32x16_bf16 v[100:115], v[36:39], v[164:167], v[100:115]
  ds_read_b64_tr_b16 v[60:61], v12 offset:30720
  ds_read_b64_tr_b16 v[62:63], v12 offset:31232
  s_cmp_lg_u32 s71, 1
  s_cbranch_scc1 L_skip_44
  v_mfma_f32_4x4x4_16b_bf16 v[116:119], v[16:17], v[36:37], v[116:119]
  s_nop 1
  v_mfma_f32_4x4x4_16b_bf16 v[116:119], v[16:17], v[38:39], v[116:119]
L_skip_44:
  s_waitcnt lgkmcnt(10)
  v_mfma_f32_32x32x16_bf16 v[100:115], v[40:43], v[168:171], v[100:115]
  ds_read_b64_tr_b16 v[32:33], v15 offset:0
  ds_read_b64_tr_b16 v[34:35], v15 offset:512
  s_cmp_lg_u32 s71, 2
  s_cbranch_scc1 L_skip_45
  v_mfma_f32_4x4x4_16b_bf16 v[116:119], v[16:17], v[40:41], v[116:119]
  s_nop 1
  v_mfma_f32_4x4x4_16b_bf16 v[116:119], v[16:17], v[42:43], v[116:119]
L_skip_45:
  s_add_u32 s82, s80, 2048
  s_mov_b32 m0, 160000
  s_nop 0
  buffer_load_dwordx4 v6, s[40:43], s82 offen lds
  s_waitcnt lgkmcnt(10)
  v_mfma_f32_32x32x16_bf16 v[100:115], v[44:47], v[172:175], v[100:115]
  ds_read_b64_tr_b16 v[36:37], v15 offset:2048
  ds_read_b64_tr_b16 v[38:39], v15 offset:2560
  s_cmp_lg_u32 s71, 3
  s_cbranch_scc1 L_skip_46
  v_mfma_f32_4x4x4_16b_bf16 v[116:119], v[16:17], v[44:45], v[116:119]
  s_nop 1
  v_mfma_f32_4x4x4_16b_bf16 v[116:119], v[16:17], v[46:47], v[116:119]
L_skip_46:
  s_waitcnt lgkmcnt(10)
  v_mfma_f32_32x32x16_bf16 v[100:115], v[48:51], v[176:179], v[100:115]
  ds_read_b64_tr_b16 v[40:41], v15 offset:4096
  ds_read_b64_tr_b16 v[42:43], v15 offset:4608
  s_cmp_lg_u32 s71, 0
  s_cbranch_scc1 L_skip_47
  v_mfma_f32_4x4x4_16b_bf16 v[116:119], v[16:17], v[48:49], v[116:119]
  s_nop 1
  v_mfma_f32_4x4x4_16b_bf16 v[116:119], v[16:17], v[50:51], v[116:119]
L_skip_47:
  s_waitcnt lgkmcnt(10)
  v_mfma_f32_32x32x16_bf16 v[100:115], v[52:55], v[180:183], v[100:115]
  ds_read_b64_tr_b16 v[44:45], v15 offset:6144
  ds_read_b64_tr_b16 v[46:47], v15 offset:6656
  s_cmp_lg_u32 s71, 1
  s_cbranch_scc1 L_skip_48
  v_mfma_f32_4x4x4_16b_bf16 v[116:119], v[16:17], v[52:53], v[116:119]
  s_nop 1
  v_mfma_f32_4x4x4_16b_bf16 v[116:119], v[16:17], v[54:55], v[116:119]
L_skip_48:
  s_add_u32 s82, s80, 3072
  s_mov_b32 m0, 160000
  s_nop 0
  buffer_load_dwordx4 v6, s[40:43], s82 offen lds
  s_waitcnt lgkmcnt(10)
  v_mfma_f32_32x32x16_bf16 v[100:115], v[56:59], v[184:187], v[100:115]
  ds_read_b64_tr_b16 v[48:49], v15 offset:8192
  ds_read_b64_tr_b16 v[50:51], v15 offset:8704
  s_cmp_lg_u32 s71, 2
  s_cbranch_scc1 L_skip_49
  v_mfma_f32_4x4x4_16b_bf16 v[116:119], v[16:17], v[56:57], v[116:119]
  s_nop 1
  v_mfma_f32_4x4x4_16b_bf16 v[116:119], v[16:17], v[58:59], v[116:119]
L_skip_49:
  s_waitcnt lgkmcnt(10)
  v_mfma_f32_32x32x16_bf16 v[100:115], v[60:63], v[188:191], v[100:115]
  ds_read_b64_tr_b16 v[52:53], v15 offset:10240
  ds_read_b64_tr_b16 v[54:55], v15 offset:10752
  s_cmp_lg_u32 s71, 3
  s_cbranch_scc1 L_skip_50
  v_mfma_f32_4x4x4_16b_bf16 v[116:119], v[16:17], v[60:61], v[116:119]
  s_nop 1
  v_mfma_f32_4x4x4_16b_bf16 v[116:119], v[16:17], v[62:63], v[116:119]
L_skip_50:
  s_waitcnt lgkmcnt(10)
  v_mfma_f32_32x32x16_bf16 v[100:115], v[32:35], v[192:195], v[100:115]
  ds_read_b64_tr_b16 v[56:57], v15 offset:12288
  ds_read_b64_tr_b16 v[58:59], v15 offset:12800
  s_cmp_lg_u32 s71, 0
  s_cbranch_scc1 L_skip_51
  v_mfma_f32_4x4x4_16b_bf16 v[116:119], v[16:17], v[32:33], v[116:119]
  s_nop 1
  v_mfma_f32_4x4x4_16b_bf16 v[116:119], v[16:17], v[34:35], v[116:119]
L_skip_51:
  s_add_u32 s82, s80, 4096
  s_mov_b32 m0, 160000
  s_nop 0
  buffer_load_dwordx4 v6, s[40:43], s82 offen lds
  s_waitcnt lgkmcnt(10)
  v_mfma_f32_32x32x16_bf16 v[100:115], v[36:39], v[196:199], v[100:115]
  ds_read_b64_tr_b16 v[60:61], v15 offset:14336
  ds_read_b64_tr_b16 v[62:63], v15 offset:14848
  s_cmp_lg_u32 s71, 1
  s_cbranch_scc1 L_skip_52
  v_mfma_f32_4x4x4_16b_bf16 v[116:119], v[16:17], v[36:37], v[116:119]
  s_nop 1
  v_mfma_f32_4x4x4_16b_bf16 v[116:119], v[16:17], v[38:39], v[116:119]
L_skip_52:
  s_waitcnt lgkmcnt(10)
  v_mfma_f32_32x32x16_bf16 v[100:115], v[40:43], v[200:203], v[100:115]
  ds_read_b64_tr_b16 v[32:33], v15 offset:16384
  ds_read_b64_tr_b16 v[34:35], v15 offset:16896
  s_cmp_lg_u32 s71, 2
  s_cbranch_scc1 L_skip_53
  v_mfma_f32_4x4x4_16b_bf16 v[116:119], v[16:17], v[40:41], v[116:119]
  s_nop 1
  v_mfma_f32_4x4x4_16b_bf16 v[116:119], v[16:17], v[42:43], v[116:119]
L_skip_53:
  s_waitcnt lgkmcnt(10)
  v_mfma_f32_32x32x16_bf16 v[100:115], v[44:47], v[204:207], v[100:115]
  ds_read_b64_tr_b16 v[36:37], v15 offset:18432
  ds_read_b64_tr_b16 v[38:39], v15 offset:18944
  s_cmp_lg_u32 s71, 3
  s_cbranch_scc1 L_skip_54
  v_mfma_f32_4x4x4_16b_bf16 v[116:119], v[16:17], v[44:45], v[116:119]
  s_nop 1
  v_mfma_f32_4x4x4_16b_bf16 v[116:119], v[16:17], v[46:47], v[116:119]
L_skip_54:
  s_add_u32 s82, s80, 5120
  s_mov_b32 m0, 160000
  s_nop 0
  buffer_load_dwordx4 v6, s[40:43], s82 offen lds
  s_waitcnt lgkmcnt(10)
  v_mfma_f32_32x32x16_bf16 v[100:115], v[48:51], v[208:211], v[100:115]
  ds_read_b64_tr_b16 v[40:41], v15 offset:20480
  ds_read_b64_tr_b16 v[42:43], v15 offset:20992
  s_cmp_lg_u32 s71, 0
  s_cbranch_scc1 L_skip_55
  v_mfma_f32_4x4x4_16b_bf16 v[116:119], v[16:17], v[48:49], v[116:119]
  s_nop 1
  v_mfma_f32_4x4x4_16b_bf16 v[116:119], v[16:17], v[50:51], v[116:119]
L_skip_55:
  s_waitcnt lgkmcnt(10)
  v_mfma_f32_32x32x16_bf16 v[100:115], v[52:55], v[212:215], v[100:115]
  ds_read_b64_tr_b16 v[44:45], v15 offset:22528
  ds_read_b64_tr_b16 v[46:47], v15 offset:23040
  s_cmp_lg_u32 s71, 1
  s_cbranch_scc1 L_skip_56
  v_mfma_f32_4x4x4_16b_bf16 v[116:119], v[16:17], v[52:53], v[116:119]
  s_nop 1
  v_mfma_f32_4x4x4_16b_bf16 v[116:119], v[16:17], v[54:55], v[116:119]
L_skip_56:
  s_waitcnt lgkmcnt(10)
  v_mfma_f32_32x32x16_bf16 v[100:115], v[56:59], v[216:219], v[100:115]
  s_cmp_lg_u32 s71, 2
  s_cbranch_scc1 L_skip_57
  v_mfma_f32_4x4x4_16b_bf16 v[116:119], v[16:17], v[56:57], v[116:119]
  s_nop 1
  v_mfma_f32_4x4x4_16b_bf16 v[116:119], v[16:17], v[58:59], v[116:119]
L_skip_57:
  s_add_u32 s82, s80, 5248
  s_mov_b32 m0, 160000
  s_nop 0
  buffer_load_dwordx4 v6, s[40:43], s82 offen lds
  s_waitcnt lgkmcnt(8)
  v_mfma_f32_32x32x16_bf16 v[100:115], v[60:63], v[220:223], v[100:115]
  s_cmp_lg_u32 s71, 3
  s_cbranch_scc1 L_skip_58
  v_mfma_f32_4x4x4_16b_bf16 v[116:119], v[16:17], v[60:61], v[116:119]
  s_nop 1
  v_mfma_f32_4x4x4_16b_bf16 v[116:119], v[16:17], v[62:63], v[116:119]
L_skip_58:
  s_waitcnt lgkmcnt(6)
  v_mfma_f32_32x32x16_bf16 v[100:115], v[32:35], v[224:227], v[100:115]
  s_cmp_lg_u32 s71, 0
  s_cbranch_scc1 L_skip_59
  v_mfma_f32_4x4x4_16b_bf16 v[116:119], v[16:17], v[32:33], v[116:119]
  s_nop 1
  v_mfma_f32_4x4x4_16b_bf16 v[116:119], v[16:17], v[34:35], v[116:119]
L_skip_59:
  s_waitcnt lgkmcnt(4)
  v_mfma_f32_32x32x16_bf16 v[100:115], v[36:39], v[228:231], v[100:115]
  s_cmp_lg_u32 s71, 1
  s_cbranch_scc1 L_skip_60
  v_mfma_f32_4x4x4_16b_bf16 v[116:119], v[16:17], v[36:37], v[116:119]
  s_nop 1
  v_mfma_f32_4x4x4_16b_bf16 v[116:119], v[16:17], v[38:39], v[116:119]
L_skip_60:
  s_add_u32 s82, s81, 0
  s_mov_b32 m0, 160000
  s_nop 0
  buffer_load_dwordx4 v6, s[44:47], s82 offen lds
  s_waitcnt lgkmcnt(2)
  v_mfma_f32_32x32x16_bf16 v[100:115], v[40:43], v[232:235], v[100:115]
  s_cmp_lg_u32 s71, 2
  s_cbranch_scc1 L_skip_61
  v_mfma_f32_4x4x4_16b_bf16 v[116:119], v[16:17], v[40:41], v[116:119]
  s_nop 1
  v_mfma_f32_4x4x4_16b_bf16 v[116:119], v[16:17], v[42:43], v[116:119]
L_skip_61:
  s_waitcnt lgkmcnt(0)
  v_mfma_f32_32x32x16_bf16 v[100:115], v[44:47], v[236:239], v[100:115]
  s_cmp_lg_u32 s71, 3
  s_cbranch_scc1 L_skip_62
  v_mfma_f32_4x4x4_16b_bf16 v[116:119], v[16:17], v[44:45], v[116:119]
  s_nop 1
  v_mfma_f32_4x4x4_16b_bf16 v[116:119], v[16:17], v[46:47], v[116:119]
L_skip_62:
  s_add_u32 s82, s81, 544
  s_mov_b32 m0, 160000
  s_nop 0
  buffer_load_dwordx4 v6, s[44:47], s82 offen lds
  s_nop 4
  s_lshl_b32 s90, s71, 2
  v_lshlrev_b32 v125, 4, v2
  v_add_u32 v125, s90, v125
  v_add_u32 v125, 152320, v125
  v_mov_b32 v124, v116
  s_nop 1
  v_permlane32_swap_b32 v116, v124
  v_add_f32 v116, v116, v124
  ds_write_b32 v125, v116 offset:2048
  s_waitcnt lgkmcnt(0)
  s_barrier
  v_lshlrev_b32 v125, 4, v2
  v_add_u32 v125, 152320, v125
  ds_read_b128 v[116:119], v125 offset:2048
  s_mul_i32 s90, s70, 384
  v_lshlrev_b32 v124, 2, v2
  v_add_u32 v124, s90, v124
  v_add_u32 v124, 155904, v124
  s_waitcnt lgkmcnt(0)
  v_add_f32 v116, v116, v117
  v_add_f32 v118, v118, v119
  v_add_f32 v116, v116, v118
  ds_write_b32 v124, v116 offset:256
  s_waitcnt lgkmcnt(0)
  v_lshlrev_b32 v9, 4, v3
  v_add_u32 v9, 151680, v9
  v_lshlrev_b32 v10, 4, v1
  ds_read_b128 v[32:35], v8 offset:256
  ds_read_b128 v[36:39], v8 offset:288
  ds_read_b128 v[40:43], v8 offset:320
  ds_read_b128 v[44:47], v8 offset:352
  ds_read_b128 v[48:51], v9 offset:0
  ds_read_b128 v[52:55], v9 offset:32
  ds_read_b128 v[56:59], v9 offset:64
  ds_read_b128 v[60:63], v9 offset:96
  s_waitcnt lgkmcnt(4)
  v_pk_fma_f32 v[100:101], v[32:33], v[30:31], v[100:101] op_sel:[0,0,0] op_sel_hi:[1,0,1]
  v_pk_fma_f32 v[102:103], v[34:35], v[30:31], v[102:103] op_sel:[0,0,0] op_sel_hi:[1,0,1]
  v_pk_fma_f32 v[104:105], v[36:37], v[30:31], v[104:105] op_sel:[0,0,0] op_sel_hi:[1,0,1]
  v_pk_fma_f32 v[106:107], v[38:39], v[30:31], v[106:107] op_sel:[0,0,0] op_sel_hi:[1,0,1]
  v_pk_fma_f32 v[108:109], v[40:41], v[30:31], v[108:109] op_sel:[0,0,0] op_sel_hi:[1,0,1]
  v_pk_fma_f32 v[110:111], v[42:43], v[30:31], v[110:111] op_sel:[0,0,0] op_sel_hi:[1,0,1]
  v_pk_fma_f32 v[112:113], v[44:45], v[30:31], v[112:113] op_sel:[0,0,0] op_sel_hi:[1,0,1]
  v_pk_fma_f32 v[114:115], v[46:47], v[30:31], v[114:115] op_sel:[0,0,0] op_sel_hi:[1,0,1]
  s_waitcnt lgkmcnt(0)
  v_pk_fma_f32 v[100:101], v[100:101], v[30:31], v[48:49] op_sel:[0,1,0] op_sel_hi:[1,1,1]
  v_pk_fma_f32 v[102:103], v[102:103], v[30:31], v[50:51] op_sel:[0,1,0] op_sel_hi:[1,1,1]
  v_pk_fma_f32 v[104:105], v[104:105], v[30:31], v[52:53] op_sel:[0,1,0] op_sel_hi:[1,1,1]
  v_pk_fma_f32 v[106:107], v[106:107], v[30:31], v[54:55] op_sel:[0,1,0] op_sel_hi:[1,1,1]
  v_pk_fma_f32 v[108:109], v[108:109], v[30:31], v[56:57] op_sel:[0,1,0] op_sel_hi:[1,1,1]
  v_pk_fma_f32 v[110:111], v[110:111], v[30:31], v[58:59] op_sel:[0,1,0] op_sel_hi:[1,1,1]
  v_pk_fma_f32 v[112:113], v[112:113], v[30:31], v[60:61] op_sel:[0,1,0] op_sel_hi:[1,1,1]
  v_pk_fma_f32 v[114:115], v[114:115], v[30:31], v[62:63] op_sel:[0,1,0] op_sel_hi:[1,1,1]
  v_max_f32 v100, 0, v100
  v_max_f32 v101, 0, v101
  v_max_f32 v102, 0, v102
  v_max_f32 v103, 0, v103
  v_max_f32 v104, 0, v104
  v_max_f32 v105, 0, v105
  v_max_f32 v106, 0, v106
  v_max_f32 v107, 0, v107
  v_max_f32 v108, 0, v108
  v_max_f32 v109, 0, v109
  v_max_f32 v110, 0, v110
  v_max_f32 v111, 0, v111
  v_max_f32 v112, 0, v112
  v_max_f32 v113, 0, v113
  v_max_f32 v114, 0, v114
  v_max_f32 v115, 0, v115
  v_pk_mul_f32 v[100:101], v[100:101], v[100:101]
  v_pk_mul_f32 v[102:103], v[102:103], v[102:103]
  v_pk_mul_f32 v[104:105], v[104:105], v[104:105]
  v_pk_mul_f32 v[106:107], v[106:107], v[106:107]
  v_pk_mul_f32 v[108:109], v[108:109], v[108:109]
  v_pk_mul_f32 v[110:111], v[110:111], v[110:111]
  v_pk_mul_f32 v[112:113], v[112:113], v[112:113]
  v_pk_mul_f32 v[114:115], v[114:115], v[114:115]
  v_cvt_pk_bf16_f32 v100, v100, v101
  v_cvt_pk_bf16_f32 v101, v102, v103
  v_cvt_pk_bf16_f32 v102, v104, v105
  v_cvt_pk_bf16_f32 v103, v106, v107
  v_cvt_pk_bf16_f32 v104, v108, v109
  v_cvt_pk_bf16_f32 v105, v110, v111
  v_cvt_pk_bf16_f32 v106, v112, v113
  v_cvt_pk_bf16_f32 v107, v114, v115
  s_lshl_b32 s90, s12, 10
  s_add_u32 s90, s90, s15
  buffer_store_dwordx4 v[100:103], v10, s[48:51], s90 offen sc1
  buffer_store_dwordx4 v[104:107], v10, s[48:51], s90 offen offset:1024 sc1
  s_waitcnt vmcnt(0)
  s_setprio 0
  s_barrier
  s_cmp_lg_u32 s71, 0
  s_cbranch_scc1 L_nohf_63
  s_cmp_lg_u32 s74, 0
  s_cbranch_scc1 L_tagok_64
  s_mov_b32 s95, 0
L_tagloop_65:
  v_mov_b32 v124, 0
  buffer_load_dword v125, v124, s[60:63], 0 offen sc1
  s_waitcnt vmcnt(0)
  v_readfirstlane_b32 s74, v125
  s_add_u32 s95, s95, 1
  s_cmp_lg_u32 s74, 0
  s_cbranch_scc1 L_tagok_64
  s_cmp_lt_u32 s95, 0x40000
  s_cbranch_scc1 L_tagloop_65
L_tagok_64:
  s_lshl_b32 s90, s68, 4
  s_add_u32 s90, s90, s69
  s_lshl_b32 s90, s90, 7
  s_add_u32 s90, s90, 86016
  v_mov_b32 v124, 0
  v_mov_b32 v125, s74
  s_mov_b64 s[100:101], exec
  s_mov_b64 exec, 1
  buffer_store_dword v125, v124, s[48:51], s90 offen sc1
  s_mov_b64 exec, s[100:101]
L_nohf_63:
  s_branch L_S2_FK
L_KV1:
  s_mov_b32 s94, s93
  s_lshl_b32 s90, s71, 6
  v_add_u32 v244, s90, v1
  s_lshl_b32 s91, s73, 6
  v_add_u32 v245, s91, v244
  v_lshlrev_b32 v245, 1, v245
  v_lshlrev_b32 v246, 2, v244
  v_add_u32 v246, 151680, v246
  s_mov_b32 s56, s16
  s_and_b32 s57, s17, 0xffff
  s_mov_b32 s58, 3584
  s_mov_b32 s59, 0x20000
  buffer_load_ushort v247, v245, s[56:59], 0 offen
  s_mov_b32 s40, s18
  s_and_b32 s41, s19, 0xffff
  s_mov_b32 s42, 1605632
  s_mov_b32 s43, 0x20000
  s_mov_b32 s32, s6
  s_and_b32 s33, s7, 0xffff
  s_mov_b32 s34, 1204224
  s_mov_b32 s35, 0x20000
  s_mov_b32 s36, s14
  s_and_b32 s37, s15, 0xffff
  s_mov_b32 s38, 1605632
  s_mov_b32 s39, 0x20000
  s_mov_b32 s7, s94
  s_mov_b32 s44, s10
  s_and_b32 s45, s11, 0xffff
  s_mov_b32 s46, 401408
  s_mov_b32 s47, 0x20000
  s_mov_b32 s48, s26
  s_and_b32 s49, s27, 0xffff
  s_mov_b32 s50, 16121856
  s_mov_b32 s51, 0x20000
  s_mov_b32 s52, s22
  s_and_b32 s53, s23, 0xffff
  s_mov_b32 s54, 1835008
  s_mov_b32 s55, 0x20000
  s_mov_b32 s60, s24
  s_and_b32 s61, s25, 0xffff
  s_mov_b32 s62, 256
  s_mov_b32 s63, 0x20000
  v_cmp_eq_u32 s[4:5], 1, v3
  s_mov_b32 s6, 0xffff0000
  s_lshl_b32 s10, s73, 7
  s_mul_i32 s90, s70, 28672
  s_add_u32 s10, s10, s90
  s_mov_b32 s11, 229376
  s_lshl_b32 s12, s73, 2
  s_add_u32 s12, s12, 2
  s_mov_b32 s22, s7
  s_lshl_b32 s90, s68, 2
  s_add_u32 s90, s90, s71
  s_mul_i32 s15, s90, 114688
  s_add_u32 s15, s15, 4587520
  v_and_b32 v124, 7, v1
  v_lshrrev_b32 v125, 2, v1
  v_and_b32 v125, 4, v125
  v_xor_b32 v124, v124, v125
  v_lshlrev_b32 v124, 4, v124
  v_lshrrev_b32 v125, 3, v1
  s_movk_i32 s90, 3584
  v_mad_u32_u24 v7, v125, s90, v124
  v_lshlrev_b32 v124, 4, v1
  s_mul_i32 s90, s2, 6272
  s_lshl_b32 s91, s71, 10
  s_cmp_eq_u32 s71, 2
  s_cselect_b32 s91, 1152, s91
  s_add_u32 s90, s90, s91
  s_add_u32 s90, s90, 4096
  s_mul_i32 s92, s2, 1568
  s_cmp_eq_u32 s71, 3
  s_cbranch_scc1 L_mpw_66
  s_mov_b32 m0, 160000
  s_nop 0
  buffer_load_dwordx4 v124, s[40:43], s90 offen lds
  s_branch L_mpe_67
L_mpw_66:
  s_mov_b32 m0, 160000
  s_nop 0
  buffer_load_dwordx4 v124, s[44:47], s92 offen lds
  s_add_u32 s92, s92, 544
  s_mov_b32 m0, 160000
  s_nop 0
  buffer_load_dwordx4 v124, s[44:47], s92 offen lds
L_mpe_67:
  s_cmp_lg_u32 s71, 3
  s_cbranch_scc1 L_tlb_68
  v_lshlrev_b32 v124, 18, v1
  s_mov_b32 m0, 160000
  s_nop 0
  buffer_load_dwordx4 v124, s[48:51], 0 offen lds
  v_lshlrev_b32 v124, 15, v1
  s_mov_b32 m0, 160000
  s_nop 0
  buffer_load_dwordx4 v124, s[40:43], 0 offen lds
  v_lshlrev_b32 v124, 13, v1
  s_mov_b32 m0, 160000
  s_nop 0
  buffer_load_dwordx4 v124, s[44:47], 0 offen lds
  v_lshlrev_b32 v124, 15, v1
  s_mov_b32 m0, 160000
  s_nop 0
  buffer_load_dwordx4 v124, s[52:55], 0 offen lds
L_tlb_68:
  s_lshl_b32 s90, s71, 12
  v_lshrrev_b32 v124, 1, v2
  v_and_b32 v124, 7, v124
  v_xor_b32 v124, v124, v3
  v_lshlrev_b32 v124, 4, v124
  v_lshl_add_u32 v124, v2, 7, v124
  v_add_u32 v8, s90, v124
  v_xor_b32 v9, 32, v8
  v_xor_b32 v10, 64, v8
  v_xor_b32 v11, 96, v8
  v_lshrrev_b32 v124, 4, v1
  v_and_b32 v124, 1, v124
  v_lshlrev_b32 v124, 5, v124
  v_and_b32 v125, 3, v1
  v_lshl_add_u32 v124, v125, 3, v124
  v_add_u32 v124, 56, v124
  v_lshlrev_b32 v125, 3, v1
  v_and_b32 v125, 64, v125
  v_xor_b32 v124, v124, v125
  v_lshrrev_b32 v125, 2, v1
  v_and_b32 v125, 3, v125
  v_mad_u32_u24 v12, v3, 8, v125
  v_lshl_add_u32 v12, v12, 7, v124
  v_lshrrev_b32 v124, 4, v1
  v_and_b32 v124, 1, v124
  v_lshlrev_b32 v124, 5, v124
  v_and_b32 v125, 3, v1
  v_lshl_add_u32 v124, v125, 3, v124
  v_add_u32 v124, 64, v124
  v_lshlrev_b32 v125, 3, v1
  v_and_b32 v125, 64, v125
  v_xor_b32 v124, v124, v125
  v_lshrrev_b32 v125, 2, v1
  v_and_b32 v125, 3, v125
  v_mad_u32_u24 v15, v3, 8, v125
  v_lshl_add_u32 v15, v15, 7, v124
  v_mov_b32 v16, 0x3f803f80
  v_mov_b32 v17, 0x3f803f80
  s_mov_b32 s56, s36
  s_mov_b32 s57, s37
  s_mov_b32 s58, s38
  s_mov_b32 s59, s39
  s_lshl_b32 s90, s71, 12
  v_lshrrev_b32 v124, 2, v2
  v_and_b32 v124, 3, v124
  v_lshlrev_b32 v124, 1, v124
  v_and_b32 v125, 1, v2
  v_add_u32 v124, v124, v125
  v_xor_b32 v124, v124, v3
  v_lshlrev_b32 v124, 3, v124
  v_lshlrev_b32 v125, 5, v2
  v_and_b32 v125, 64, v125
  v_add_u32 v124, v124, v125
  v_lshl_add_u32 v124, v2, 7, v124
  v_add_u32 v124, s90, v124
  v_add_u32 v64, 49152, v124
  s_lshl_b32 s90, s71, 11
  v_lshrrev_b32 v65, 1, v2
  v_and_b32 v65, 7, v65
  v_xor_b32 v65, v65, v3
  v_lshlrev_b32 v65, 3, v65
  v_lshl_add_u32 v65, v2, 6, v65
  v_add_u32 v65, s90, v65
  v_add_u32 v65, 73728, v65
  v_lshrrev_b32 v124, 4, v1
  v_and_b32 v124, 1, v124
  v_and_b32 v125, 3, v1
  v_lshlrev_b32 v124, 2, v124
  v_add_u32 v124, v124, v125
  v_min_u32 v124, 6, v124
  v_lshlrev_b32 v124, 3, v124
  v_lshrrev_b32 v125, 2, v1
  v_and_b32 v125, 3, v125
  v_lshl_add_u32 v125, v3, 2, v125
  v_mul_u32_u24 v125, 56, v125
  v_add_u32 v124, v124, v125
  v_add_u32 v66, 149024, v124
  v_mov_b32 v125, 150208
  v_cndmask_b32 v67, v66, v125, s[4:5]
  v_lshrrev_b32 v120, 2, v1
  v_and_b32 v120, 4, v120
  v_and_b32 v124, 3, v1
  v_add_u32 v120, v120, v124
  v_lshrrev_b32 v121, 2, v1
  v_and_b32 v121, 3, v121
  v_lshlrev_b32 v124, 1, v3
  v_lshlrev_b32 v124, 1, v124
  v_and_b32 v125, 1, v121
  v_add_u32 v124, v124, v125
  v_xor_b32 v124, v124, v120
  v_lshlrev_b32 v124, 3, v124
  v_lshrrev_b32 v125, 1, v121
  v_xor_b32 v125, s71, v125
  v_lshl_add_u32 v124, v125, 6, v124
  v_lshl_add_u32 v125, v3, 3, v121
  v_lshl_add_u32 v26, v125, 7, v124
  v_add_u32 v26, 49152, v26
  v_lshrrev_b32 v124, 1, v121
  v_lshl_add_u32 v124, v3, 2, v124
  v_xor_b32 v124, v124, v120
  v_lshlrev_b32 v124, 3, v124
  v_lshl_add_u32 v28, v125, 6, v124
  v_add_u32 v28, 73728, v28
  v_lshlrev_b32 v124, 1, v3
  v_add_u32 v124, 1, v124
  v_lshlrev_b32 v124, 1, v124
  v_and_b32 v125, 1, v121
  v_add_u32 v124, v124, v125
  v_xor_b32 v124, v124, v120
  v_lshlrev_b32 v124, 3, v124
  v_lshrrev_b32 v125, 1, v121
  v_xor_b32 v125, s71, v125
  v_lshl_add_u32 v124, v125, 6, v124
  v_lshl_add_u32 v125, v3, 3, v121
  v_add_u32 v125, 4, v125
  v_lshl_add_u32 v27, v125, 7, v124
  v_add_u32 v27, 49152, v27
  v_lshrrev_b32 v124, 1, v121
  v_lshl_add_u32 v124, v3, 2, v124
  v_add_u32 v124, 2, v124
  v_xor_b32 v124, v124, v120
  v_lshlrev_b32 v124, 3, v124
  v_lshl_add_u32 v29, v125, 6, v124
  v_add_u32 v29, 73728, v29
  v_mov_b32 v116, 0
  v_mov_b32 v117, 0
  v_mov_b32 v118, 0
  v_mov_b32 v119, 0
  v_mov_b32 v120, 0
  v_mov_b32 v121, 0
  v_mov_b32 v122, 0
  v_mov_b32 v123, 0
  s_waitcnt vmcnt(6)
  s_barrier
  ds_read_b128 v[128:131], v8
  ds_read_b64_tr_b16 v[32:33], v12 offset:16384
  ds_read_b64_tr_b16 v[34:35], v12 offset:16896
  ds_read_b64_tr_b16 v[36:37], v12 offset:24576
  ds_read_b64_tr_b16 v[38:39], v12 offset:25088
  ds_read_b128 v[132:135], v9
  ds_read_b64_tr_b16 v[40:41], v12 offset:18432
  ds_read_b64_tr_b16 v[42:43], v12 offset:18944
  ds_read_b64_tr_b16 v[44:45], v12 offset:26624
  ds_read_b64_tr_b16 v[46:47], v12 offset:27136
  ds_read_b128 v[136:139], v10
  ds_read_b64_tr_b16 v[48:49], v12 offset:20480
  ds_read_b64_tr_b16 v[50:51], v12 offset:20992
  ds_read_b64_tr_b16 v[52:53], v12 offset:28672
  ds_read_b64_tr_b16 v[54:55], v12 offset:29184
  v_mov_b32 v124, 0
  buffer_load_dword v126, v124, s[60:63], 0 offen sc1
  s_waitcnt lgkmcnt(10)
  v_mfma_f32_32x32x16_bf16 v[68:83], v[32:35], v[128:131], 0
  ds_read_b128 v[140:143], v11
  ds_read_b64_tr_b16 v[56:57], v12 offset:22528
  ds_read_b64_tr_b16 v[58:59], v12 offset:23040
  v_mfma_f32_32x32x16_bf16 v[84:99], v[36:39], v[128:131], 0
  ds_read_b64_tr_b16 v[60:61], v12 offset:30720
  ds_read_b64_tr_b16 v[62:63], v12 offset:31232
  s_cmp_lg_u32 s75, 0
  s_cbranch_scc1 L_skip_69
  s_call_b64 s[96:97], L_DMA
  v_mfma_f32_4x4x4_16b_bf16 v[116:119], v[16:17], v[32:33], v[116:119]
  v_mfma_f32_4x4x4_16b_bf16 v[120:123], v[16:17], v[36:37], v[120:123]
  s_nop 0
  v_mfma_f32_4x4x4_16b_bf16 v[116:119], v[16:17], v[34:35], v[116:119]
  v_mfma_f32_4x4x4_16b_bf16 v[120:123], v[16:17], v[38:39], v[120:123]
L_skip_69:
  s_waitcnt lgkmcnt(10)
  v_mfma_f32_32x32x16_bf16 v[68:83], v[40:43], v[132:135], v[68:83]
  v_add_u32 v8, 32768, v8
  v_add_u32 v9, 32768, v9
  v_add_u32 v10, 32768, v10
  v_add_u32 v11, 32768, v11
  v_add_u32 v12, 32768, v12
  ds_read_b128 v[144:147], v8
  ds_read_b64_tr_b16 v[32:33], v12 offset:16384
  ds_read_b64_tr_b16 v[34:35], v12 offset:16896
  v_mfma_f32_32x32x16_bf16 v[84:99], v[44:47], v[132:135], v[84:99]
  ds_read_b64_tr_b16 v[36:37], v12 offset:24576
  ds_read_b64_tr_b16 v[38:39], v12 offset:25088
  s_cmp_lg_u32 s75, 1
  s_cbranch_scc1 L_skip_70
  s_call_b64 s[96:97], L_DMA
  v_mfma_f32_4x4x4_16b_bf16 v[116:119], v[16:17], v[40:41], v[116:119]
  v_mfma_f32_4x4x4_16b_bf16 v[120:123], v[16:17], v[44:45], v[120:123]
  s_nop 0
  v_mfma_f32_4x4x4_16b_bf16 v[116:119], v[16:17], v[42:43], v[116:119]
  v_mfma_f32_4x4x4_16b_bf16 v[120:123], v[16:17], v[46:47], v[120:123]
L_skip_70:
  s_waitcnt lgkmcnt(10)
  v_mfma_f32_32x32x16_bf16 v[68:83], v[48:51], v[136:139], v[68:83]
  ds_read_b128 v[148:151], v9
  ds_read_b64_tr_b16 v[40:41], v12 offset:18432
  ds_read_b64_tr_b16 v[42:43], v12 offset:18944
  v_mfma_f32_32x32x16_bf16 v[84:99], v[52:55], v[136:139], v[84:99]
  ds_read_b64_tr_b16 v[44:45], v12 offset:26624
  ds_read_b64_tr_b16 v[46:47], v12 offset:27136
  s_cmp_lg_u32 s75, 2
  s_cbranch_scc1 L_skip_71
  s_call_b64 s[96:97], L_DMA
  v_mfma_f32_4x4x4_16b_bf16 v[116:119], v[16:17], v[48:49], v[116:119]
  v_mfma_f32_4x4x4_16b_bf16 v[120:123], v[16:17], v[52:53], v[120:123]
  s_nop 0
  v_mfma_f32_4x4x4_16b_bf16 v[116:119], v[16:17], v[50:51], v[116:119]
  v_mfma_f32_4x4x4_16b_bf16 v[120:123], v[16:17], v[54:55], v[120:123]
L_skip_71:
  s_waitcnt lgkmcnt(10)
  v_mfma_f32_32x32x16_bf16 v[68:83], v[56:59], v[140:143], v[68:83]
  ds_read_b128 v[152:155], v10
  ds_read_b64_tr_b16 v[48:49], v12 offset:20480
  ds_read_b64_tr_b16 v[50:51], v12 offset:20992
  v_mfma_f32_32x32x16_bf16 v[84:99], v[60:63], v[140:143], v[84:99]
  ds_read_b64_tr_b16 v[52:53], v12 offset:28672
  ds_read_b64_tr_b16 v[54:55], v12 offset:29184
  s_cmp_lg_u32 s75, 3
  s_cbranch_scc1 L_skip_72
  s_call_b64 s[96:97], L_DMA
  v_mfma_f32_4x4x4_16b_bf16 v[116:119], v[16:17], v[56:57], v[116:119]
  v_mfma_f32_4x4x4_16b_bf16 v[120:123], v[16:17], v[60:61], v[120:123]
  s_nop 0
  v_mfma_f32_4x4x4_16b_bf16 v[116:119], v[16:17], v[58:59], v[116:119]
  v_mfma_f32_4x4x4_16b_bf16 v[120:123], v[16:17], v[62:63], v[120:123]
L_skip_72:
  s_waitcnt vmcnt(7)
  s_barrier
  s_waitcnt vmcnt(6)
  v_lshlrev_b32 v247, 16, v247
  v_cmp_gt_u32 vcc, 64, v244
  s_nop 0
  s_and_saveexec_b64 s[100:101], vcc
  s_cbranch_execz L_b1skip_73
  ds_write_b32 v246, v247
L_b1skip_73:
  s_mov_b64 exec, s[100:101]
  s_waitcnt lgkmcnt(10)
  v_mfma_f32_32x32x16_bf16 v[68:83], v[32:35], v[144:147], v[68:83]
  ds_read_b128 v[156:159], v11
  ds_read_b64_tr_b16 v[56:57], v12 offset:22528
  ds_read_b64_tr_b16 v[58:59], v12 offset:23040
  v_mfma_f32_32x32x16_bf16 v[84:99], v[36:39], v[144:147], v[84:99]
  ds_read_b64_tr_b16 v[60:61], v12 offset:30720
  ds_read_b64_tr_b16 v[62:63], v12 offset:31232
  s_waitcnt vmcnt(4)
  v_readfirstlane_b32 s74, v126
  s_nop 0
  s_cmp_lg_u32 s74, 0
  s_cbranch_scc1 L_tagok_74
  s_mov_b32 s95, 0
L_tagloop_75:
  v_mov_b32 v124, 0
  buffer_load_dword v125, v124, s[60:63], 0 offen sc1
  s_waitcnt vmcnt(0)
  v_readfirstlane_b32 s74, v125
  s_add_u32 s95, s95, 1
  s_cmp_lg_u32 s74, 0
  s_cbranch_scc1 L_tagok_74
  s_cmp_lt_u32 s95, 0x40000
  s_cbranch_scc1 L_tagloop_75
L_tagok_74:
  v_mov_b32 v22, 0
  v_mov_b32 v23, 0
  v_lshlrev_b32 v20, 16, v240
  v_and_b32 v21, s6, v240
  v_add_f32 v22, v22, v20
  v_fmac_f32 v23, v20, v20
  v_add_f32 v22, v22, v21
  v_fmac_f32 v23, v21, v21
  s_cmp_lg_u32 s75, 0
  s_cbranch_scc1 L_skip_76
  s_call_b64 s[96:97], L_DMA
  v_mfma_f32_4x4x4_16b_bf16 v[116:119], v[16:17], v[32:33], v[116:119]
  v_mfma_f32_4x4x4_16b_bf16 v[120:123], v[16:17], v[36:37], v[120:123]
  s_nop 0
  v_mfma_f32_4x4x4_16b_bf16 v[116:119], v[16:17], v[34:35], v[116:119]
  v_mfma_f32_4x4x4_16b_bf16 v[120:123], v[16:17], v[38:39], v[120:123]
L_skip_76:
  s_waitcnt lgkmcnt(10)
  v_mfma_f32_32x32x16_bf16 v[68:83], v[40:43], v[148:151], v[68:83]
  v_add_u32 v8, 32768, v8
  v_add_u32 v9, 32768, v9
  v_add_u32 v10, 32768, v10
  v_add_u32 v11, 32768, v11
  v_add_u32 v12, 32768, v12
  ds_read_b128 v[160:163], v8
  ds_read_b64_tr_b16 v[32:33], v12 offset:16384
  ds_read_b64_tr_b16 v[34:35], v12 offset:16896
  v_mfma_f32_32x32x16_bf16 v[84:99], v[44:47], v[148:151], v[84:99]
  ds_read_b64_tr_b16 v[36:37], v12 offset:24576
  ds_read_b64_tr_b16 v[38:39], v12 offset:25088
  v_lshlrev_b32 v20, 16, v241
  v_and_b32 v21, s6, v241
  v_add_f32 v22, v22, v20
  v_fmac_f32 v23, v20, v20
  v_add_f32 v22, v22, v21
  v_fmac_f32 v23, v21, v21
  v_lshlrev_b32 v20, 16, v242
  v_and_b32 v21, s6, v242
  v_add_f32 v22, v22, v20
  v_fmac_f32 v23, v20, v20
  v_add_f32 v22, v22, v21
  v_fmac_f32 v23, v21, v21
  s_cmp_lg_u32 s75, 1
  s_cbranch_scc1 L_skip_77
  s_call_b64 s[96:97], L_DMA
  v_mfma_f32_4x4x4_16b_bf16 v[116:119], v[16:17], v[40:41], v[116:119]
  v_mfma_f32_4x4x4_16b_bf16 v[120:123], v[16:17], v[44:45], v[120:123]
  s_nop 0
  v_mfma_f32_4x4x4_16b_bf16 v[116:119], v[16:17], v[42:43], v[116:119]
  v_mfma_f32_4x4x4_16b_bf16 v[120:123], v[16:17], v[46:47], v[120:123]
L_skip_77:
  s_waitcnt lgkmcnt(10)
  v_mfma_f32_32x32x16_bf16 v[68:83], v[48:51], v[152:155], v[68:83]
  ds_read_b128 v[164:167], v9
  ds_read_b64_tr_b16 v[40:41], v12 offset:18432
  ds_read_b64_tr_b16 v[42:43], v12 offset:18944
  v_mfma_f32_32x32x16_bf16 v[84:99], v[52:55], v[152:155], v[84:99]
  ds_read_b64_tr_b16 v[44:45], v12 offset:26624
  ds_read_b64_tr_b16 v[46:47], v12 offset:27136
  v_lshlrev_b32 v20, 16, v243
  v_and_b32 v21, s6, v243
  v_add_f32 v22, v22, v20
  v_fmac_f32 v23, v20, v20
  v_add_f32 v22, v22, v21
  v_fmac_f32 v23, v21, v21
  s_nop 0
  v_add_f32_dpp v22, v22, v22 quad_perm:[1,0,3,2] row_mask:0xf bank_mask:0xf
  v_add_f32_dpp v23, v23, v23 quad_perm:[1,0,3,2] row_mask:0xf bank_mask:0xf
  s_cmp_lg_u32 s75, 2
  s_cbranch_scc1 L_skip_78
  s_call_b64 s[96:97], L_DMA
  v_mfma_f32_4x4x4_16b_bf16 v[116:119], v[16:17], v[48:49], v[116:119]
  v_mfma_f32_4x4x4_16b_bf16 v[120:123], v[16:17], v[52:53], v[120:123]
  s_nop 0
  v_mfma_f32_4x4x4_16b_bf16 v[116:119], v[16:17], v[50:51], v[116:119]
  v_mfma_f32_4x4x4_16b_bf16 v[120:123], v[16:17], v[54:55], v[120:123]
L_skip_78:
  s_waitcnt lgkmcnt(10)
  v_mfma_f32_32x32x16_bf16 v[68:83], v[56:59], v[156:159], v[68:83]
  ds_read_b128 v[168:171], v10
  ds_read_b64_tr_b16 v[48:49], v12 offset:20480
  ds_read_b64_tr_b16 v[50:51], v12 offset:20992
  v_mfma_f32_32x32x16_bf16 v[84:99], v[60:63], v[156:159], v[84:99]
  ds_read_b64_tr_b16 v[52:53], v12 offset:28672
  ds_read_b64_tr_b16 v[54:55], v12 offset:29184
  v_add_f32_dpp v22, v22, v22 quad_perm:[2,3,0,1] row_mask:0xf bank_mask:0xf
  v_add_f32_dpp v23, v23, v23 quad_perm:[2,3,0,1] row_mask:0xf bank_mask:0xf
  s_nop 0
  v_add_f32_dpp v22, v22, v22 row_half_mirror row_mask:0xf bank_mask:0xf
  v_add_f32_dpp v23, v23, v23 row_half_mirror row_mask:0xf bank_mask:0xf
  s_cmp_lg_u32 s75, 3
  s_cbranch_scc1 L_skip_79
  s_call_b64 s[96:97], L_DMA
  v_mfma_f32_4x4x4_16b_bf16 v[116:119], v[16:17], v[56:57], v[116:119]
  v_mfma_f32_4x4x4_16b_bf16 v[120:123], v[16:17], v[60:61], v[120:123]
  s_nop 0
  v_mfma_f32_4x4x4_16b_bf16 v[116:119], v[16:17], v[58:59], v[116:119]
  v_mfma_f32_4x4x4_16b_bf16 v[120:123], v[16:17], v[62:63], v[120:123]
L_skip_79:
  s_waitcnt vmcnt(4)
  s_barrier
  s_waitcnt lgkmcnt(10)
  v_mfma_f32_32x32x16_bf16 v[68:83], v[32:35], v[160:163], v[68:83]
  ds_read_b128 v[172:175], v11
  ds_read_b64_tr_b16 v[56:57], v12 offset:22528
  ds_read_b64_tr_b16 v[58:59], v12 offset:23040
  v_mfma_f32_32x32x16_bf16 v[84:99], v[36:39], v[160:163], v[84:99]
  ds_read_b64_tr_b16 v[60:61], v12 offset:30720
  ds_read_b64_tr_b16 v[62:63], v12 offset:31232
  v_add_f32_dpp v22, v22, v22 row_mirror row_mask:0xf bank_mask:0xf
  v_add_f32_dpp v23, v23, v23 row_mirror row_mask:0xf bank_mask:0xf
  v_mov_b32 v20, v22
  s_nop 1
  v_permlane16_swap_b32 v22, v20
  v_add_f32 v22, v22, v20
  v_mov_b32 v20, v23
  s_nop 1
  v_permlane16_swap_b32 v23, v20
  v_add_f32 v23, v23, v20
  s_cmp_lg_u32 s75, 0
  s_cbranch_scc1 L_skip_80
  s_call_b64 s[96:97], L_DMA
  v_mfma_f32_4x4x4_16b_bf16 v[116:119], v[16:17], v[32:33], v[116:119]
  v_mfma_f32_4x4x4_16b_bf16 v[120:123], v[16:17], v[36:37], v[120:123]
  s_nop 0
  v_mfma_f32_4x4x4_16b_bf16 v[116:119], v[16:17], v[34:35], v[116:119]
  v_mfma_f32_4x4x4_16b_bf16 v[120:123], v[16:17], v[38:39], v[120:123]
L_skip_80:
  s_waitcnt lgkmcnt(10)
  v_mfma_f32_32x32x16_bf16 v[68:83], v[40:43], v[164:167], v[68:83]
  v_add_u32 v8, 32768, v8
  v_add_u32 v9, 32768, v9
  v_add_u32 v10, 32768, v10
  v_add_u32 v11, 32768, v11
  v_add_u32 v12, 32768, v12
  ds_read_b128 v[176:179], v8
  ds_read_b64_tr_b16 v[32:33], v12 offset:16384
  ds_read_b64_tr_b16 v[34:35], v12 offset:16896
  v_mfma_f32_32x32x16_bf16 v[84:99], v[44:47], v[164:167], v[84:99]
  ds_read_b64_tr_b16 v[36:37], v12 offset:24576
  ds_read_b64_tr_b16 v[38:39], v12 offset:25088
  v_mov_b32 v20, v22
  s_nop 1
  v_permlane32_swap_b32 v22, v20
  v_add_f32 v22, v22, v20
  v_mov_b32 v20, v23
  s_nop 1
  v_permlane32_swap_b32 v23, v20
  v_add_f32 v23, v23, v20
  v_mul_f32 v22, 0x3b124925, v22
  v_mul_f32 v23, 0x3b124925, v23
  v_fma_f32 v23, -v22, v22, v23
  v_max_f32 v23, 0, v23
  v_cvt_pk_bf16_f32 v23, v23, v23
  v_lshlrev_b32 v23, 16, v23
  v_add_f32 v23, 0x3727c5ac, v23
  v_cvt_pk_bf16_f32 v23, v23, v23
  v_lshlrev_b32 v23, 16, v23
  s_cmp_lg_u32 s75, 1
  s_cbranch_scc1 L_skip_81
  s_call_b64 s[96:97], L_DMA
  v_mfma_f32_4x4x4_16b_bf16 v[116:119], v[16:17], v[40:41], v[116:119]
  v_mfma_f32_4x4x4_16b_bf16 v[120:123], v[16:17], v[44:45], v[120:123]
  s_nop 0
  v_mfma_f32_4x4x4_16b_bf16 v[116:119], v[16:17], v[42:43], v[116:119]
  v_mfma_f32_4x4x4_16b_bf16 v[120:123], v[16:17], v[46:47], v[120:123]
L_skip_81:
  s_waitcnt lgkmcnt(10)
  v_mfma_f32_32x32x16_bf16 v[68:83], v[48:51], v[168:171], v[68:83]
  ds_read_b128 v[180:183], v9
  ds_read_b64_tr_b16 v[40:41], v12 offset:18432
  ds_read_b64_tr_b16 v[42:43], v12 offset:18944
  v_mfma_f32_32x32x16_bf16 v[84:99], v[52:55], v[168:171], v[84:99]
  ds_read_b64_tr_b16 v[44:45], v12 offset:26624
  ds_read_b64_tr_b16 v[46:47], v12 offset:27136
  v_sqrt_f32 v23, v23
  v_mov_b32 v20, 0
  v_mov_b32 v25, s74
  v_cvt_pk_bf16_f32 v24, v23, v22
  s_mov_b64 s[100:101], exec
  s_mov_b64 exec, 1
  buffer_store_dwordx2 v[24:25], v20, s[48:51], s3 offen sc1
  s_mov_b64 exec, s[100:101]
  s_cmp_lg_u32 s75, 2
  s_cbranch_scc1 L_skip_82
  s_call_b64 s[96:97], L_DMA
  v_mfma_f32_4x4x4_16b_bf16 v[116:119], v[16:17], v[48:49], v[116:119]
  v_mfma_f32_4x4x4_16b_bf16 v[120:123], v[16:17], v[52:53], v[120:123]
  s_nop 0
  v_mfma_f32_4x4x4_16b_bf16 v[116:119], v[16:17], v[50:51], v[116:119]
  v_mfma_f32_4x4x4_16b_bf16 v[120:123], v[16:17], v[54:55], v[120:123]
L_skip_82:
  s_waitcnt lgkmcnt(10)
  v_mfma_f32_32x32x16_bf16 v[68:83], v[56:59], v[172:175], v[68:83]
  ds_read_b128 v[184:187], v10
  ds_read_b64_tr_b16 v[48:49], v12 offset:20480
  ds_read_b64_tr_b16 v[50:51], v12 offset:20992
  v_mfma_f32_32x32x16_bf16 v[84:99], v[60:63], v[172:175], v[84:99]
  ds_read_b64_tr_b16 v[52:53], v12 offset:28672
  ds_read_b64_tr_b16 v[54:55], v12 offset:29184
  s_cmp_lg_u32 s75, 3
  s_cbranch_scc1 L_skip_83
  s_call_b64 s[96:97], L_DMA
  v_mfma_f32_4x4x4_16b_bf16 v[116:119], v[16:17], v[56:57], v[116:119]
  v_mfma_f32_4x4x4_16b_bf16 v[120:123], v[16:17], v[60:61], v[120:123]
  s_nop 0
  v_mfma_f32_4x4x4_16b_bf16 v[116:119], v[16:17], v[58:59], v[116:119]
  v_mfma_f32_4x4x4_16b_bf16 v[120:123], v[16:17], v[62:63], v[120:123]
L_skip_83:
  s_waitcnt vmcnt(4)
  s_barrier
  s_waitcnt lgkmcnt(10)
  v_mfma_f32_32x32x16_bf16 v[68:83], v[32:35], v[176:179], v[68:83]
  ds_read_b128 v[188:191], v11
  ds_read_b64_tr_b16 v[56:57], v12 offset:22528
  ds_read_b64_tr_b16 v[58:59], v12 offset:23040
  v_mfma_f32_32x32x16_bf16 v[84:99], v[36:39], v[176:179], v[84:99]
  ds_read_b64_tr_b16 v[60:61], v12 offset:30720
  ds_read_b64_tr_b16 v[62:63], v12 offset:31232
  s_cmp_lg_u32 s75, 0
  s_cbranch_scc1 L_skip_84
  s_call_b64 s[96:97], L_DMA
  v_mfma_f32_4x4x4_16b_bf16 v[116:119], v[16:17], v[32:33], v[116:119]
  v_mfma_f32_4x4x4_16b_bf16 v[120:123], v[16:17], v[36:37], v[120:123]
  s_nop 0
  v_mfma_f32_4x4x4_16b_bf16 v[116:119], v[16:17], v[34:35], v[116:119]
  v_mfma_f32_4x4x4_16b_bf16 v[120:123], v[16:17], v[38:39], v[120:123]
L_skip_84:
  s_waitcnt lgkmcnt(10)
  v_mfma_f32_32x32x16_bf16 v[68:83], v[40:43], v[180:183], v[68:83]
  v_subrev_u32 v8, 98304, v8
  v_subrev_u32 v9, 98304, v9
  v_subrev_u32 v10, 98304, v10
  v_subrev_u32 v11, 98304, v11
  v_subrev_u32 v12, 98304, v12
  ds_read_b128 v[192:195], v8
  ds_read_b64_tr_b16 v[32:33], v12 offset:16384
  ds_read_b64_tr_b16 v[34:35], v12 offset:16896
  v_mfma_f32_32x32x16_bf16 v[84:99], v[44:47], v[180:183], v[84:99]
  ds_read_b64_tr_b16 v[36:37], v12 offset:24576
  ds_read_b64_tr_b16 v[38:39], v12 offset:25088
  s_cmp_lg_u32 s75, 1
  s_cbranch_scc1 L_skip_85
  s_call_b64 s[96:97], L_DMA
  v_mfma_f32_4x4x4_16b_bf16 v[116:119], v[16:17], v[40:41], v[116:119]
  v_mfma_f32_4x4x4_16b_bf16 v[120:123], v[16:17], v[44:45], v[120:123]
  s_nop 0
  v_mfma_f32_4x4x4_16b_bf16 v[116:119], v[16:17], v[42:43], v[116:119]
  v_mfma_f32_4x4x4_16b_bf16 v[120:123], v[16:17], v[46:47], v[120:123]
L_skip_85:
  s_waitcnt lgkmcnt(10)
  v_mfma_f32_32x32x16_bf16 v[68:83], v[48:51], v[184:187], v[68:83]
  ds_read_b128 v[196:199], v9
  ds_read_b64_tr_b16 v[40:41], v12 offset:18432
  ds_read_b64_tr_b16 v[42:43], v12 offset:18944
  v_mfma_f32_32x32x16_bf16 v[84:99], v[52:55], v[184:187], v[84:99]
  ds_read_b64_tr_b16 v[44:45], v12 offset:26624
  ds_read_b64_tr_b16 v[46:47], v12 offset:27136
  s_cmp_lg_u32 s75, 2
  s_cbranch_scc1 L_skip_86
  s_call_b64 s[96:97], L_DMA
  v_mfma_f32_4x4x4_16b_bf16 v[116:119], v[16:17], v[48:49], v[116:119]
  v_mfma_f32_4x4x4_16b_bf16 v[120:123], v[16:17], v[52:53], v[120:123]
  s_nop 0
  v_mfma_f32_4x4x4_16b_bf16 v[116:119], v[16:17], v[50:51], v[116:119]
  v_mfma_f32_4x4x4_16b_bf16 v[120:123], v[16:17], v[54:55], v[120:123]
L_skip_86:
  s_waitcnt lgkmcnt(10)
  v_mfma_f32_32x32x16_bf16 v[68:83], v[56:59], v[188:191], v[68:83]
  ds_read_b128 v[200:203], v10
  ds_read_b64_tr_b16 v[48:49], v12 offset:20480
  ds_read_b64_tr_b16 v[50:51], v12 offset:20992
  v_mfma_f32_32x32x16_bf16 v[84:99], v[60:63], v[188:191], v[84:99]
  ds_read_b64_tr_b16 v[52:53], v12 offset:28672
  ds_read_b64_tr_b16 v[54:55], v12 offset:29184
  s_cmp_lg_u32 s75, 3
  s_cbranch_scc1 L_skip_87
  s_call_b64 s[96:97], L_DMA
  v_mfma_f32_4x4x4_16b_bf16 v[116:119], v[16:17], v[56:57], v[116:119]
  v_mfma_f32_4x4x4_16b_bf16 v[120:123], v[16:17], v[60:61], v[120:123]
  s_nop 0
  v_mfma_f32_4x4x4_16b_bf16 v[116:119], v[16:17], v[58:59], v[116:119]
  v_mfma_f32_4x4x4_16b_bf16 v[120:123], v[16:17], v[62:63], v[120:123]
L_skip_87:
  s_waitcnt vmcnt(4)
  s_barrier
  s_lshl_b32 s90, s68, 10
  s_lshl_b32 s91, s71, 8
  s_add_u32 s90, s90, s91
  s_add_u32 s3, s90, 184320
  v_lshlrev_b32 v24, 3, v2
  buffer_load_dwordx2 v[18:19], v24, s[48:51], s3 offen sc1
  s_mov_b32 s24, 4
  s_lshl_b32 s23, s70, 10
  s_add_u32 s23, s23, 98304
  s_waitcnt lgkmcnt(10)
  v_mfma_f32_32x32x16_bf16 v[68:83], v[32:35], v[192:195], v[68:83]
  ds_read_b128 v[204:207], v11
  ds_read_b64_tr_b16 v[56:57], v12 offset:22528
  ds_read_b64_tr_b16 v[58:59], v12 offset:23040
  v_mfma_f32_32x32x16_bf16 v[84:99], v[36:39], v[192:195], v[84:99]
  ds_read_b64_tr_b16 v[60:61], v12 offset:30720
  ds_read_b64_tr_b16 v[62:63], v12 offset:31232
  s_cmp_lg_u32 s75, 0
  s_cbranch_scc1 L_skip_88
  s_call_b64 s[96:97], L_DMA2
  v_mfma_f32_4x4x4_16b_bf16 v[116:119], v[16:17], v[32:33], v[116:119]
  v_mfma_f32_4x4x4_16b_bf16 v[120:123], v[16:17], v[36:37], v[120:123]
  s_nop 0
  v_mfma_f32_4x4x4_16b_bf16 v[116:119], v[16:17], v[34:35], v[116:119]
  v_mfma_f32_4x4x4_16b_bf16 v[120:123], v[16:17], v[38:39], v[120:123]
L_skip_88:
  s_waitcnt lgkmcnt(10)
  v_mfma_f32_32x32x16_bf16 v[68:83], v[40:43], v[196:199], v[68:83]
  v_add_u32 v8, 32768, v8
  v_add_u32 v9, 32768, v9
  v_add_u32 v10, 32768, v10
  v_add_u32 v11, 32768, v11
  v_add_u32 v12, 32768, v12
  ds_read_b128 v[208:211], v8
  ds_read_b64_tr_b16 v[32:33], v12 offset:16384
  ds_read_b64_tr_b16 v[34:35], v12 offset:16896
  v_mfma_f32_32x32x16_bf16 v[84:99], v[44:47], v[196:199], v[84:99]
  ds_read_b64_tr_b16 v[36:37], v12 offset:24576
  ds_read_b64_tr_b16 v[38:39], v12 offset:25088
  s_cmp_lg_u32 s75, 1
  s_cbranch_scc1 L_skip_89
  s_call_b64 s[96:97], L_DMA2
  v_mfma_f32_4x4x4_16b_bf16 v[116:119], v[16:17], v[40:41], v[116:119]
  v_mfma_f32_4x4x4_16b_bf16 v[120:123], v[16:17], v[44:45], v[120:123]
  s_nop 0
  v_mfma_f32_4x4x4_16b_bf16 v[116:119], v[16:17], v[42:43], v[116:119]
  v_mfma_f32_4x4x4_16b_bf16 v[120:123], v[16:17], v[46:47], v[120:123]
L_skip_89:
  s_waitcnt lgkmcnt(10)
  v_mfma_f32_32x32x16_bf16 v[68:83], v[48:51], v[200:203], v[68:83]
  ds_read_b128 v[212:215], v9
  ds_read_b64_tr_b16 v[40:41], v12 offset:18432
  ds_read_b64_tr_b16 v[42:43], v12 offset:18944
  v_mfma_f32_32x32x16_bf16 v[84:99], v[52:55], v[200:203], v[84:99]
  ds_read_b64_tr_b16 v[44:45], v12 offset:26624
  ds_read_b64_tr_b16 v[46:47], v12 offset:27136
  s_cmp_lg_u32 s75, 2
  s_cbranch_scc1 L_skip_90
  s_call_b64 s[96:97], L_DMA2
  v_mfma_f32_4x4x4_16b_bf16 v[116:119], v[16:17], v[48:49], v[116:119]
  v_mfma_f32_4x4x4_16b_bf16 v[120:123], v[16:17], v[52:53], v[120:123]
  s_nop 0
  v_mfma_f32_4x4x4_16b_bf16 v[116:119], v[16:17], v[50:51], v[116:119]
  v_mfma_f32_4x4x4_16b_bf16 v[120:123], v[16:17], v[54:55], v[120:123]
L_skip_90:
  s_waitcnt lgkmcnt(10)
  v_mfma_f32_32x32x16_bf16 v[68:83], v[56:59], v[204:207], v[68:83]
  ds_read_b128 v[216:219], v10
  ds_read_b64_tr_b16 v[48:49], v12 offset:20480
  ds_read_b64_tr_b16 v[50:51], v12 offset:20992
  v_mfma_f32_32x32x16_bf16 v[84:99], v[60:63], v[204:207], v[84:99]
  ds_read_b64_tr_b16 v[52:53], v12 offset:28672
  ds_read_b64_tr_b16 v[54:55], v12 offset:29184
  s_cmp_lg_u32 s75, 3
  s_cbranch_scc1 L_skip_91
  s_call_b64 s[96:97], L_DMA2
  v_mfma_f32_4x4x4_16b_bf16 v[116:119], v[16:17], v[56:57], v[116:119]
  v_mfma_f32_4x4x4_16b_bf16 v[120:123], v[16:17], v[60:61], v[120:123]
  s_nop 0
  v_mfma_f32_4x4x4_16b_bf16 v[116:119], v[16:17], v[58:59], v[116:119]
  v_mfma_f32_4x4x4_16b_bf16 v[120:123], v[16:17], v[62:63], v[120:123]
L_skip_91:
  s_waitcnt vmcnt(5)
  s_barrier
  s_mov_b32 s24, 3
  s_lshl_b32 s23, s70, 10
  s_waitcnt lgkmcnt(10)
  v_mfma_f32_32x32x16_bf16 v[68:83], v[32:35], v[208:211], v[68:83]
  ds_read_b128 v[220:223], v11
  ds_read_b64_tr_b16 v[56:57], v12 offset:22528
  ds_read_b64_tr_b16 v[58:59], v12 offset:23040
  v_mfma_f32_32x32x16_bf16 v[84:99], v[36:39], v[208:211], v[84:99]
  ds_read_b64_tr_b16 v[60:61], v12 offset:30720
  ds_read_b64_tr_b16 v[62:63], v12 offset:31232
  s_cmp_lg_u32 s75, 0
  s_cbranch_scc1 L_skip_92
  s_call_b64 s[96:97], L_DMA2
  v_mfma_f32_4x4x4_16b_bf16 v[116:119], v[16:17], v[32:33], v[116:119]
  v_mfma_f32_4x4x4_16b_bf16 v[120:123], v[16:17], v[36:37], v[120:123]
  s_nop 0
  v_mfma_f32_4x4x4_16b_bf16 v[116:119], v[16:17], v[34:35], v[116:119]
  v_mfma_f32_4x4x4_16b_bf16 v[120:123], v[16:17], v[38:39], v[120:123]
L_skip_92:
  s_waitcnt lgkmcnt(10)
  v_mfma_f32_32x32x16_bf16 v[68:83], v[40:43], v[212:215], v[68:83]
  v_add_u32 v8, 32768, v8
  v_add_u32 v9, 32768, v9
  v_add_u32 v10, 32768, v10
  v_add_u32 v11, 32768, v11
  v_add_u32 v12, 32768, v12
  ds_read_b128 v[224:227], v8
  ds_read_b64_tr_b16 v[32:33], v12 offset:16384
  ds_read_b64_tr_b16 v[34:35], v12 offset:16896
  v_mfma_f32_32x32x16_bf16 v[84:99], v[44:47], v[212:215], v[84:99]
  ds_read_b64_tr_b16 v[36:37], v12 offset:24576
  ds_read_b64_tr_b16 v[38:39], v12 offset:25088
  s_cmp_lg_u32 s75, 1
  s_cbranch_scc1 L_skip_93
  s_call_b64 s[96:97], L_DMA2
  v_mfma_f32_4x4x4_16b_bf16 v[116:119], v[16:17], v[40:41], v[116:119]
  v_mfma_f32_4x4x4_16b_bf16 v[120:123], v[16:17], v[44:45], v[120:123]
  s_nop 0
  v_mfma_f32_4x4x4_16b_bf16 v[116:119], v[16:17], v[42:43], v[116:119]
  v_mfma_f32_4x4x4_16b_bf16 v[120:123], v[16:17], v[46:47], v[120:123]
L_skip_93:
  s_waitcnt lgkmcnt(10)
  v_mfma_f32_32x32x16_bf16 v[68:83], v[48:51], v[216:219], v[68:83]
  ds_read_b128 v[228:231], v9
  ds_read_b64_tr_b16 v[40:41], v12 offset:18432
  ds_read_b64_tr_b16 v[42:43], v12 offset:18944
  v_mfma_f32_32x32x16_bf16 v[84:99], v[52:55], v[216:219], v[84:99]
  ds_read_b64_tr_b16 v[44:45], v12 offset:26624
  ds_read_b64_tr_b16 v[46:47], v12 offset:27136
  s_cmp_lg_u32 s75, 2
  s_cbranch_scc1 L_skip_94
  s_call_b64 s[96:97], L_DMA2
  v_mfma_f32_4x4x4_16b_bf16 v[116:119], v[16:17], v[48:49], v[116:119]
  v_mfma_f32_4x4x4_16b_bf16 v[120:123], v[16:17], v[52:53], v[120:123]
  s_nop 0
  v_mfma_f32_4x4x4_16b_bf16 v[116:119], v[16:17], v[50:51], v[116:119]
  v_mfma_f32_4x4x4_16b_bf16 v[120:123], v[16:17], v[54:55], v[120:123]
L_skip_94:
  s_waitcnt lgkmcnt(10)
  v_mfma_f32_32x32x16_bf16 v[68:83], v[56:59], v[220:223], v[68:83]
  ds_read_b128 v[232:235], v10
  ds_read_b64_tr_b16 v[48:49], v12 offset:20480
  ds_read_b64_tr_b16 v[50:51], v12 offset:20992
  v_mfma_f32_32x32x16_bf16 v[84:99], v[60:63], v[220:223], v[84:99]
  ds_read_b64_tr_b16 v[52:53], v12 offset:28672
  ds_read_b64_tr_b16 v[54:55], v12 offset:29184
  s_cmp_lg_u32 s75, 3
  s_cbranch_scc1 L_skip_95
  s_call_b64 s[96:97], L_DMA2
  v_mfma_f32_4x4x4_16b_bf16 v[116:119], v[16:17], v[56:57], v[116:119]
  v_mfma_f32_4x4x4_16b_bf16 v[120:123], v[16:17], v[60:61], v[120:123]
  s_nop 0
  v_mfma_f32_4x4x4_16b_bf16 v[116:119], v[16:17], v[58:59], v[116:119]
  v_mfma_f32_4x4x4_16b_bf16 v[120:123], v[16:17], v[62:63], v[120:123]
L_skip_95:
  s_barrier
  s_waitcnt lgkmcnt(10)
  v_mfma_f32_32x32x16_bf16 v[68:83], v[32:35], v[224:227], v[68:83]
  ds_read_b128 v[236:239], v11
  ds_read_b64_tr_b16 v[56:57], v12 offset:22528
  ds_read_b64_tr_b16 v[58:59], v12 offset:23040
  v_mfma_f32_32x32x16_bf16 v[84:99], v[36:39], v[224:227], v[84:99]
  ds_read_b64_tr_b16 v[60:61], v12 offset:30720
  ds_read_b64_tr_b16 v[62:63], v12 offset:31232
  s_cmp_lg_u32 s75, 0
  s_cbranch_scc1 L_skip_96
  v_mfma_f32_4x4x4_16b_bf16 v[116:119], v[16:17], v[32:33], v[116:119]
  v_mfma_f32_4x4x4_16b_bf16 v[120:123], v[16:17], v[36:37], v[120:123]
  s_nop 0
  v_mfma_f32_4x4x4_16b_bf16 v[116:119], v[16:17], v[34:35], v[116:119]
  v_mfma_f32_4x4x4_16b_bf16 v[120:123], v[16:17], v[38:39], v[120:123]
L_skip_96:
  s_waitcnt lgkmcnt(10)
  v_mfma_f32_32x32x16_bf16 v[68:83], v[40:43], v[228:231], v[68:83]
  v_mfma_f32_32x32x16_bf16 v[84:99], v[44:47], v[228:231], v[84:99]
  s_cmp_lg_u32 s75, 1
  s_cbranch_scc1 L_skip_97
  v_mfma_f32_4x4x4_16b_bf16 v[116:119], v[16:17], v[40:41], v[116:119]
  v_mfma_f32_4x4x4_16b_bf16 v[120:123], v[16:17], v[44:45], v[120:123]
  s_nop 0
  v_mfma_f32_4x4x4_16b_bf16 v[116:119], v[16:17], v[42:43], v[116:119]
  v_mfma_f32_4x4x4_16b_bf16 v[120:123], v[16:17], v[46:47], v[120:123]
L_skip_97:
  s_waitcnt lgkmcnt(5)
  v_mfma_f32_32x32x16_bf16 v[68:83], v[48:51], v[232:235], v[68:83]
  v_mfma_f32_32x32x16_bf16 v[84:99], v[52:55], v[232:235], v[84:99]
  s_cmp_lg_u32 s75, 2
  s_cbranch_scc1 L_skip_98
  v_mfma_f32_4x4x4_16b_bf16 v[116:119], v[16:17], v[48:49], v[116:119]
  v_mfma_f32_4x4x4_16b_bf16 v[120:123], v[16:17], v[52:53], v[120:123]
  s_nop 0
  v_mfma_f32_4x4x4_16b_bf16 v[116:119], v[16:17], v[50:51], v[116:119]
  v_mfma_f32_4x4x4_16b_bf16 v[120:123], v[16:17], v[54:55], v[120:123]
L_skip_98:
  s_waitcnt lgkmcnt(0)
  v_mfma_f32_32x32x16_bf16 v[68:83], v[56:59], v[236:239], v[68:83]
  v_mfma_f32_32x32x16_bf16 v[84:99], v[60:63], v[236:239], v[84:99]
  s_cmp_lg_u32 s75, 3
  s_cbranch_scc1 L_skip_99
  v_mfma_f32_4x4x4_16b_bf16 v[116:119], v[16:17], v[56:57], v[116:119]
  v_mfma_f32_4x4x4_16b_bf16 v[120:123], v[16:17], v[60:61], v[120:123]
  s_nop 0
  v_mfma_f32_4x4x4_16b_bf16 v[116:119], v[16:17], v[58:59], v[116:119]
  v_mfma_f32_4x4x4_16b_bf16 v[120:123], v[16:17], v[62:63], v[120:123]
L_skip_99:
  s_nop 4
  s_lshl_b32 s90, s71, 2
  v_lshlrev_b32 v125, 4, v2
  v_add_u32 v125, s90, v125
  v_add_u32 v125, 152320, v125
  v_mov_b32 v124, v116
  s_nop 1
  v_permlane32_swap_b32 v116, v124
  v_add_f32 v116, v116, v124
  ds_write_b32 v125, v116 offset:512
  v_mov_b32 v124, v120
  s_nop 1
  v_permlane32_swap_b32 v120, v124
  v_add_f32 v120, v120, v124
  ds_write_b32 v125, v120 offset:1536
  s_waitcnt lgkmcnt(0)
  s_waitcnt vmcnt(0)
  s_barrier
  s_mul_i32 s90, s70, 384
  v_lshlrev_b32 v8, 4, v3
  v_add_u32 v8, s90, v8
  v_add_u32 v8, 155904, v8
  v_lshlrev_b32 v125, 4, v2
  v_add_u32 v125, 152320, v125
  ds_read_b128 v[116:119], v125 offset:512
  ds_read_b128 v[120:123], v125 offset:1536
  s_mul_i32 s90, s70, 384
  v_lshlrev_b32 v124, 2, v2
  v_add_u32 v124, s90, v124
  v_add_u32 v124, 155904, v124
  s_waitcnt lgkmcnt(1)
  v_add_f32 v116, v116, v117
  v_add_f32 v118, v118, v119
  v_add_f32 v116, v116, v118
  ds_write_b32 v124, v116 offset:0
  s_waitcnt lgkmcnt(1)
  v_add_f32 v120, v120, v121
  v_add_f32 v122, v122, v123
  v_add_f32 v120, v120, v122
  ds_write_b32 v124, v120 offset:128
  s_waitcnt lgkmcnt(0)
  ds_read_b128 v[100:103], v8 offset:128
  ds_read_b128 v[104:107], v8 offset:160
  ds_read_b128 v[108:111], v8 offset:192
  ds_read_b128 v[112:115], v8 offset:224
  ds_read_b128 v[32:35], v8 offset:0
  ds_read_b128 v[36:39], v8 offset:32
  ds_read_b128 v[40:43], v8 offset:64
  ds_read_b128 v[44:47], v8 offset:96
  ds_read_b64_tr_b16 v[56:57], v66
  ds_read_b64_tr_b16 v[58:59], v66 offset:448
  ds_read_b64_tr_b16 v[60:61], v66 offset:896
  ds_read_b64_tr_b16 v[62:63], v67 offset:1344
  s_mov_b32 s95, 0
L_gr_100:
  v_cmp_ne_u32 vcc, s74, v19
  s_add_u32 s95, s95, 1
  s_cmp_eq_u64 vcc, 0
  s_cbranch_scc1 L_grdone_101
  buffer_load_dwordx2 v[18:19], v24, s[48:51], s3 offen sc1
  s_waitcnt vmcnt(0)
  s_cmp_lt_u32 s95, 0x20000
  s_cbranch_scc1 L_gr_100
L_grdone_101:
  v_and_b32 v30, s6, v18
  v_lshlrev_b32 v124, 16, v18
  v_xor_b32 v30, 0x80000000, v30
  v_rcp_f32 v31, v124
  s_waitcnt lgkmcnt(8)
  v_pk_fma_f32 v[84:85], v[100:101], v[30:31], v[84:85] op_sel:[0,0,0] op_sel_hi:[1,0,1]
  v_pk_fma_f32 v[86:87], v[102:103], v[30:31], v[86:87] op_sel:[0,0,0] op_sel_hi:[1,0,1]
  v_pk_fma_f32 v[88:89], v[104:105], v[30:31], v[88:89] op_sel:[0,0,0] op_sel_hi:[1,0,1]
  v_pk_fma_f32 v[90:91], v[106:107], v[30:31], v[90:91] op_sel:[0,0,0] op_sel_hi:[1,0,1]
  v_pk_fma_f32 v[92:93], v[108:109], v[30:31], v[92:93] op_sel:[0,0,0] op_sel_hi:[1,0,1]
  v_pk_fma_f32 v[94:95], v[110:111], v[30:31], v[94:95] op_sel:[0,0,0] op_sel_hi:[1,0,1]
  v_pk_fma_f32 v[96:97], v[112:113], v[30:31], v[96:97] op_sel:[0,0,0] op_sel_hi:[1,0,1]
  v_pk_fma_f32 v[98:99], v[114:115], v[30:31], v[98:99] op_sel:[0,0,0] op_sel_hi:[1,0,1]
  v_pk_mul_f32 v[84:85], v[84:85], v[30:31] op_sel:[0,1] op_sel_hi:[1,1]
  v_pk_mul_f32 v[86:87], v[86:87], v[30:31] op_sel:[0,1] op_sel_hi:[1,1]
  v_pk_mul_f32 v[88:89], v[88:89], v[30:31] op_sel:[0,1] op_sel_hi:[1,1]
  v_pk_mul_f32 v[90:91], v[90:91], v[30:31] op_sel:[0,1] op_sel_hi:[1,1]
  v_pk_mul_f32 v[92:93], v[92:93], v[30:31] op_sel:[0,1] op_sel_hi:[1,1]
  v_pk_mul_f32 v[94:95], v[94:95], v[30:31] op_sel:[0,1] op_sel_hi:[1,1]
  v_pk_mul_f32 v[96:97], v[96:97], v[30:31] op_sel:[0,1] op_sel_hi:[1,1]
  v_pk_mul_f32 v[98:99], v[98:99], v[30:31] op_sel:[0,1] op_sel_hi:[1,1]
  v_cvt_pk_bf16_f32 v100, v84, v85
  v_cvt_pk_bf16_f32 v101, v86, v87
  v_cvt_pk_bf16_f32 v102, v88, v89
  v_cvt_pk_bf16_f32 v103, v90, v91
  v_cvt_pk_bf16_f32 v104, v92, v93
  v_cvt_pk_bf16_f32 v105, v94, v95
  v_cvt_pk_bf16_f32 v106, v96, v97
  v_cvt_pk_bf16_f32 v107, v98, v99
  v_mov_b32 v124, 0x00003f80
  v_cndmask_b32 v106, v106, v124, s[4:5]
  v_mov_b32 v125, 0
  v_cndmask_b32 v107, v107, v125, s[4:5]
  ds_write_b64 v65, v[100:101]
  v_xor_b32 v11, 16, v65
  ds_write_b64 v11, v[102:103]
  v_xor_b32 v11, 32, v65
  ds_write_b64 v11, v[104:105]
  v_xor_b32 v11, 48, v65
  ds_write_b64 v11, v[106:107]
  s_waitcnt lgkmcnt(8)
  v_pk_fma_f32 v[68:69], v[32:33], v[30:31], v[68:69] op_sel:[0,0,0] op_sel_hi:[1,0,1]
  v_pk_fma_f32 v[70:71], v[34:35], v[30:31], v[70:71] op_sel:[0,0,0] op_sel_hi:[1,0,1]
  v_pk_fma_f32 v[72:73], v[36:37], v[30:31], v[72:73] op_sel:[0,0,0] op_sel_hi:[1,0,1]
  v_pk_fma_f32 v[74:75], v[38:39], v[30:31], v[74:75] op_sel:[0,0,0] op_sel_hi:[1,0,1]
  v_pk_fma_f32 v[76:77], v[40:41], v[30:31], v[76:77] op_sel:[0,0,0] op_sel_hi:[1,0,1]
  v_pk_fma_f32 v[78:79], v[42:43], v[30:31], v[78:79] op_sel:[0,0,0] op_sel_hi:[1,0,1]
  v_pk_fma_f32 v[80:81], v[44:45], v[30:31], v[80:81] op_sel:[0,0,0] op_sel_hi:[1,0,1]
  v_pk_fma_f32 v[82:83], v[46:47], v[30:31], v[82:83] op_sel:[0,0,0] op_sel_hi:[1,0,1]
  v_cvt_pk_bf16_f32 v48, v68, v69
  v_cvt_pk_bf16_f32 v49, v70, v71
  v_cvt_pk_bf16_f32 v50, v72, v73
  v_cvt_pk_bf16_f32 v51, v74, v75
  v_cvt_pk_bf16_f32 v52, v76, v77
  v_cvt_pk_bf16_f32 v53, v78, v79
  v_cvt_pk_bf16_f32 v54, v80, v81
  v_cvt_pk_bf16_f32 v55, v82, v83
  s_waitcnt lgkmcnt(4)
  v_mfma_f32_32x32x16_bf16 v[68:83], v[56:59], v[48:51], 0
  v_mfma_f32_32x32x16_bf16 v[68:83], v[60:63], v[52:55], v[68:83]
  v_mul_f32 v116, 0x3fb8aa3b, v31
  s_nop 10
  v_max3_f32 v22, v68, v69, v70
  v_min3_f32 v23, v68, v69, v70
  v_max3_f32 v22, v22, v71, v72
  v_min3_f32 v23, v23, v71, v72
  v_max3_f32 v22, v22, v73, v74
  v_min3_f32 v23, v23, v73, v74
  v_max3_f32 v22, v22, v75, v76
  v_min3_f32 v23, v23, v75, v76
  v_max3_f32 v22, v22, v77, v78
  v_min3_f32 v23, v23, v77, v78
  v_max3_f32 v22, v22, v79, v80
  v_min3_f32 v23, v23, v79, v80
  v_max3_f32 v22, v22, v81, v82
  v_min3_f32 v23, v23, v81, v82
  v_max_f32 v22, v22, v83
  v_min_f32 v23, v23, v83
  v_mov_b32 v24, v22
  s_nop 1
  v_permlane32_swap_b32 v22, v24
  v_max_f32 v22, v22, v24
  v_mov_b32 v24, v23
  s_nop 1
  v_permlane32_swap_b32 v23, v24
  v_min_f32 v23, v23, v24
  v_mul_f32 v118, -v22, v116
  v_mul_f32 v119, v23, v116
  v_pk_fma_f32 v[32:33], v[68:69], v[116:117], v[118:119] op_sel:[0,0,0] op_sel_hi:[1,0,0]
  v_pk_fma_f32 v[48:49], v[68:69], v[116:117], v[118:119] op_sel:[0,0,1] op_sel_hi:[1,0,1] neg_lo:[0,1,0] neg_hi:[0,1,0]
  v_pk_fma_f32 v[34:35], v[70:71], v[116:117], v[118:119] op_sel:[0,0,0] op_sel_hi:[1,0,0]
  v_pk_fma_f32 v[50:51], v[70:71], v[116:117], v[118:119] op_sel:[0,0,1] op_sel_hi:[1,0,1] neg_lo:[0,1,0] neg_hi:[0,1,0]
  v_pk_fma_f32 v[36:37], v[72:73], v[116:117], v[118:119] op_sel:[0,0,0] op_sel_hi:[1,0,0]
  v_pk_fma_f32 v[52:53], v[72:73], v[116:117], v[118:119] op_sel:[0,0,1] op_sel_hi:[1,0,1] neg_lo:[0,1,0] neg_hi:[0,1,0]
  v_pk_fma_f32 v[38:39], v[74:75], v[116:117], v[118:119] op_sel:[0,0,0] op_sel_hi:[1,0,0]
  v_pk_fma_f32 v[54:55], v[74:75], v[116:117], v[118:119] op_sel:[0,0,1] op_sel_hi:[1,0,1] neg_lo:[0,1,0] neg_hi:[0,1,0]
  v_pk_fma_f32 v[40:41], v[76:77], v[116:117], v[118:119] op_sel:[0,0,0] op_sel_hi:[1,0,0]
  v_pk_fma_f32 v[56:57], v[76:77], v[116:117], v[118:119] op_sel:[0,0,1] op_sel_hi:[1,0,1] neg_lo:[0,1,0] neg_hi:[0,1,0]
  v_pk_fma_f32 v[42:43], v[78:79], v[116:117], v[118:119] op_sel:[0,0,0] op_sel_hi:[1,0,0]
  v_pk_fma_f32 v[58:59], v[78:79], v[116:117], v[118:119] op_sel:[0,0,1] op_sel_hi:[1,0,1] neg_lo:[0,1,0] neg_hi:[0,1,0]
  v_pk_fma_f32 v[44:45], v[80:81], v[116:117], v[118:119] op_sel:[0,0,0] op_sel_hi:[1,0,0]
  v_pk_fma_f32 v[60:61], v[80:81], v[116:117], v[118:119] op_sel:[0,0,1] op_sel_hi:[1,0,1] neg_lo:[0,1,0] neg_hi:[0,1,0]
  v_pk_fma_f32 v[46:47], v[82:83], v[116:117], v[118:119] op_sel:[0,0,0] op_sel_hi:[1,0,0]
  v_pk_fma_f32 v[62:63], v[82:83], v[116:117], v[118:119] op_sel:[0,0,1] op_sel_hi:[1,0,1] neg_lo:[0,1,0] neg_hi:[0,1,0]
  v_exp_f32 v32, v32
  v_exp_f32 v48, v48
  v_exp_f32 v33, v33
  v_exp_f32 v49, v49
  v_exp_f32 v34, v34
  v_exp_f32 v50, v50
  v_exp_f32 v35, v35
  v_exp_f32 v51, v51
  v_exp_f32 v36, v36
  v_exp_f32 v52, v52
  v_exp_f32 v37, v37
  v_exp_f32 v53, v53
  v_exp_f32 v38, v38
  v_exp_f32 v54, v54
  v_exp_f32 v39, v39
  v_exp_f32 v55, v55
  v_exp_f32 v40, v40
  v_exp_f32 v56, v56
  v_exp_f32 v41, v41
  v_exp_f32 v57, v57
  v_exp_f32 v42, v42
  v_exp_f32 v58, v58
  v_exp_f32 v43, v43
  v_exp_f32 v59, v59
  v_exp_f32 v44, v44
  v_exp_f32 v60, v60
  v_exp_f32 v45, v45
  v_exp_f32 v61, v61
  v_exp_f32 v46, v46
  v_exp_f32 v62, v62
  v_exp_f32 v47, v47
  v_exp_f32 v63, v63
  v_cndmask_b32 v125, 1.0, 0, s[4:5]
  v_pk_add_f32 v[68:69], v[32:33], v[34:35]
  v_pk_add_f32 v[70:71], v[44:45], v[46:47]
  v_pk_add_f32 v[68:69], v[68:69], v[36:37]
  v_pk_add_f32 v[68:69], v[68:69], v[38:39]
  v_pk_add_f32 v[68:69], v[68:69], v[40:41]
  v_pk_add_f32 v[68:69], v[68:69], v[42:43]
  v_add_f32 v70, v70, v71
  v_add_f32 v120, v68, v69
  v_fmac_f32 v120, v70, v125
  v_pk_add_f32 v[72:73], v[48:49], v[50:51]
  v_pk_add_f32 v[74:75], v[60:61], v[62:63]
  v_pk_add_f32 v[72:73], v[72:73], v[52:53]
  v_pk_add_f32 v[72:73], v[72:73], v[54:55]
  v_pk_add_f32 v[72:73], v[72:73], v[56:57]
  v_pk_add_f32 v[72:73], v[72:73], v[58:59]
  v_add_f32 v74, v74, v75
  v_add_f32 v121, v72, v73
  v_fmac_f32 v121, v74, v125
  v_mov_b32 v24, v120
  s_nop 1
  v_permlane32_swap_b32 v120, v24
  v_add_f32 v120, v120, v24
  v_mov_b32 v24, v121
  s_nop 1
  v_permlane32_swap_b32 v121, v24
  v_add_f32 v121, v121, v24
  v_rcp_f32 v120, v120
  v_rcp_f32 v121, v121
  s_nop 0
  v_pk_mul_f32 v[32:33], v[32:33], v[120:121] op_sel:[0,0] op_sel_hi:[1,0]
  v_pk_mul_f32 v[48:49], v[48:49], v[120:121] op_sel:[0,1] op_sel_hi:[1,1]
  v_pk_mul_f32 v[34:35], v[34:35], v[120:121] op_sel:[0,0] op_sel_hi:[1,0]
  v_pk_mul_f32 v[50:51], v[50:51], v[120:121] op_sel:[0,1] op_sel_hi:[1,1]
  v_pk_mul_f32 v[36:37], v[36:37], v[120:121] op_sel:[0,0] op_sel_hi:[1,0]
  v_pk_mul_f32 v[52:53], v[52:53], v[120:121] op_sel:[0,1] op_sel_hi:[1,1]
  v_pk_mul_f32 v[38:39], v[38:39], v[120:121] op_sel:[0,0] op_sel_hi:[1,0]
  v_pk_mul_f32 v[54:55], v[54:55], v[120:121] op_sel:[0,1] op_sel_hi:[1,1]
  v_pk_mul_f32 v[40:41], v[40:41], v[120:121] op_sel:[0,0] op_sel_hi:[1,0]
  v_pk_mul_f32 v[56:57], v[56:57], v[120:121] op_sel:[0,1] op_sel_hi:[1,1]
  v_pk_mul_f32 v[42:43], v[42:43], v[120:121] op_sel:[0,0] op_sel_hi:[1,0]
  v_pk_mul_f32 v[58:59], v[58:59], v[120:121] op_sel:[0,1] op_sel_hi:[1,1]
  v_pk_mul_f32 v[44:45], v[44:45], v[120:121] op_sel:[0,0] op_sel_hi:[1,0]
  v_pk_mul_f32 v[60:61], v[60:61], v[120:121] op_sel:[0,1] op_sel_hi:[1,1]
  v_pk_mul_f32 v[46:47], v[46:47], v[120:121] op_sel:[0,0] op_sel_hi:[1,0]
  v_pk_mul_f32 v[62:63], v[62:63], v[120:121] op_sel:[0,1] op_sel_hi:[1,1]
  v_cvt_pk_bf16_f32 v240, v32, v33
  v_cvt_pk_bf16_f32 v248, v48, v49
  v_cvt_pk_bf16_f32 v241, v34, v35
  v_cvt_pk_bf16_f32 v249, v50, v51
  v_cvt_pk_bf16_f32 v242, v36, v37
  v_cvt_pk_bf16_f32 v250, v52, v53
  v_cvt_pk_bf16_f32 v243, v38, v39
  v_cvt_pk_bf16_f32 v251, v54, v55
  v_cvt_pk_bf16_f32 v244, v40, v41
  v_cvt_pk_bf16_f32 v252, v56, v57
  v_cvt_pk_bf16_f32 v245, v42, v43
  v_cvt_pk_bf16_f32 v253, v58, v59
  v_cvt_pk_bf16_f32 v246, v44, v45
  v_cvt_pk_bf16_f32 v254, v60, v61
  v_cvt_pk_bf16_f32 v247, v46, v47
  v_cvt_pk_bf16_f32 v255, v62, v63
  ds_write_b64 v64, v[240:241]
  v_xor_b32 v125, 16, v64
  ds_write_b64 v125, v[242:243]
  v_xor_b32 v125, 32, v64
  ds_write_b64 v125, v[244:245]
  v_xor_b32 v125, 48, v64
  ds_write_b64 v125, v[246:247]
  v_xor_b32 v125, 64, v64
  ds_write_b64 v125, v[248:249]
  v_xor_b32 v125, 80, v64
  ds_write_b64 v125, v[250:251]
  v_xor_b32 v125, 96, v64
  ds_write_b64 v125, v[252:253]
  v_xor_b32 v125, 112, v64
  ds_write_b64 v125, v[254:255]
  s_waitcnt lgkmcnt(0)
  s_barrier
  s_cmp_gt_u32 s71, 1
  s_cbranch_scc1 L_nopart_102
  ds_read_b64_tr_b16 v[32:33], v26 offset:0
  ds_read_b64_tr_b16 v[34:35], v27 offset:0
  ds_read_b64_tr_b16 v[36:37], v28 offset:0
  ds_read_b64_tr_b16 v[38:39], v29 offset:0
  ds_read_b64_tr_b16 v[40:41], v26 offset:2048
  ds_read_b64_tr_b16 v[42:43], v27 offset:2048
  ds_read_b64_tr_b16 v[44:45], v28 offset:1024
  ds_read_b64_tr_b16 v[46:47], v29 offset:1024
  ds_read_b64_tr_b16 v[48:49], v26 offset:4096
  ds_read_b64_tr_b16 v[50:51], v27 offset:4096
  ds_read_b64_tr_b16 v[52:53], v28 offset:2048
  ds_read_b64_tr_b16 v[54:55], v29 offset:2048
  s_waitcnt lgkmcnt(8)
  v_mfma_f32_32x32x16_bf16 v[68:83], v[32:35], v[36:39], 0
  ds_read_b64_tr_b16 v[32:33], v26 offset:6144
  ds_read_b64_tr_b16 v[34:35], v27 offset:6144
  ds_read_b64_tr_b16 v[36:37], v28 offset:3072
  ds_read_b64_tr_b16 v[38:39], v29 offset:3072
  s_waitcnt lgkmcnt(8)
  v_mfma_f32_32x32x16_bf16 v[68:83], v[40:43], v[44:47], v[68:83]
  ds_read_b64_tr_b16 v[40:41], v26 offset:8192
  ds_read_b64_tr_b16 v[42:43], v27 offset:8192
  ds_read_b64_tr_b16 v[44:45], v28 offset:4096
  ds_read_b64_tr_b16 v[46:47], v29 offset:4096
  s_waitcnt lgkmcnt(8)
  v_mfma_f32_32x32x16_bf16 v[68:83], v[48:51], v[52:55], v[68:83]
  ds_read_b64_tr_b16 v[48:49], v26 offset:10240
  ds_read_b64_tr_b16 v[50:51], v27 offset:10240
  ds_read_b64_tr_b16 v[52:53], v28 offset:5120
  ds_read_b64_tr_b16 v[54:55], v29 offset:5120
  s_waitcnt lgkmcnt(8)
  v_mfma_f32_32x32x16_bf16 v[68:83], v[32:35], v[36:39], v[68:83]
  ds_read_b64_tr_b16 v[32:33], v26 offset:12288
  ds_read_b64_tr_b16 v[34:35], v27 offset:12288
  ds_read_b64_tr_b16 v[36:37], v28 offset:6144
  ds_read_b64_tr_b16 v[38:39], v29 offset:6144
  s_waitcnt lgkmcnt(8)
  v_mfma_f32_32x32x16_bf16 v[68:83], v[40:43], v[44:47], v[68:83]
  ds_read_b64_tr_b16 v[40:41], v26 offset:14336
  ds_read_b64_tr_b16 v[42:43], v27 offset:14336
  ds_read_b64_tr_b16 v[44:45], v28 offset:7168
  ds_read_b64_tr_b16 v[46:47], v29 offset:7168
  s_waitcnt lgkmcnt(8)
  v_mfma_f32_32x32x16_bf16 v[68:83], v[48:51], v[52:55], v[68:83]
  s_waitcnt lgkmcnt(4)
  v_mfma_f32_32x32x16_bf16 v[68:83], v[32:35], v[36:39], v[68:83]
  s_waitcnt lgkmcnt(0)
  v_mfma_f32_32x32x16_bf16 v[68:83], v[40:43], v[44:47], v[68:83]
  s_lshl_b32 s90, s73, 1
  s_add_u32 s90, s90, 1
  s_lshl_b32 s90, s90, 4
  s_add_u32 s90, s90, s68
  s_lshl_b32 s90, s90, 1
  s_add_u32 s90, s90, s71
  s_lshl_b32 s90, s90, 12
  s_add_u32 s90, s90, 262144
  v_lshlrev_b32 v124, 4, v1
  s_nop 2
  v_cvt_pk_bf16_f32 v68, v68, v69
  v_cvt_pk_bf16_f32 v70, v70, v71
  v_mov_b32 v69, s74
  v_mov_b32 v71, s74
  v_cvt_pk_bf16_f32 v72, v72, v73
  v_cvt_pk_bf16_f32 v74, v74, v75
  v_mov_b32 v73, s74
  v_mov_b32 v75, s74
  v_cvt_pk_bf16_f32 v76, v76, v77
  v_cvt_pk_bf16_f32 v78, v78, v79
  v_mov_b32 v77, s74
  v_mov_b32 v79, s74
  v_cvt_pk_bf16_f32 v80, v80, v81
  v_cvt_pk_bf16_f32 v82, v82, v83
  v_mov_b32 v81, s74
  v_mov_b32 v83, s74
  buffer_store_dwordx4 v[68:71], v124, s[48:51], s90 offen offset:0 sc1
  buffer_store_dwordx4 v[72:75], v124, s[48:51], s90 offen offset:1024 sc1
  buffer_store_dwordx4 v[76:79], v124, s[48:51], s90 offen offset:2048 sc1
  buffer_store_dwordx4 v[80:83], v124, s[48:51], s90 offen offset:3072 sc1
L_nopart_102:
  v_add_u32 v12, 98304, v15
  v_mov_b32 v116, 0
  v_mov_b32 v117, 0
  v_mov_b32 v118, 0
  v_mov_b32 v119, 0
  ds_read_b64_tr_b16 v[32:33], v12 offset:0
  ds_read_b64_tr_b16 v[34:35], v12 offset:512
  ds_read_b64_tr_b16 v[36:37], v12 offset:2048
  ds_read_b64_tr_b16 v[38:39], v12 offset:2560
  ds_read_b64_tr_b16 v[40:41], v12 offset:4096
  ds_read_b64_tr_b16 v[42:43], v12 offset:4608
  ds_read_b64_tr_b16 v[44:45], v12 offset:6144
  ds_read_b64_tr_b16 v[46:47], v12 offset:6656
  ds_read_b64_tr_b16 v[48:49], v12 offset:8192
  ds_read_b64_tr_b16 v[50:51], v12 offset:8704
  ds_read_b64_tr_b16 v[52:53], v12 offset:10240
  ds_read_b64_tr_b16 v[54:55], v12 offset:10752
  s_waitcnt lgkmcnt(10)
  v_mfma_f32_32x32x16_bf16 v[100:115], v[32:35], v[128:131], 0
  ds_read_b64_tr_b16 v[56:57], v12 offset:12288
  ds_read_b64_tr_b16 v[58:59], v12 offset:12800
  s_cmp_lg_u32 s71, 0
  s_cbranch_scc1 L_skip_103
  v_mfma_f32_4x4x4_16b_bf16 v[116:119], v[16:17], v[32:33], v[116:119]
  s_nop 1
  v_mfma_f32_4x4x4_16b_bf16 v[116:119], v[16:17], v[34:35], v[116:119]
L_skip_103:
  s_waitcnt lgkmcnt(10)
  v_mfma_f32_32x32x16_bf16 v[100:115], v[36:39], v[132:135], v[100:115]
  ds_read_b64_tr_b16 v[60:61], v12 offset:14336
  ds_read_b64_tr_b16 v[62:63], v12 offset:14848
  s_cmp_lg_u32 s71, 1
  s_cbranch_scc1 L_skip_104
  v_mfma_f32_4x4x4_16b_bf16 v[116:119], v[16:17], v[36:37], v[116:119]
  s_nop 1
  v_mfma_f32_4x4x4_16b_bf16 v[116:119], v[16:17], v[38:39], v[116:119]
L_skip_104:
  s_lshr_b32 s92, s2, 3
  s_mul_i32 s93, s92, 50176
  s_mul_i32 s94, s70, 6272
  s_add_u32 s80, s93, s94
  s_mul_i32 s93, s92, 12544
  s_mul_i32 s94, s70, 1568
  s_add_u32 s81, s93, s94
  v_lshlrev_b32 v6, 4, v1
  s_waitcnt lgkmcnt(10)
  v_mfma_f32_32x32x16_bf16 v[100:115], v[40:43], v[136:139], v[100:115]
  ds_read_b64_tr_b16 v[32:33], v12 offset:16384
  ds_read_b64_tr_b16 v[34:35], v12 offset:16896
  s_cmp_lg_u32 s71, 2
  s_cbranch_scc1 L_skip_105
  v_mfma_f32_4x4x4_16b_bf16 v[116:119], v[16:17], v[40:41], v[116:119]
  s_nop 1
  v_mfma_f32_4x4x4_16b_bf16 v[116:119], v[16:17], v[42:43], v[116:119]
L_skip_105:
  s_waitcnt lgkmcnt(10)
  v_mfma_f32_32x32x16_bf16 v[100:115], v[44:47], v[140:143], v[100:115]
  ds_read_b64_tr_b16 v[36:37], v12 offset:18432
  ds_read_b64_tr_b16 v[38:39], v12 offset:18944
  s_cmp_lg_u32 s71, 3
  s_cbranch_scc1 L_skip_106
  v_mfma_f32_4x4x4_16b_bf16 v[116:119], v[16:17], v[44:45], v[116:119]
  s_nop 1
  v_mfma_f32_4x4x4_16b_bf16 v[116:119], v[16:17], v[46:47], v[116:119]
L_skip_106:
  s_waitcnt lgkmcnt(10)
  v_mfma_f32_32x32x16_bf16 v[100:115], v[48:51], v[144:147], v[100:115]
  ds_read_b64_tr_b16 v[40:41], v12 offset:20480
  ds_read_b64_tr_b16 v[42:43], v12 offset:20992
  s_cmp_lg_u32 s71, 0
  s_cbranch_scc1 L_skip_107
  v_mfma_f32_4x4x4_16b_bf16 v[116:119], v[16:17], v[48:49], v[116:119]
  s_nop 1
  v_mfma_f32_4x4x4_16b_bf16 v[116:119], v[16:17], v[50:51], v[116:119]
L_skip_107:
  s_add_u32 s82, s80, 0
  s_mov_b32 m0, 160000
  s_nop 0
  buffer_load_dwordx4 v6, s[40:43], s82 offen lds
  s_waitcnt lgkmcnt(10)
  v_mfma_f32_32x32x16_bf16 v[100:115], v[52:55], v[148:151], v[100:115]
  ds_read_b64_tr_b16 v[44:45], v12 offset:22528
  ds_read_b64_tr_b16 v[46:47], v12 offset:23040
  s_cmp_lg_u32 s71, 1
  s_cbranch_scc1 L_skip_108
  v_mfma_f32_4x4x4_16b_bf16 v[116:119], v[16:17], v[52:53], v[116:119]
  s_nop 1
  v_mfma_f32_4x4x4_16b_bf16 v[116:119], v[16:17], v[54:55], v[116:119]
L_skip_108:
  s_waitcnt lgkmcnt(10)
  v_mfma_f32_32x32x16_bf16 v[100:115], v[56:59], v[152:155], v[100:115]
  ds_read_b64_tr_b16 v[48:49], v12 offset:24576
  ds_read_b64_tr_b16 v[50:51], v12 offset:25088
  s_cmp_lg_u32 s71, 2
  s_cbranch_scc1 L_skip_109
  v_mfma_f32_4x4x4_16b_bf16 v[116:119], v[16:17], v[56:57], v[116:119]
  s_nop 1
  v_mfma_f32_4x4x4_16b_bf16 v[116:119], v[16:17], v[58:59], v[116:119]
L_skip_109:
  s_waitcnt lgkmcnt(10)
  v_mfma_f32_32x32x16_bf16 v[100:115], v[60:63], v[156:159], v[100:115]
  ds_read_b64_tr_b16 v[52:53], v12 offset:26624
  ds_read_b64_tr_b16 v[54:55], v12 offset:27136
  s_cmp_lg_u32 s71, 3
  s_cbranch_scc1 L_skip_110
  v_mfma_f32_4x4x4_16b_bf16 v[116:119], v[16:17], v[60:61], v[116:119]
  s_nop 1
  v_mfma_f32_4x4x4_16b_bf16 v[116:119], v[16:17], v[62:63], v[116:119]
L_skip_110:
  s_add_u32 s82, s80, 1024
  s_mov_b32 m0, 160000
  s_nop 0
  buffer_load_dwordx4 v6, s[40:43], s82 offen lds
  s_waitcnt lgkmcnt(10)
  v_mfma_f32_32x32x16_bf16 v[100:115], v[32:35], v[160:163], v[100:115]
  ds_read_b64_tr_b16 v[56:57], v12 offset:28672
  ds_read_b64_tr_b16 v[58:59], v12 offset:29184
  s_cmp_lg_u32 s71, 0
  s_cbranch_scc1 L_skip_111
  v_mfma_f32_4x4x4_16b_bf16 v[116:119], v[16:17], v[32:33], v[116:119]
  s_nop 1
  v_mfma_f32_4x4x4_16b_bf16 v[116:119], v[16:17], v[34:35], v[116:119]
L_skip_111:
  s_waitcnt lgkmcnt(10)
  v_mfma_f32_32x32x16_bf16 v[100:115], v[36:39], v[164:167], v[100:115]
  ds_read_b64_tr_b16 v[60:61], v12 offset:30720
  ds_read_b64_tr_b16 v[62:63], v12 offset:31232
  s_cmp_lg_u32 s71, 1
  s_cbranch_scc1 L_skip_112
  v_mfma_f32_4x4x4_16b_bf16 v[116:119], v[16:17], v[36:37], v[116:119]
  s_nop 1
  v_mfma_f32_4x4x4_16b_bf16 v[116:119], v[16:17], v[38:39], v[116:119]
L_skip_112:
  s_waitcnt lgkmcnt(10)
  v_mfma_f32_32x32x16_bf16 v[100:115], v[40:43], v[168:171], v[100:115]
  ds_read_b64_tr_b16 v[32:33], v15 offset:0
  ds_read_b64_tr_b16 v[34:35], v15 offset:512
  s_cmp_lg_u32 s71, 2
  s_cbranch_scc1 L_skip_113
  v_mfma_f32_4x4x4_16b_bf16 v[116:119], v[16:17], v[40:41], v[116:119]
  s_nop 1
  v_mfma_f32_4x4x4_16b_bf16 v[116:119], v[16:17], v[42:43], v[116:119]
L_skip_113:
  s_add_u32 s82, s80, 2048
  s_mov_b32 m0, 160000
  s_nop 0
  buffer_load_dwordx4 v6, s[40:43], s82 offen lds
  s_waitcnt lgkmcnt(10)
  v_mfma_f32_32x32x16_bf16 v[100:115], v[44:47], v[172:175], v[100:115]
  ds_read_b64_tr_b16 v[36:37], v15 offset:2048
  ds_read_b64_tr_b16 v[38:39], v15 offset:2560
  s_cmp_lg_u32 s71, 3
  s_cbranch_scc1 L_skip_114
  v_mfma_f32_4x4x4_16b_bf16 v[116:119], v[16:17], v[44:45], v[116:119]
  s_nop 1
  v_mfma_f32_4x4x4_16b_bf16 v[116:119], v[16:17], v[46:47], v[116:119]
L_skip_114:
  s_waitcnt lgkmcnt(10)
  v_mfma_f32_32x32x16_bf16 v[100:115], v[48:51], v[176:179], v[100:115]
  ds_read_b64_tr_b16 v[40:41], v15 offset:4096
  ds_read_b64_tr_b16 v[42:43], v15 offset:4608
  s_cmp_lg_u32 s71, 0
  s_cbranch_scc1 L_skip_115
  v_mfma_f32_4x4x4_16b_bf16 v[116:119], v[16:17], v[48:49], v[116:119]
  s_nop 1
  v_mfma_f32_4x4x4_16b_bf16 v[116:119], v[16:17], v[50:51], v[116:119]
L_skip_115:
  s_waitcnt lgkmcnt(10)
  v_mfma_f32_32x32x16_bf16 v[100:115], v[52:55], v[180:183], v[100:115]
  ds_read_b64_tr_b16 v[44:45], v15 offset:6144
  ds_read_b64_tr_b16 v[46:47], v15 offset:6656
  s_cmp_lg_u32 s71, 1
  s_cbranch_scc1 L_skip_116
  v_mfma_f32_4x4x4_16b_bf16 v[116:119], v[16:17], v[52:53], v[116:119]
  s_nop 1
  v_mfma_f32_4x4x4_16b_bf16 v[116:119], v[16:17], v[54:55], v[116:119]
L_skip_116:
  s_add_u32 s82, s80, 3072
  s_mov_b32 m0, 160000
  s_nop 0
  buffer_load_dwordx4 v6, s[40:43], s82 offen lds
  s_waitcnt lgkmcnt(10)
  v_mfma_f32_32x32x16_bf16 v[100:115], v[56:59], v[184:187], v[100:115]
  ds_read_b64_tr_b16 v[48:49], v15 offset:8192
  ds_read_b64_tr_b16 v[50:51], v15 offset:8704
  s_cmp_lg_u32 s71, 2
  s_cbranch_scc1 L_skip_117
  v_mfma_f32_4x4x4_16b_bf16 v[116:119], v[16:17], v[56:57], v[116:119]
  s_nop 1
  v_mfma_f32_4x4x4_16b_bf16 v[116:119], v[16:17], v[58:59], v[116:119]
L_skip_117:
  s_waitcnt lgkmcnt(10)
  v_mfma_f32_32x32x16_bf16 v[100:115], v[60:63], v[188:191], v[100:115]
  ds_read_b64_tr_b16 v[52:53], v15 offset:10240
  ds_read_b64_tr_b16 v[54:55], v15 offset:10752
  s_cmp_lg_u32 s71, 3
  s_cbranch_scc1 L_skip_118
  v_mfma_f32_4x4x4_16b_bf16 v[116:119], v[16:17], v[60:61], v[116:119]
  s_nop 1
  v_mfma_f32_4x4x4_16b_bf16 v[116:119], v[16:17], v[62:63], v[116:119]
L_skip_118:
  s_waitcnt lgkmcnt(10)
  v_mfma_f32_32x32x16_bf16 v[100:115], v[32:35], v[192:195], v[100:115]
  ds_read_b64_tr_b16 v[56:57], v15 offset:12288
  ds_read_b64_tr_b16 v[58:59], v15 offset:12800
  s_cmp_lg_u32 s71, 0
  s_cbranch_scc1 L_skip_119
  v_mfma_f32_4x4x4_16b_bf16 v[116:119], v[16:17], v[32:33], v[116:119]
  s_nop 1
  v_mfma_f32_4x4x4_16b_bf16 v[116:119], v[16:17], v[34:35], v[116:119]
L_skip_119:
  s_add_u32 s82, s80, 4096
  s_mov_b32 m0, 160000
  s_nop 0
  buffer_load_dwordx4 v6, s[40:43], s82 offen lds
  s_waitcnt lgkmcnt(10)
  v_mfma_f32_32x32x16_bf16 v[100:115], v[36:39], v[196:199], v[100:115]
  ds_read_b64_tr_b16 v[60:61], v15 offset:14336
  ds_read_b64_tr_b16 v[62:63], v15 offset:14848
  s_cmp_lg_u32 s71, 1
  s_cbranch_scc1 L_skip_120
  v_mfma_f32_4x4x4_16b_bf16 v[116:119], v[16:17], v[36:37], v[116:119]
  s_nop 1
  v_mfma_f32_4x4x4_16b_bf16 v[116:119], v[16:17], v[38:39], v[116:119]
L_skip_120:
  s_waitcnt lgkmcnt(10)
  v_mfma_f32_32x32x16_bf16 v[100:115], v[40:43], v[200:203], v[100:115]
  ds_read_b64_tr_b16 v[32:33], v15 offset:16384
  ds_read_b64_tr_b16 v[34:35], v15 offset:16896
  s_cmp_lg_u32 s71, 2
  s_cbranch_scc1 L_skip_121
  v_mfma_f32_4x4x4_16b_bf16 v[116:119], v[16:17], v[40:41], v[116:119]
  s_nop 1
  v_mfma_f32_4x4x4_16b_bf16 v[116:119], v[16:17], v[42:43], v[116:119]
L_skip_121:
  s_waitcnt lgkmcnt(10)
  v_mfma_f32_32x32x16_bf16 v[100:115], v[44:47], v[204:207], v[100:115]
  ds_read_b64_tr_b16 v[36:37], v15 offset:18432
  ds_read_b64_tr_b16 v[38:39], v15 offset:18944
  s_cmp_lg_u32 s71, 3
  s_cbranch_scc1 L_skip_122
  v_mfma_f32_4x4x4_16b_bf16 v[116:119], v[16:17], v[44:45], v[116:119]
  s_nop 1
  v_mfma_f32_4x4x4_16b_bf16 v[116:119], v[16:17], v[46:47], v[116:119]
L_skip_122:
  s_add_u32 s82, s80, 5120
  s_mov_b32 m0, 160000
  s_nop 0
  buffer_load_dwordx4 v6, s[40:43], s82 offen lds
  s_waitcnt lgkmcnt(10)
  v_mfma_f32_32x32x16_bf16 v[100:115], v[48:51], v[208:211], v[100:115]
  ds_read_b64_tr_b16 v[40:41], v15 offset:20480
  ds_read_b64_tr_b16 v[42:43], v15 offset:20992
  s_cmp_lg_u32 s71, 0
  s_cbranch_scc1 L_skip_123
  v_mfma_f32_4x4x4_16b_bf16 v[116:119], v[16:17], v[48:49], v[116:119]
  s_nop 1
  v_mfma_f32_4x4x4_16b_bf16 v[116:119], v[16:17], v[50:51], v[116:119]
L_skip_123:
  s_waitcnt lgkmcnt(10)
  v_mfma_f32_32x32x16_bf16 v[100:115], v[52:55], v[212:215], v[100:115]
  ds_read_b64_tr_b16 v[44:45], v15 offset:22528
  ds_read_b64_tr_b16 v[46:47], v15 offset:23040
  s_cmp_lg_u32 s71, 1
  s_cbranch_scc1 L_skip_124
  v_mfma_f32_4x4x4_16b_bf16 v[116:119], v[16:17], v[52:53], v[116:119]
  s_nop 1
  v_mfma_f32_4x4x4_16b_bf16 v[116:119], v[16:17], v[54:55], v[116:119]
L_skip_124:
  s_waitcnt lgkmcnt(10)
  v_mfma_f32_32x32x16_bf16 v[100:115], v[56:59], v[216:219], v[100:115]
  s_cmp_lg_u32 s71, 2
  s_cbranch_scc1 L_skip_125
  v_mfma_f32_4x4x4_16b_bf16 v[116:119], v[16:17], v[56:57], v[116:119]
  s_nop 1
  v_mfma_f32_4x4x4_16b_bf16 v[116:119], v[16:17], v[58:59], v[116:119]
L_skip_125:
  s_add_u32 s82, s80, 5248
  s_mov_b32 m0, 160000
  s_nop 0
  buffer_load_dwordx4 v6, s[40:43], s82 offen lds
  s_waitcnt lgkmcnt(8)
  v_mfma_f32_32x32x16_bf16 v[100:115], v[60:63], v[220:223], v[100:115]
  s_cmp_lg_u32 s71, 3
  s_cbranch_scc1 L_skip_126
  v_mfma_f32_4x4x4_16b_bf16 v[116:119], v[16:17], v[60:61], v[116:119]
  s_nop 1
  v_mfma_f32_4x4x4_16b_bf16 v[116:119], v[16:17], v[62:63], v[116:119]
L_skip_126:
  s_waitcnt lgkmcnt(6)
  v_mfma_f32_32x32x16_bf16 v[100:115], v[32:35], v[224:227], v[100:115]
  s_cmp_lg_u32 s71, 0
  s_cbranch_scc1 L_skip_127
  v_mfma_f32_4x4x4_16b_bf16 v[116:119], v[16:17], v[32:33], v[116:119]
  s_nop 1
  v_mfma_f32_4x4x4_16b_bf16 v[116:119], v[16:17], v[34:35], v[116:119]
L_skip_127:
  s_waitcnt lgkmcnt(4)
  v_mfma_f32_32x32x16_bf16 v[100:115], v[36:39], v[228:231], v[100:115]
  s_cmp_lg_u32 s71, 1
  s_cbranch_scc1 L_skip_128
  v_mfma_f32_4x4x4_16b_bf16 v[116:119], v[16:17], v[36:37], v[116:119]
  s_nop 1
  v_mfma_f32_4x4x4_16b_bf16 v[116:119], v[16:17], v[38:39], v[116:119]
L_skip_128:
  s_add_u32 s82, s81, 0
  s_mov_b32 m0, 160000
  s_nop 0
  buffer_load_dwordx4 v6, s[44:47], s82 offen lds
  s_waitcnt lgkmcnt(2)
  v_mfma_f32_32x32x16_bf16 v[100:115], v[40:43], v[232:235], v[100:115]
  s_cmp_lg_u32 s71, 2
  s_cbranch_scc1 L_skip_129
  v_mfma_f32_4x4x4_16b_bf16 v[116:119], v[16:17], v[40:41], v[116:119]
  s_nop 1
  v_mfma_f32_4x4x4_16b_bf16 v[116:119], v[16:17], v[42:43], v[116:119]
L_skip_129:
  s_waitcnt lgkmcnt(0)
  v_mfma_f32_32x32x16_bf16 v[100:115], v[44:47], v[236:239], v[100:115]
  s_cmp_lg_u32 s71, 3
  s_cbranch_scc1 L_skip_130
  v_mfma_f32_4x4x4_16b_bf16 v[116:119], v[16:17], v[44:45], v[116:119]
  s_nop 1
  v_mfma_f32_4x4x4_16b_bf16 v[116:119], v[16:17], v[46:47], v[116:119]
L_skip_130:
  s_add_u32 s82, s81, 544
  s_mov_b32 m0, 160000
  s_nop 0
  buffer_load_dwordx4 v6, s[44:47], s82 offen lds
  s_nop 4
  s_lshl_b32 s90, s71, 2
  v_lshlrev_b32 v125, 4, v2
  v_add_u32 v125, s90, v125
  v_add_u32 v125, 152320, v125
  v_mov_b32 v124, v116
  s_nop 1
  v_permlane32_swap_b32 v116, v124
  v_add_f32 v116, v116, v124
  ds_write_b32 v125, v116 offset:2560
  s_waitcnt lgkmcnt(0)
  s_barrier
  v_lshlrev_b32 v125, 4, v2
  v_add_u32 v125, 152320, v125
  ds_read_b128 v[116:119], v125 offset:2560
  s_mul_i32 s90, s70, 384
  v_lshlrev_b32 v124, 2, v2
  v_add_u32 v124, s90, v124
  v_add_u32 v124, 155904, v124
  s_waitcnt lgkmcnt(0)
  v_add_f32 v116, v116, v117
  v_add_f32 v118, v118, v119
  v_add_f32 v116, v116, v118
  ds_write_b32 v124, v116 offset:256
  s_waitcnt lgkmcnt(0)
  v_lshlrev_b32 v9, 4, v3
  v_add_u32 v9, 151680, v9
  v_lshlrev_b32 v10, 4, v1
  ds_read_b128 v[32:35], v8 offset:256
  ds_read_b128 v[36:39], v8 offset:288
  ds_read_b128 v[40:43], v8 offset:320
  ds_read_b128 v[44:47], v8 offset:352
  ds_read_b128 v[48:51], v9 offset:128
  ds_read_b128 v[52:55], v9 offset:160
  ds_read_b128 v[56:59], v9 offset:192
  ds_read_b128 v[60:63], v9 offset:224
  s_waitcnt lgkmcnt(4)
  v_pk_fma_f32 v[100:101], v[32:33], v[30:31], v[100:101] op_sel:[0,0,0] op_sel_hi:[1,0,1]
  v_pk_fma_f32 v[102:103], v[34:35], v[30:31], v[102:103] op_sel:[0,0,0] op_sel_hi:[1,0,1]
  v_pk_fma_f32 v[104:105], v[36:37], v[30:31], v[104:105] op_sel:[0,0,0] op_sel_hi:[1,0,1]
  v_pk_fma_f32 v[106:107], v[38:39], v[30:31], v[106:107] op_sel:[0,0,0] op_sel_hi:[1,0,1]
  v_pk_fma_f32 v[108:109], v[40:41], v[30:31], v[108:109] op_sel:[0,0,0] op_sel_hi:[1,0,1]
  v_pk_fma_f32 v[110:111], v[42:43], v[30:31], v[110:111] op_sel:[0,0,0] op_sel_hi:[1,0,1]
  v_pk_fma_f32 v[112:113], v[44:45], v[30:31], v[112:113] op_sel:[0,0,0] op_sel_hi:[1,0,1]
  v_pk_fma_f32 v[114:115], v[46:47], v[30:31], v[114:115] op_sel:[0,0,0] op_sel_hi:[1,0,1]
  s_waitcnt lgkmcnt(0)
  v_pk_fma_f32 v[100:101], v[100:101], v[30:31], v[48:49] op_sel:[0,1,0] op_sel_hi:[1,1,1]
  v_pk_fma_f32 v[102:103], v[102:103], v[30:31], v[50:51] op_sel:[0,1,0] op_sel_hi:[1,1,1]
  v_pk_fma_f32 v[104:105], v[104:105], v[30:31], v[52:53] op_sel:[0,1,0] op_sel_hi:[1,1,1]
  v_pk_fma_f32 v[106:107], v[106:107], v[30:31], v[54:55] op_sel:[0,1,0] op_sel_hi:[1,1,1]
  v_pk_fma_f32 v[108:109], v[108:109], v[30:31], v[56:57] op_sel:[0,1,0] op_sel_hi:[1,1,1]
  v_pk_fma_f32 v[110:111], v[110:111], v[30:31], v[58:59] op_sel:[0,1,0] op_sel_hi:[1,1,1]
  v_pk_fma_f32 v[112:113], v[112:113], v[30:31], v[60:61] op_sel:[0,1,0] op_sel_hi:[1,1,1]
  v_pk_fma_f32 v[114:115], v[114:115], v[30:31], v[62:63] op_sel:[0,1,0] op_sel_hi:[1,1,1]
  v_max_f32 v100, 0, v100
  v_max_f32 v101, 0, v101
  v_max_f32 v102, 0, v102
  v_max_f32 v103, 0, v103
  v_max_f32 v104, 0, v104
  v_max_f32 v105, 0, v105
  v_max_f32 v106, 0, v106
  v_max_f32 v107, 0, v107
  v_max_f32 v108, 0, v108
  v_max_f32 v109, 0, v109
  v_max_f32 v110, 0, v110
  v_max_f32 v111, 0, v111
  v_max_f32 v112, 0, v112
  v_max_f32 v113, 0, v113
  v_max_f32 v114, 0, v114
  v_max_f32 v115, 0, v115
  v_pk_mul_f32 v[100:101], v[100:101], v[100:101]
  v_pk_mul_f32 v[102:103], v[102:103], v[102:103]
  v_pk_mul_f32 v[104:105], v[104:105], v[104:105]
  v_pk_mul_f32 v[106:107], v[106:107], v[106:107]
  v_pk_mul_f32 v[108:109], v[108:109], v[108:109]
  v_pk_mul_f32 v[110:111], v[110:111], v[110:111]
  v_pk_mul_f32 v[112:113], v[112:113], v[112:113]
  v_pk_mul_f32 v[114:115], v[114:115], v[114:115]
  v_cvt_pk_bf16_f32 v100, v100, v101
  v_cvt_pk_bf16_f32 v101, v102, v103
  v_cvt_pk_bf16_f32 v102, v104, v105
  v_cvt_pk_bf16_f32 v103, v106, v107
  v_cvt_pk_bf16_f32 v104, v108, v109
  v_cvt_pk_bf16_f32 v105, v110, v111
  v_cvt_pk_bf16_f32 v106, v112, v113
  v_cvt_pk_bf16_f32 v107, v114, v115
  s_lshl_b32 s90, s12, 10
  s_add_u32 s90, s90, s15
  buffer_store_dwordx4 v[100:103], v10, s[48:51], s90 offen sc1
  buffer_store_dwordx4 v[104:107], v10, s[48:51], s90 offen offset:1024 sc1
  s_waitcnt vmcnt(0)
  s_setprio 0
  s_barrier
  s_branch L_S2_TK
L_Q0:
  s_mov_b32 s94, s93
  s_mul_i32 s92, s73, 3136
  s_lshl_b32 s93, s71, 10
  s_add_u32 s92, s92, s93
  v_lshlrev_b32 v244, 4, v1
  s_mov_b32 s56, s8
  s_and_b32 s57, s9, 0xffff
  s_mov_b32 s58, 25088
  s_mov_b32 s59, 0x20000
  s_add_u32 m0, s93, 147456
  s_nop 0
  buffer_load_dwordx4 v244, s[56:59], s92 offen lds
  s_mov_b32 s40, s18
  s_and_b32 s41, s19, 0xffff
  s_mov_b32 s42, 1605632
  s_mov_b32 s43, 0x20000
  s_mov_b32 s32, s6
  s_and_b32 s33, s7, 0xffff
  s_mov_b32 s34, 1204224
  s_mov_b32 s35, 0x20000
  s_mov_b32 s36, s14
  s_and_b32 s37, s15, 0xffff
  s_mov_b32 s38, 1605632
  s_mov_b32 s39, 0x20000
  s_mov_b32 s7, s94
  s_mov_b32 s44, s10
  s_and_b32 s45, s11, 0xffff
  s_mov_b32 s46, 401408
  s_mov_b32 s47, 0x20000
  s_mov_b32 s48, s26
  s_and_b32 s49, s27, 0xffff
  s_mov_b32 s50, 16121856
  s_mov_b32 s51, 0x20000
  s_mov_b32 s52, s22
  s_and_b32 s53, s23, 0xffff
  s_mov_b32 s54, 1835008
  s_mov_b32 s55, 0x20000
  s_mov_b32 s60, s24
  s_and_b32 s61, s25, 0xffff
  s_mov_b32 s62, 256
  s_mov_b32 s63, 0x20000
  v_cmp_eq_u32 s[4:5], 1, v3
  s_mov_b32 s6, 0xffff0000
  s_mul_i32 s10, s73, 112
  s_mul_i32 s90, s70, 21504
  s_add_u32 s10, s10, s90
  s_mov_b32 s11, 172032
  s_mul_i32 s90, s73, 160
  s_add_u32 s90, s90, 512
  s_and_b32 s91, s73, 1
  s_lshl_b32 s92, s91, 5
  s_add_u32 s92, s92, s90
  s_xor_b32 s93, s91, 1
  s_lshl_b32 s93, s93, 7
  s_add_u32 s93, s93, s90
  s_lshr_b32 s12, s92, 4
  s_add_u32 s13, s12, 2
  s_lshr_b32 s14, s93, 4
  s_mov_b32 s22, s7
  s_lshl_b32 s90, s68, 2
  s_add_u32 s90, s90, s71
  s_mul_i32 s15, s90, 114688
  s_add_u32 s15, s15, 4587520
  v_and_b32 v124, 7, v1
  v_lshrrev_b32 v125, 2, v1
  v_and_b32 v125, 4, v125
  v_xor_b32 v124, v124, v125
  v_min_u32 v124, 6, v124
  v_lshlrev_b32 v124, 4, v124
  v_lshrrev_b32 v125, 3, v1
  s_movk_i32 s90, 2688
  v_mad_u32_u24 v7, v125, s90, v124
  v_lshlrev_b32 v124, 4, v1
  s_mul_i32 s90, s2, 6272
  s_lshl_b32 s91, s71, 10
  s_add_u32 s90, s90, s91
  s_mov_b32 m0, 160000
  s_nop 0
  buffer_load_dwordx4 v124, s[40:43], s90 offen lds
  v_mov_b32 v125, 0
  v_lshlrev_b32 v124, 2, v2
  v_add_u32 v124, 151552, v124
  ds_write_b32 v124, v125
  s_or_b32 s90, s2, s70
  s_cmp_lg_u32 s90, 0
  s_cbranch_scc1 L_nonce_131
  s_load_dword s91, s[26:27], 0
  s_waitcnt lgkmcnt(0)
  s_add_u32 s91, s91, 0x9E3779B8
  s_or_b32 s91, s91, 1
  v_mov_b32 v124, 0
  v_mov_b32 v125, s91
  s_mov_b64 s[100:101], exec
  s_mov_b64 exec, 1
  buffer_store_dword v125, v124, s[60:63], 0 offen sc1
  buffer_store_dword v125, v124, s[48:51], 0 offen sc1
  s_mov_b64 exec, s[100:101]
L_nonce_131:
  s_lshl_b32 s90, s71, 12
  v_lshrrev_b32 v124, 1, v2
  v_and_b32 v124, 7, v124
  v_xor_b32 v124, v124, v3
  v_lshlrev_b32 v124, 4, v124
  v_lshl_add_u32 v124, v2, 7, v124
  v_add_u32 v8, s90, v124
  v_xor_b32 v9, 32, v8
  v_xor_b32 v10, 64, v8
  v_xor_b32 v11, 96, v8
  v_lshrrev_b32 v124, 4, v1
  v_and_b32 v124, 1, v124
  v_lshlrev_b32 v124, 5, v124
  v_and_b32 v125, 3, v1
  v_lshl_add_u32 v124, v125, 3, v124
  v_lshlrev_b32 v125, 3, v1
  v_and_b32 v125, 64, v125
  v_xor_b32 v124, v124, v125
  v_lshrrev_b32 v125, 2, v1
  v_and_b32 v125, 3, v125
  v_mad_u32_u24 v12, v3, 8, v125
  v_lshl_add_u32 v12, v12, 7, v124
  v_lshrrev_b32 v124, 4, v1
  v_and_b32 v124, 1, v124
  v_lshlrev_b32 v124, 5, v124
  v_and_b32 v125, 3, v1
  v_lshl_add_u32 v124, v125, 3, v124
  v_add_u32 v124, 64, v124
  v_lshlrev_b32 v125, 3, v1
  v_and_b32 v125, 64, v125
  v_xor_b32 v124, v124, v125
  v_lshrrev_b32 v125, 2, v1
  v_and_b32 v125, 3, v125
  v_mad_u32_u24 v13, v3, 8, v125
  v_lshl_add_u32 v13, v13, 7, v124
  v_lshrrev_b32 v124, 4, v1
  v_and_b32 v124, 1, v124
  v_lshlrev_b32 v124, 5, v124
  v_and_b32 v125, 3, v1
  v_lshl_add_u32 v124, v125, 3, v124
  v_lshrrev_b32 v125, 2, v1
  v_and_b32 v125, 3, v125
  v_mad_u32_u24 v14, v3, 8, v125
  v_lshl_add_u32 v14, v14, 6, v124
  v_mov_b32 v16, 0x3f803f80
  v_mov_b32 v17, 0x3f803f80
  s_mov_b32 s56, s32
  s_mov_b32 s57, s33
  s_mov_b32 s58, s34
  s_mov_b32 s59, s35
  v_mov_b32 v116, 0
  v_mov_b32 v117, 0
  v_mov_b32 v118, 0
  v_mov_b32 v119, 0
  v_mov_b32 v120, 0
  v_mov_b32 v121, 0
  v_mov_b32 v122, 0
  v_mov_b32 v123, 0
  v_mov_b32 v26, 0
  v_mov_b32 v27, 0
  v_mov_b32 v28, 0
  v_mov_b32 v29, 0
  s_waitcnt vmcnt(6)
  s_waitcnt lgkmcnt(0)
  s_barrier
  ds_read_b128 v[128:131], v8
  ds_read_b64_tr_b16 v[32:33], v12 offset:16384
  ds_read_b64_tr_b16 v[34:35], v12 offset:16896
  ds_read_b64_tr_b16 v[36:37], v13 offset:16384
  ds_read_b64_tr_b16 v[38:39], v13 offset:16896
  ds_read_b64_tr_b16 v[40:41], v14 offset:32768
  ds_read_b64_tr_b16 v[42:43], v14 offset:33024
  ds_read_b128 v[132:135], v9
  ds_read_b64_tr_b16 v[44:45], v12 offset:18432
  ds_read_b64_tr_b16 v[46:47], v12 offset:18944
  ds_read_b64_tr_b16 v[48:49], v13 offset:18432
  ds_read_b64_tr_b16 v[50:51], v13 offset:18944
  ds_read_b64_tr_b16 v[52:53], v14 offset:33792
  ds_read_b64_tr_b16 v[54:55], v14 offset:34048
  v_mov_b32 v124, 0
  buffer_load_dword v126, v124, s[60:63], 0 offen sc1
  s_waitcnt lgkmcnt(7)
  v_mfma_f32_32x32x16_bf16 v[68:83], v[32:35], v[128:131], 0
  ds_read_b128 v[136:139], v10
  ds_read_b64_tr_b16 v[56:57], v12 offset:20480
  ds_read_b64_tr_b16 v[58:59], v12 offset:20992
  v_mfma_f32_32x32x16_bf16 v[84:99], v[36:39], v[128:131], 0
  ds_read_b64_tr_b16 v[60:61], v13 offset:20480
  ds_read_b64_tr_b16 v[62:63], v13 offset:20992
  v_mfma_f32_32x32x16_bf16 v[100:115], v[40:43], v[128:131], 0
  ds_read_b64_tr_b16 v[64:65], v14 offset:34816
  ds_read_b64_tr_b16 v[66:67], v14 offset:35072
  s_cmp_lg_u32 s75, 0
  s_cbranch_scc1 L_skip_132
  s_call_b64 s[96:97], L_DMA
  v_mfma_f32_4x4x4_16b_bf16 v[116:119], v[16:17], v[32:33], v[116:119]
  v_mfma_f32_4x4x4_16b_bf16 v[120:123], v[16:17], v[36:37], v[120:123]
  v_mfma_f32_4x4x4_16b_bf16 v[26:29], v[16:17], v[40:41], v[26:29]
  v_mfma_f32_4x4x4_16b_bf16 v[116:119], v[16:17], v[34:35], v[116:119]
  v_mfma_f32_4x4x4_16b_bf16 v[120:123], v[16:17], v[38:39], v[120:123]
  v_mfma_f32_4x4x4_16b_bf16 v[26:29], v[16:17], v[42:43], v[26:29]
L_skip_132:
  s_waitcnt lgkmcnt(7)
  v_mfma_f32_32x32x16_bf16 v[68:83], v[44:47], v[132:135], v[68:83]
  ds_read_b128 v[140:143], v11
  ds_read_b64_tr_b16 v[32:33], v12 offset:22528
  ds_read_b64_tr_b16 v[34:35], v12 offset:23040
  v_mfma_f32_32x32x16_bf16 v[84:99], v[48:51], v[132:135], v[84:99]
  ds_read_b64_tr_b16 v[36:37], v13 offset:22528
  ds_read_b64_tr_b16 v[38:39], v13 offset:23040
  v_mfma_f32_32x32x16_bf16 v[100:115], v[52:55], v[132:135], v[100:115]
  ds_read_b64_tr_b16 v[40:41], v14 offset:35840
  ds_read_b64_tr_b16 v[42:43], v14 offset:36096
  s_cmp_lg_u32 s75, 1
  s_cbranch_scc1 L_skip_133
  s_call_b64 s[96:97], L_DMA
  v_mfma_f32_4x4x4_16b_bf16 v[116:119], v[16:17], v[44:45], v[116:119]
  v_mfma_f32_4x4x4_16b_bf16 v[120:123], v[16:17], v[48:49], v[120:123]
  v_mfma_f32_4x4x4_16b_bf16 v[26:29], v[16:17], v[52:53], v[26:29]
  v_mfma_f32_4x4x4_16b_bf16 v[116:119], v[16:17], v[46:47], v[116:119]
  v_mfma_f32_4x4x4_16b_bf16 v[120:123], v[16:17], v[50:51], v[120:123]
  v_mfma_f32_4x4x4_16b_bf16 v[26:29], v[16:17], v[54:55], v[26:29]
L_skip_133:
  s_waitcnt lgkmcnt(7)
  v_mfma_f32_32x32x16_bf16 v[68:83], v[56:59], v[136:139], v[68:83]
  v_add_u32 v8, 36864, v8
  v_add_u32 v9, 36864, v9
  v_add_u32 v10, 36864, v10
  v_add_u32 v11, 36864, v11
  v_add_u32 v12, 36864, v12
  v_add_u32 v13, 36864, v13
  v_add_u32 v14, 36864, v14
  ds_read_b128 v[144:147], v8
  ds_read_b64_tr_b16 v[44:45], v12 offset:16384
  ds_read_b64_tr_b16 v[46:47], v12 offset:16896
  v_mfma_f32_32x32x16_bf16 v[84:99], v[60:63], v[136:139], v[84:99]
  ds_read_b64_tr_b16 v[48:49], v13 offset:16384
  ds_read_b64_tr_b16 v[50:51], v13 offset:16896
  v_mfma_f32_32x32x16_bf16 v[100:115], v[64:67], v[136:139], v[100:115]
  ds_read_b64_tr_b16 v[52:53], v14 offset:32768
  ds_read_b64_tr_b16 v[54:55], v14 offset:33024
  s_cmp_lg_u32 s75, 2
  s_cbranch_scc1 L_skip_134
  s_call_b64 s[96:97], L_DMA
  v_mfma_f32_4x4x4_16b_bf16 v[116:119], v[16:17], v[56:57], v[116:119]
  v_mfma_f32_4x4x4_16b_bf16 v[120:123], v[16:17], v[60:61], v[120:123]
  v_mfma_f32_4x4x4_16b_bf16 v[26:29], v[16:17], v[64:65], v[26:29]
  v_mfma_f32_4x4x4_16b_bf16 v[116:119], v[16:17], v[58:59], v[116:119]
  v_mfma_f32_4x4x4_16b_bf16 v[120:123], v[16:17], v[62:63], v[120:123]
  v_mfma_f32_4x4x4_16b_bf16 v[26:29], v[16:17], v[66:67], v[26:29]
L_skip_134:
  s_waitcnt lgkmcnt(7)
  v_mfma_f32_32x32x16_bf16 v[68:83], v[32:35], v[140:143], v[68:83]
  ds_read_b128 v[148:151], v9
  ds_read_b64_tr_b16 v[56:57], v12 offset:18432
  ds_read_b64_tr_b16 v[58:59], v12 offset:18944
  v_mfma_f32_32x32x16_bf16 v[84:99], v[36:39], v[140:143], v[84:99]
  ds_read_b64_tr_b16 v[60:61], v13 offset:18432
  ds_read_b64_tr_b16 v[62:63], v13 offset:18944
  v_mfma_f32_32x32x16_bf16 v[100:115], v[40:43], v[140:143], v[100:115]
  ds_read_b64_tr_b16 v[64:65], v14 offset:33792
  ds_read_b64_tr_b16 v[66:67], v14 offset:34048
  s_cmp_lg_u32 s75, 3
  s_cbranch_scc1 L_skip_135
  s_call_b64 s[96:97], L_DMA
  v_mfma_f32_4x4x4_16b_bf16 v[116:119], v[16:17], v[32:33], v[116:119]
  v_mfma_f32_4x4x4_16b_bf16 v[120:123], v[16:17], v[36:37], v[120:123]
  v_mfma_f32_4x4x4_16b_bf16 v[26:29], v[16:17], v[40:41], v[26:29]
  v_mfma_f32_4x4x4_16b_bf16 v[116:119], v[16:17], v[34:35], v[116:119]
  v_mfma_f32_4x4x4_16b_bf16 v[120:123], v[16:17], v[38:39], v[120:123]
  v_mfma_f32_4x4x4_16b_bf16 v[26:29], v[16:17], v[42:43], v[26:29]
L_skip_135:
  s_waitcnt vmcnt(7)
  s_barrier
  s_waitcnt lgkmcnt(7)
  v_mfma_f32_32x32x16_bf16 v[68:83], v[44:47], v[144:147], v[68:83]
  ds_read_b128 v[152:155], v10
  ds_read_b64_tr_b16 v[32:33], v12 offset:20480
  ds_read_b64_tr_b16 v[34:35], v12 offset:20992
  v_mfma_f32_32x32x16_bf16 v[84:99], v[48:51], v[144:147], v[84:99]
  ds_read_b64_tr_b16 v[36:37], v13 offset:20480
  ds_read_b64_tr_b16 v[38:39], v13 offset:20992
  v_mfma_f32_32x32x16_bf16 v[100:115], v[52:55], v[144:147], v[100:115]
  ds_read_b64_tr_b16 v[40:41], v14 offset:34816
  ds_read_b64_tr_b16 v[42:43], v14 offset:35072
  s_waitcnt vmcnt(4)
  v_readfirstlane_b32 s74, v126
  s_nop 0
  s_cmp_lg_u32 s74, 0
  s_cbranch_scc1 L_tagok_136
  s_mov_b32 s95, 0
L_tagloop_137:
  v_mov_b32 v124, 0
  buffer_load_dword v125, v124, s[60:63], 0 offen sc1
  s_waitcnt vmcnt(0)
  v_readfirstlane_b32 s74, v125
  s_add_u32 s95, s95, 1
  s_cmp_lg_u32 s74, 0
  s_cbranch_scc1 L_tagok_136
  s_cmp_lt_u32 s95, 0x40000
  s_cbranch_scc1 L_tagloop_137
L_tagok_136:
  v_mov_b32 v22, 0
  v_mov_b32 v23, 0
  v_lshlrev_b32 v20, 16, v240
  v_and_b32 v21, s6, v240
  v_add_f32 v22, v22, v20
  v_fmac_f32 v23, v20, v20
  v_add_f32 v22, v22, v21
  v_fmac_f32 v23, v21, v21
  s_cmp_lg_u32 s75, 0
  s_cbranch_scc1 L_skip_138
  s_call_b64 s[96:97], L_DMA
  v_mfma_f32_4x4x4_16b_bf16 v[116:119], v[16:17], v[44:45], v[116:119]
  v_mfma_f32_4x4x4_16b_bf16 v[120:123], v[16:17], v[48:49], v[120:123]
  v_mfma_f32_4x4x4_16b_bf16 v[26:29], v[16:17], v[52:53], v[26:29]
  v_mfma_f32_4x4x4_16b_bf16 v[116:119], v[16:17], v[46:47], v[116:119]
  v_mfma_f32_4x4x4_16b_bf16 v[120:123], v[16:17], v[50:51], v[120:123]
  v_mfma_f32_4x4x4_16b_bf16 v[26:29], v[16:17], v[54:55], v[26:29]
L_skip_138:
  s_waitcnt lgkmcnt(7)
  v_mfma_f32_32x32x16_bf16 v[68:83], v[56:59], v[148:151], v[68:83]
  ds_read_b128 v[156:159], v11
  ds_read_b64_tr_b16 v[44:45], v12 offset:22528
  ds_read_b64_tr_b16 v[46:47], v12 offset:23040
  v_mfma_f32_32x32x16_bf16 v[84:99], v[60:63], v[148:151], v[84:99]
  ds_read_b64_tr_b16 v[48:49], v13 offset:22528
  ds_read_b64_tr_b16 v[50:51], v13 offset:23040
  v_mfma_f32_32x32x16_bf16 v[100:115], v[64:67], v[148:151], v[100:115]
  ds_read_b64_tr_b16 v[52:53], v14 offset:35840
  ds_read_b64_tr_b16 v[54:55], v14 offset:36096
  v_lshlrev_b32 v20, 16, v241
  v_and_b32 v21, s6, v241
  v_add_f32 v22, v22, v20
  v_fmac_f32 v23, v20, v20
  v_add_f32 v22, v22, v21
  v_fmac_f32 v23, v21, v21
  v_lshlrev_b32 v20, 16, v242
  v_and_b32 v21, s6, v242
  v_add_f32 v22, v22, v20
  v_fmac_f32 v23, v20, v20
  v_add_f32 v22, v22, v21
  v_fmac_f32 v23, v21, v21
  s_cmp_lg_u32 s75, 1
  s_cbranch_scc1 L_skip_139
  s_call_b64 s[96:97], L_DMA
  v_mfma_f32_4x4x4_16b_bf16 v[116:119], v[16:17], v[56:57], v[116:119]
  v_mfma_f32_4x4x4_16b_bf16 v[120:123], v[16:17], v[60:61], v[120:123]
  v_mfma_f32_4x4x4_16b_bf16 v[26:29], v[16:17], v[64:65], v[26:29]
  v_mfma_f32_4x4x4_16b_bf16 v[116:119], v[16:17], v[58:59], v[116:119]
  v_mfma_f32_4x4x4_16b_bf16 v[120:123], v[16:17], v[62:63], v[120:123]
  v_mfma_f32_4x4x4_16b_bf16 v[26:29], v[16:17], v[66:67], v[26:29]
L_skip_139:
  s_waitcnt lgkmcnt(7)
  v_mfma_f32_32x32x16_bf16 v[68:83], v[32:35], v[152:155], v[68:83]
  v_add_u32 v8, 36864, v8
  v_add_u32 v9, 36864, v9
  v_add_u32 v10, 36864, v10
  v_add_u32 v11, 36864, v11
  v_add_u32 v12, 36864, v12
  v_add_u32 v13, 36864, v13
  v_add_u32 v14, 36864, v14
  ds_read_b128 v[160:163], v8
  ds_read_b64_tr_b16 v[56:57], v12 offset:16384
  ds_read_b64_tr_b16 v[58:59], v12 offset:16896
  v_mfma_f32_32x32x16_bf16 v[84:99], v[36:39], v[152:155], v[84:99]
  ds_read_b64_tr_b16 v[60:61], v13 offset:16384
  ds_read_b64_tr_b16 v[62:63], v13 offset:16896
  v_mfma_f32_32x32x16_bf16 v[100:115], v[40:43], v[152:155], v[100:115]
  ds_read_b64_tr_b16 v[64:65], v14 offset:32768
  ds_read_b64_tr_b16 v[66:67], v14 offset:33024
  v_lshlrev_b32 v20, 16, v243
  v_and_b32 v21, s6, v243
  v_add_f32 v22, v22, v20
  v_fmac_f32 v23, v20, v20
  v_add_f32 v22, v22, v21
  v_fmac_f32 v23, v21, v21
  s_nop 0
  v_add_f32_dpp v22, v22, v22 quad_perm:[1,0,3,2] row_mask:0xf bank_mask:0xf
  v_add_f32_dpp v23, v23, v23 quad_perm:[1,0,3,2] row_mask:0xf bank_mask:0xf
  s_cmp_lg_u32 s75, 2
  s_cbranch_scc1 L_skip_140
  s_call_b64 s[96:97], L_DMA
  v_mfma_f32_4x4x4_16b_bf16 v[116:119], v[16:17], v[32:33], v[116:119]
  v_mfma_f32_4x4x4_16b_bf16 v[120:123], v[16:17], v[36:37], v[120:123]
  v_mfma_f32_4x4x4_16b_bf16 v[26:29], v[16:17], v[40:41], v[26:29]
  v_mfma_f32_4x4x4_16b_bf16 v[116:119], v[16:17], v[34:35], v[116:119]
  v_mfma_f32_4x4x4_16b_bf16 v[120:123], v[16:17], v[38:39], v[120:123]
  v_mfma_f32_4x4x4_16b_bf16 v[26:29], v[16:17], v[42:43], v[26:29]
L_skip_140:
  s_waitcnt lgkmcnt(7)
  v_mfma_f32_32x32x16_bf16 v[68:83], v[44:47], v[156:159], v[68:83]
  ds_read_b128 v[164:167], v9
  ds_read_b64_tr_b16 v[32:33], v12 offset:18432
  ds_read_b64_tr_b16 v[34:35], v12 offset:18944
  v_mfma_f32_32x32x16_bf16 v[84:99], v[48:51], v[156:159], v[84:99]
  ds_read_b64_tr_b16 v[36:37], v13 offset:18432
  ds_read_b64_tr_b16 v[38:39], v13 offset:18944
  v_mfma_f32_32x32x16_bf16 v[100:115], v[52:55], v[156:159], v[100:115]
  ds_read_b64_tr_b16 v[40:41], v14 offset:33792
  ds_read_b64_tr_b16 v[42:43], v14 offset:34048
  v_add_f32_dpp v22, v22, v22 quad_perm:[2,3,0,1] row_mask:0xf bank_mask:0xf
  v_add_f32_dpp v23, v23, v23 quad_perm:[2,3,0,1] row_mask:0xf bank_mask:0xf
  s_nop 0
  v_add_f32_dpp v22, v22, v22 row_half_mirror row_mask:0xf bank_mask:0xf
  v_add_f32_dpp v23, v23, v23 row_half_mirror row_mask:0xf bank_mask:0xf
  s_cmp_lg_u32 s75, 3
  s_cbranch_scc1 L_skip_141
  s_call_b64 s[96:97], L_DMA
  v_mfma_f32_4x4x4_16b_bf16 v[116:119], v[16:17], v[44:45], v[116:119]
  v_mfma_f32_4x4x4_16b_bf16 v[120:123], v[16:17], v[48:49], v[120:123]
  v_mfma_f32_4x4x4_16b_bf16 v[26:29], v[16:17], v[52:53], v[26:29]
  v_mfma_f32_4x4x4_16b_bf16 v[116:119], v[16:17], v[46:47], v[116:119]
  v_mfma_f32_4x4x4_16b_bf16 v[120:123], v[16:17], v[50:51], v[120:123]
  v_mfma_f32_4x4x4_16b_bf16 v[26:29], v[16:17], v[54:55], v[26:29]
L_skip_141:
  s_waitcnt vmcnt(4)
  s_barrier
  s_waitcnt lgkmcnt(7)
  v_mfma_f32_32x32x16_bf16 v[68:83], v[56:59], v[160:163], v[68:83]
  ds_read_b128 v[168:171], v10
  ds_read_b64_tr_b16 v[44:45], v12 offset:20480
  ds_read_b64_tr_b16 v[46:47], v12 offset:20992
  v_mfma_f32_32x32x16_bf16 v[84:99], v[60:63], v[160:163], v[84:99]
  ds_read_b64_tr_b16 v[48:49], v13 offset:20480
  ds_read_b64_tr_b16 v[50:51], v13 offset:20992
  v_mfma_f32_32x32x16_bf16 v[100:115], v[64:67], v[160:163], v[100:115]
  ds_read_b64_tr_b16 v[52:53], v14 offset:34816
  ds_read_b64_tr_b16 v[54:55], v14 offset:35072
  v_add_f32_dpp v22, v22, v22 row_mirror row_mask:0xf bank_mask:0xf
  v_add_f32_dpp v23, v23, v23 row_mirror row_mask:0xf bank_mask:0xf
  v_mov_b32 v20, v22
  s_nop 1
  v_permlane16_swap_b32 v22, v20
  v_add_f32 v22, v22, v20
  v_mov_b32 v20, v23
  s_nop 1
  v_permlane16_swap_b32 v23, v20
  v_add_f32 v23, v23, v20
  s_cmp_lg_u32 s75, 0
  s_cbranch_scc1 L_skip_142
  s_call_b64 s[96:97], L_DMA
  v_mfma_f32_4x4x4_16b_bf16 v[116:119], v[16:17], v[56:57], v[116:119]
  v_mfma_f32_4x4x4_16b_bf16 v[120:123], v[16:17], v[60:61], v[120:123]
  v_mfma_f32_4x4x4_16b_bf16 v[26:29], v[16:17], v[64:65], v[26:29]
  v_mfma_f32_4x4x4_16b_bf16 v[116:119], v[16:17], v[58:59], v[116:119]
  v_mfma_f32_4x4x4_16b_bf16 v[120:123], v[16:17], v[62:63], v[120:123]
  v_mfma_f32_4x4x4_16b_bf16 v[26:29], v[16:17], v[66:67], v[26:29]
L_skip_142:
  s_waitcnt lgkmcnt(7)
  v_mfma_f32_32x32x16_bf16 v[68:83], v[32:35], v[164:167], v[68:83]
  ds_read_b128 v[172:175], v11
  ds_read_b64_tr_b16 v[56:57], v12 offset:22528
  ds_read_b64_tr_b16 v[58:59], v12 offset:23040
  v_mfma_f32_32x32x16_bf16 v[84:99], v[36:39], v[164:167], v[84:99]
  ds_read_b64_tr_b16 v[60:61], v13 offset:22528
  ds_read_b64_tr_b16 v[62:63], v13 offset:23040
  v_mfma_f32_32x32x16_bf16 v[100:115], v[40:43], v[164:167], v[100:115]
  ds_read_b64_tr_b16 v[64:65], v14 offset:35840
  ds_read_b64_tr_b16 v[66:67], v14 offset:36096
  v_mov_b32 v20, v22
  s_nop 1
  v_permlane32_swap_b32 v22, v20
  v_add_f32 v22, v22, v20
  v_mov_b32 v20, v23
  s_nop 1
  v_permlane32_swap_b32 v23, v20
  v_add_f32 v23, v23, v20
  v_mul_f32 v22, 0x3b124925, v22
  v_mul_f32 v23, 0x3b124925, v23
  v_fma_f32 v23, -v22, v22, v23
  v_max_f32 v23, 0, v23
  v_cvt_pk_bf16_f32 v23, v23, v23
  v_lshlrev_b32 v23, 16, v23
  v_add_f32 v23, 0x3727c5ac, v23
  v_cvt_pk_bf16_f32 v23, v23, v23
  v_lshlrev_b32 v23, 16, v23
  s_cmp_lg_u32 s75, 1
  s_cbranch_scc1 L_skip_143
  s_call_b64 s[96:97], L_DMA
  v_mfma_f32_4x4x4_16b_bf16 v[116:119], v[16:17], v[32:33], v[116:119]
  v_mfma_f32_4x4x4_16b_bf16 v[120:123], v[16:17], v[36:37], v[120:123]
  v_mfma_f32_4x4x4_16b_bf16 v[26:29], v[16:17], v[40:41], v[26:29]
  v_mfma_f32_4x4x4_16b_bf16 v[116:119], v[16:17], v[34:35], v[116:119]
  v_mfma_f32_4x4x4_16b_bf16 v[120:123], v[16:17], v[38:39], v[120:123]
  v_mfma_f32_4x4x4_16b_bf16 v[26:29], v[16:17], v[42:43], v[26:29]
L_skip_143:
  s_waitcnt lgkmcnt(7)
  v_mfma_f32_32x32x16_bf16 v[68:83], v[44:47], v[168:171], v[68:83]
  v_add_u32 v8, 36864, v8
  v_add_u32 v9, 36864, v9
  v_add_u32 v10, 36864, v10
  v_add_u32 v11, 36864, v11
  v_add_u32 v12, 36864, v12
  v_add_u32 v13, 36864, v13
  v_add_u32 v14, 36864, v14
  ds_read_b128 v[176:179], v8
  ds_read_b64_tr_b16 v[32:33], v12 offset:16384
  ds_read_b64_tr_b16 v[34:35], v12 offset:16896
  v_mfma_f32_32x32x16_bf16 v[84:99], v[48:51], v[168:171], v[84:99]
  ds_read_b64_tr_b16 v[36:37], v13 offset:16384
  ds_read_b64_tr_b16 v[38:39], v13 offset:16896
  v_mfma_f32_32x32x16_bf16 v[100:115], v[52:55], v[168:171], v[100:115]
  ds_read_b64_tr_b16 v[40:41], v14 offset:32768
  ds_read_b64_tr_b16 v[42:43], v14 offset:33024
  v_sqrt_f32 v23, v23
  v_mov_b32 v20, 0
  v_mov_b32 v25, s74
  v_cvt_pk_bf16_f32 v24, v23, v22
  s_mov_b64 s[100:101], exec
  s_mov_b64 exec, 1
  buffer_store_dwordx2 v[24:25], v20, s[48:51], s3 offen sc1
  s_mov_b64 exec, s[100:101]
  s_cmp_lg_u32 s75, 2
  s_cbranch_scc1 L_skip_144
  s_call_b64 s[96:97], L_DMA
  v_mfma_f32_4x4x4_16b_bf16 v[116:119], v[16:17], v[44:45], v[116:119]
  v_mfma_f32_4x4x4_16b_bf16 v[120:123], v[16:17], v[48:49], v[120:123]
  v_mfma_f32_4x4x4_16b_bf16 v[26:29], v[16:17], v[52:53], v[26:29]
  v_mfma_f32_4x4x4_16b_bf16 v[116:119], v[16:17], v[46:47], v[116:119]
  v_mfma_f32_4x4x4_16b_bf16 v[120:123], v[16:17], v[50:51], v[120:123]
  v_mfma_f32_4x4x4_16b_bf16 v[26:29], v[16:17], v[54:55], v[26:29]
L_skip_144:
  s_waitcnt lgkmcnt(7)
  v_mfma_f32_32x32x16_bf16 v[68:83], v[56:59], v[172:175], v[68:83]
  ds_read_b128 v[180:183], v9
  ds_read_b64_tr_b16 v[44:45], v12 offset:18432
  ds_read_b64_tr_b16 v[46:47], v12 offset:18944
  v_mfma_f32_32x32x16_bf16 v[84:99], v[60:63], v[172:175], v[84:99]
  ds_read_b64_tr_b16 v[48:49], v13 offset:18432
  ds_read_b64_tr_b16 v[50:51], v13 offset:18944
  v_mfma_f32_32x32x16_bf16 v[100:115], v[64:67], v[172:175], v[100:115]
  ds_read_b64_tr_b16 v[52:53], v14 offset:33792
  ds_read_b64_tr_b16 v[54:55], v14 offset:34048
  s_cmp_lg_u32 s75, 3
  s_cbranch_scc1 L_skip_145
  s_call_b64 s[96:97], L_DMA
  v_mfma_f32_4x4x4_16b_bf16 v[116:119], v[16:17], v[56:57], v[116:119]
  v_mfma_f32_4x4x4_16b_bf16 v[120:123], v[16:17], v[60:61], v[120:123]
  v_mfma_f32_4x4x4_16b_bf16 v[26:29], v[16:17], v[64:65], v[26:29]
  v_mfma_f32_4x4x4_16b_bf16 v[116:119], v[16:17], v[58:59], v[116:119]
  v_mfma_f32_4x4x4_16b_bf16 v[120:123], v[16:17], v[62:63], v[120:123]
  v_mfma_f32_4x4x4_16b_bf16 v[26:29], v[16:17], v[66:67], v[26:29]
L_skip_145:
  s_waitcnt vmcnt(4)
  s_barrier
  s_waitcnt lgkmcnt(7)
  v_mfma_f32_32x32x16_bf16 v[68:83], v[32:35], v[176:179], v[68:83]
  ds_read_b128 v[184:187], v10
  ds_read_b64_tr_b16 v[56:57], v12 offset:20480
  ds_read_b64_tr_b16 v[58:59], v12 offset:20992
  v_mfma_f32_32x32x16_bf16 v[84:99], v[36:39], v[176:179], v[84:99]
  ds_read_b64_tr_b16 v[60:61], v13 offset:20480
  ds_read_b64_tr_b16 v[62:63], v13 offset:20992
  v_mfma_f32_32x32x16_bf16 v[100:115], v[40:43], v[176:179], v[100:115]
  ds_read_b64_tr_b16 v[64:65], v14 offset:34816
  ds_read_b64_tr_b16 v[66:67], v14 offset:35072
  s_cmp_lg_u32 s75, 0
  s_cbranch_scc1 L_skip_146
  s_call_b64 s[96:97], L_DMA
  v_mfma_f32_4x4x4_16b_bf16 v[116:119], v[16:17], v[32:33], v[116:119]
  v_mfma_f32_4x4x4_16b_bf16 v[120:123], v[16:17], v[36:37], v[120:123]
  v_mfma_f32_4x4x4_16b_bf16 v[26:29], v[16:17], v[40:41], v[26:29]
  v_mfma_f32_4x4x4_16b_bf16 v[116:119], v[16:17], v[34:35], v[116:119]
  v_mfma_f32_4x4x4_16b_bf16 v[120:123], v[16:17], v[38:39], v[120:123]
  v_mfma_f32_4x4x4_16b_bf16 v[26:29], v[16:17], v[42:43], v[26:29]
L_skip_146:
  s_waitcnt lgkmcnt(7)
  v_mfma_f32_32x32x16_bf16 v[68:83], v[44:47], v[180:183], v[68:83]
  ds_read_b128 v[188:191], v11
  ds_read_b64_tr_b16 v[32:33], v12 offset:22528
  ds_read_b64_tr_b16 v[34:35], v12 offset:23040
  v_mfma_f32_32x32x16_bf16 v[84:99], v[48:51], v[180:183], v[84:99]
  ds_read_b64_tr_b16 v[36:37], v13 offset:22528
  ds_read_b64_tr_b16 v[38:39], v13 offset:23040
  v_mfma_f32_32x32x16_bf16 v[100:115], v[52:55], v[180:183], v[100:115]
  ds_read_b64_tr_b16 v[40:41], v14 offset:35840
  ds_read_b64_tr_b16 v[42:43], v14 offset:36096
  s_cmp_lg_u32 s75, 1
  s_cbranch_scc1 L_skip_147
  s_call_b64 s[96:97], L_DMA
  v_mfma_f32_4x4x4_16b_bf16 v[116:119], v[16:17], v[44:45], v[116:119]
  v_mfma_f32_4x4x4_16b_bf16 v[120:123], v[16:17], v[48:49], v[120:123]
  v_mfma_f32_4x4x4_16b_bf16 v[26:29], v[16:17], v[52:53], v[26:29]
  v_mfma_f32_4x4x4_16b_bf16 v[116:119], v[16:17], v[46:47], v[116:119]
  v_mfma_f32_4x4x4_16b_bf16 v[120:123], v[16:17], v[50:51], v[120:123]
  v_mfma_f32_4x4x4_16b_bf16 v[26:29], v[16:17], v[54:55], v[26:29]
L_skip_147:
  s_waitcnt lgkmcnt(7)
  v_mfma_f32_32x32x16_bf16 v[68:83], v[56:59], v[184:187], v[68:83]
  v_subrev_u32 v8, 110592, v8
  v_subrev_u32 v9, 110592, v9
  v_subrev_u32 v10, 110592, v10
  v_subrev_u32 v11, 110592, v11
  v_subrev_u32 v12, 110592, v12
  v_subrev_u32 v13, 110592, v13
  v_subrev_u32 v14, 110592, v14
  ds_read_b128 v[192:195], v8
  ds_read_b64_tr_b16 v[44:45], v12 offset:16384
  ds_read_b64_tr_b16 v[46:47], v12 offset:16896
  v_mfma_f32_32x32x16_bf16 v[84:99], v[60:63], v[184:187], v[84:99]
  ds_read_b64_tr_b16 v[48:49], v13 offset:16384
  ds_read_b64_tr_b16 v[50:51], v13 offset:16896
  v_mfma_f32_32x32x16_bf16 v[100:115], v[64:67], v[184:187], v[100:115]
  ds_read_b64_tr_b16 v[52:53], v14 offset:32768
  ds_read_b64_tr_b16 v[54:55], v14 offset:33024
  s_cmp_lg_u32 s75, 2
  s_cbranch_scc1 L_skip_148
  s_call_b64 s[96:97], L_DMA
  v_mfma_f32_4x4x4_16b_bf16 v[116:119], v[16:17], v[56:57], v[116:119]
  v_mfma_f32_4x4x4_16b_bf16 v[120:123], v[16:17], v[60:61], v[120:123]
  v_mfma_f32_4x4x4_16b_bf16 v[26:29], v[16:17], v[64:65], v[26:29]
  v_mfma_f32_4x4x4_16b_bf16 v[116:119], v[16:17], v[58:59], v[116:119]
  v_mfma_f32_4x4x4_16b_bf16 v[120:123], v[16:17], v[62:63], v[120:123]
  v_mfma_f32_4x4x4_16b_bf16 v[26:29], v[16:17], v[66:67], v[26:29]
L_skip_148:
  s_waitcnt lgkmcnt(7)
  v_mfma_f32_32x32x16_bf16 v[68:83], v[32:35], v[188:191], v[68:83]
  ds_read_b128 v[196:199], v9
  ds_read_b64_tr_b16 v[56:57], v12 offset:18432
  ds_read_b64_tr_b16 v[58:59], v12 offset:18944
  v_mfma_f32_32x32x16_bf16 v[84:99], v[36:39], v[188:191], v[84:99]
  ds_read_b64_tr_b16 v[60:61], v13 offset:18432
  ds_read_b64_tr_b16 v[62:63], v13 offset:18944
  v_mfma_f32_32x32x16_bf16 v[100:115], v[40:43], v[188:191], v[100:115]
  ds_read_b64_tr_b16 v[64:65], v14 offset:33792
  ds_read_b64_tr_b16 v[66:67], v14 offset:34048
  s_cmp_lg_u32 s75, 3
  s_cbranch_scc1 L_skip_149
  s_call_b64 s[96:97], L_DMA
  v_mfma_f32_4x4x4_16b_bf16 v[116:119], v[16:17], v[32:33], v[116:119]
  v_mfma_f32_4x4x4_16b_bf16 v[120:123], v[16:17], v[36:37], v[120:123]
  v_mfma_f32_4x4x4_16b_bf16 v[26:29], v[16:17], v[40:41], v[26:29]
  v_mfma_f32_4x4x4_16b_bf16 v[116:119], v[16:17], v[34:35], v[116:119]
  v_mfma_f32_4x4x4_16b_bf16 v[120:123], v[16:17], v[38:39], v[120:123]
  v_mfma_f32_4x4x4_16b_bf16 v[26:29], v[16:17], v[42:43], v[26:29]
L_skip_149:
  s_waitcnt vmcnt(4)
  s_barrier
  s_lshl_b32 s90, s68, 10
  s_lshl_b32 s91, s71, 8
  s_add_u32 s90, s90, s91
  s_add_u32 s3, s90, 184320
  v_lshlrev_b32 v24, 3, v2
  buffer_load_dwordx2 v[18:19], v24, s[48:51], s3 offen sc1
  s_mov_b32 s24, 4
  s_lshl_b32 s23, s70, 10
  s_add_u32 s23, s23, 110592
  s_waitcnt lgkmcnt(7)
  v_mfma_f32_32x32x16_bf16 v[68:83], v[44:47], v[192:195], v[68:83]
  ds_read_b128 v[200:203], v10
  ds_read_b64_tr_b16 v[32:33], v12 offset:20480
  ds_read_b64_tr_b16 v[34:35], v12 offset:20992
  v_mfma_f32_32x32x16_bf16 v[84:99], v[48:51], v[192:195], v[84:99]
  ds_read_b64_tr_b16 v[36:37], v13 offset:20480
  ds_read_b64_tr_b16 v[38:39], v13 offset:20992
  v_mfma_f32_32x32x16_bf16 v[100:115], v[52:55], v[192:195], v[100:115]
  ds_read_b64_tr_b16 v[40:41], v14 offset:34816
  ds_read_b64_tr_b16 v[42:43], v14 offset:35072
  s_cmp_lg_u32 s75, 0
  s_cbranch_scc1 L_skip_150
  s_call_b64 s[96:97], L_DMA2
  v_mfma_f32_4x4x4_16b_bf16 v[116:119], v[16:17], v[44:45], v[116:119]
  v_mfma_f32_4x4x4_16b_bf16 v[120:123], v[16:17], v[48:49], v[120:123]
  v_mfma_f32_4x4x4_16b_bf16 v[26:29], v[16:17], v[52:53], v[26:29]
  v_mfma_f32_4x4x4_16b_bf16 v[116:119], v[16:17], v[46:47], v[116:119]
  v_mfma_f32_4x4x4_16b_bf16 v[120:123], v[16:17], v[50:51], v[120:123]
  v_mfma_f32_4x4x4_16b_bf16 v[26:29], v[16:17], v[54:55], v[26:29]
L_skip_150:
  s_waitcnt lgkmcnt(7)
  v_mfma_f32_32x32x16_bf16 v[68:83], v[56:59], v[196:199], v[68:83]
  ds_read_b128 v[204:207], v11
  ds_read_b64_tr_b16 v[44:45], v12 offset:22528
  ds_read_b64_tr_b16 v[46:47], v12 offset:23040
  v_mfma_f32_32x32x16_bf16 v[84:99], v[60:63], v[196:199], v[84:99]
  ds_read_b64_tr_b16 v[48:49], v13 offset:22528
  ds_read_b64_tr_b16 v[50:51], v13 offset:23040
  v_mfma_f32_32x32x16_bf16 v[100:115], v[64:67], v[196:199], v[100:115]
  ds_read_b64_tr_b16 v[52:53], v14 offset:35840
  ds_read_b64_tr_b16 v[54:55], v14 offset:36096
  s_cmp_lg_u32 s75, 1
  s_cbranch_scc1 L_skip_151
  s_call_b64 s[96:97], L_DMA2
  v_mfma_f32_4x4x4_16b_bf16 v[116:119], v[16:17], v[56:57], v[116:119]
  v_mfma_f32_4x4x4_16b_bf16 v[120:123], v[16:17], v[60:61], v[120:123]
  v_mfma_f32_4x4x4_16b_bf16 v[26:29], v[16:17], v[64:65], v[26:29]
  v_mfma_f32_4x4x4_16b_bf16 v[116:119], v[16:17], v[58:59], v[116:119]
  v_mfma_f32_4x4x4_16b_bf16 v[120:123], v[16:17], v[62:63], v[120:123]
  v_mfma_f32_4x4x4_16b_bf16 v[26:29], v[16:17], v[66:67], v[26:29]
L_skip_151:
  s_waitcnt lgkmcnt(7)
  v_mfma_f32_32x32x16_bf16 v[68:83], v[32:35], v[200:203], v[68:83]
  v_add_u32 v8, 36864, v8
  v_add_u32 v9, 36864, v9
  v_add_u32 v10, 36864, v10
  v_add_u32 v11, 36864, v11
  v_add_u32 v12, 36864, v12
  v_add_u32 v13, 36864, v13
  v_add_u32 v14, 36864, v14
  ds_read_b128 v[208:211], v8
  ds_read_b64_tr_b16 v[56:57], v12 offset:16384
  ds_read_b64_tr_b16 v[58:59], v12 offset:16896
  v_mfma_f32_32x32x16_bf16 v[84:99], v[36:39], v[200:203], v[84:99]
  ds_read_b64_tr_b16 v[60:61], v13 offset:16384
  ds_read_b64_tr_b16 v[62:63], v13 offset:16896
  v_mfma_f32_32x32x16_bf16 v[100:115], v[40:43], v[200:203], v[100:115]
  ds_read_b64_tr_b16 v[64:65], v14 offset:32768
  ds_read_b64_tr_b16 v[66:67], v14 offset:33024
  s_cmp_lg_u32 s75, 2
  s_cbranch_scc1 L_skip_152
  s_call_b64 s[96:97], L_DMA2
  v_mfma_f32_4x4x4_16b_bf16 v[116:119], v[16:17], v[32:33], v[116:119]
  v_mfma_f32_4x4x4_16b_bf16 v[120:123], v[16:17], v[36:37], v[120:123]
  v_mfma_f32_4x4x4_16b_bf16 v[26:29], v[16:17], v[40:41], v[26:29]
  v_mfma_f32_4x4x4_16b_bf16 v[116:119], v[16:17], v[34:35], v[116:119]
  v_mfma_f32_4x4x4_16b_bf16 v[120:123], v[16:17], v[38:39], v[120:123]
  v_mfma_f32_4x4x4_16b_bf16 v[26:29], v[16:17], v[42:43], v[26:29]
L_skip_152:
  s_waitcnt lgkmcnt(7)
  v_mfma_f32_32x32x16_bf16 v[68:83], v[44:47], v[204:207], v[68:83]
  ds_read_b128 v[212:215], v9
  ds_read_b64_tr_b16 v[32:33], v12 offset:18432
  ds_read_b64_tr_b16 v[34:35], v12 offset:18944
  v_mfma_f32_32x32x16_bf16 v[84:99], v[48:51], v[204:207], v[84:99]
  ds_read_b64_tr_b16 v[36:37], v13 offset:18432
  ds_read_b64_tr_b16 v[38:39], v13 offset:18944
  v_mfma_f32_32x32x16_bf16 v[100:115], v[52:55], v[204:207], v[100:115]
  ds_read_b64_tr_b16 v[40:41], v14 offset:33792
  ds_read_b64_tr_b16 v[42:43], v14 offset:34048
  s_cmp_lg_u32 s75, 3
  s_cbranch_scc1 L_skip_153
  s_call_b64 s[96:97], L_DMA2
  v_mfma_f32_4x4x4_16b_bf16 v[116:119], v[16:17], v[44:45], v[116:119]
  v_mfma_f32_4x4x4_16b_bf16 v[120:123], v[16:17], v[48:49], v[120:123]
  v_mfma_f32_4x4x4_16b_bf16 v[26:29], v[16:17], v[52:53], v[26:29]
  v_mfma_f32_4x4x4_16b_bf16 v[116:119], v[16:17], v[46:47], v[116:119]
  v_mfma_f32_4x4x4_16b_bf16 v[120:123], v[16:17], v[50:51], v[120:123]
  v_mfma_f32_4x4x4_16b_bf16 v[26:29], v[16:17], v[54:55], v[26:29]
L_skip_153:
  s_waitcnt vmcnt(5)
  s_barrier
  s_mov_b32 s24, 3
  s_lshl_b32 s23, s70, 10
  s_waitcnt lgkmcnt(7)
  v_mfma_f32_32x32x16_bf16 v[68:83], v[56:59], v[208:211], v[68:83]
  ds_read_b128 v[216:219], v10
  ds_read_b64_tr_b16 v[44:45], v12 offset:20480
  ds_read_b64_tr_b16 v[46:47], v12 offset:20992
  v_mfma_f32_32x32x16_bf16 v[84:99], v[60:63], v[208:211], v[84:99]
  ds_read_b64_tr_b16 v[48:49], v13 offset:20480
  ds_read_b64_tr_b16 v[50:51], v13 offset:20992
  v_mfma_f32_32x32x16_bf16 v[100:115], v[64:67], v[208:211], v[100:115]
  ds_read_b64_tr_b16 v[52:53], v14 offset:34816
  ds_read_b64_tr_b16 v[54:55], v14 offset:35072
  s_cmp_lg_u32 s75, 0
  s_cbranch_scc1 L_skip_154
  s_call_b64 s[96:97], L_DMA2
  v_mfma_f32_4x4x4_16b_bf16 v[116:119], v[16:17], v[56:57], v[116:119]
  v_mfma_f32_4x4x4_16b_bf16 v[120:123], v[16:17], v[60:61], v[120:123]
  v_mfma_f32_4x4x4_16b_bf16 v[26:29], v[16:17], v[64:65], v[26:29]
  v_mfma_f32_4x4x4_16b_bf16 v[116:119], v[16:17], v[58:59], v[116:119]
  v_mfma_f32_4x4x4_16b_bf16 v[120:123], v[16:17], v[62:63], v[120:123]
  v_mfma_f32_4x4x4_16b_bf16 v[26:29], v[16:17], v[66:67], v[26:29]
L_skip_154:
  s_waitcnt lgkmcnt(7)
  v_mfma_f32_32x32x16_bf16 v[68:83], v[32:35], v[212:215], v[68:83]
  ds_read_b128 v[220:223], v11
  ds_read_b64_tr_b16 v[56:57], v12 offset:22528
  ds_read_b64_tr_b16 v[58:59], v12 offset:23040
  v_mfma_f32_32x32x16_bf16 v[84:99], v[36:39], v[212:215], v[84:99]
  ds_read_b64_tr_b16 v[60:61], v13 offset:22528
  ds_read_b64_tr_b16 v[62:63], v13 offset:23040
  v_mfma_f32_32x32x16_bf16 v[100:115], v[40:43], v[212:215], v[100:115]
  ds_read_b64_tr_b16 v[64:65], v14 offset:35840
  ds_read_b64_tr_b16 v[66:67], v14 offset:36096
  s_cmp_lg_u32 s75, 1
  s_cbranch_scc1 L_skip_155
  s_call_b64 s[96:97], L_DMA2
  v_mfma_f32_4x4x4_16b_bf16 v[116:119], v[16:17], v[32:33], v[116:119]
  v_mfma_f32_4x4x4_16b_bf16 v[120:123], v[16:17], v[36:37], v[120:123]
  v_mfma_f32_4x4x4_16b_bf16 v[26:29], v[16:17], v[40:41], v[26:29]
  v_mfma_f32_4x4x4_16b_bf16 v[116:119], v[16:17], v[34:35], v[116:119]
  v_mfma_f32_4x4x4_16b_bf16 v[120:123], v[16:17], v[38:39], v[120:123]
  v_mfma_f32_4x4x4_16b_bf16 v[26:29], v[16:17], v[42:43], v[26:29]
L_skip_155:
  s_waitcnt lgkmcnt(7)
  v_mfma_f32_32x32x16_bf16 v[68:83], v[44:47], v[216:219], v[68:83]
  v_add_u32 v8, 36864, v8
  v_add_u32 v9, 36864, v9
  v_add_u32 v10, 36864, v10
  v_add_u32 v11, 36864, v11
  v_add_u32 v12, 36864, v12
  v_add_u32 v13, 36864, v13
  v_add_u32 v14, 36864, v14
  ds_read_b128 v[224:227], v8
  ds_read_b64_tr_b16 v[32:33], v12 offset:16384
  ds_read_b64_tr_b16 v[34:35], v12 offset:16896
  v_mfma_f32_32x32x16_bf16 v[84:99], v[48:51], v[216:219], v[84:99]
  ds_read_b64_tr_b16 v[36:37], v13 offset:16384
  ds_read_b64_tr_b16 v[38:39], v13 offset:16896
  v_mfma_f32_32x32x16_bf16 v[100:115], v[52:55], v[216:219], v[100:115]
  ds_read_b64_tr_b16 v[40:41], v14 offset:32768
  ds_read_b64_tr_b16 v[42:43], v14 offset:33024
  s_cmp_lg_u32 s75, 2
  s_cbranch_scc1 L_skip_156
  s_call_b64 s[96:97], L_DMA2
  v_mfma_f32_4x4x4_16b_bf16 v[116:119], v[16:17], v[44:45], v[116:119]
  v_mfma_f32_4x4x4_16b_bf16 v[120:123], v[16:17], v[48:49], v[120:123]
  v_mfma_f32_4x4x4_16b_bf16 v[26:29], v[16:17], v[52:53], v[26:29]
  v_mfma_f32_4x4x4_16b_bf16 v[116:119], v[16:17], v[46:47], v[116:119]
  v_mfma_f32_4x4x4_16b_bf16 v[120:123], v[16:17], v[50:51], v[120:123]
  v_mfma_f32_4x4x4_16b_bf16 v[26:29], v[16:17], v[54:55], v[26:29]
L_skip_156:
  s_waitcnt lgkmcnt(7)
  v_mfma_f32_32x32x16_bf16 v[68:83], v[56:59], v[220:223], v[68:83]
  ds_read_b128 v[228:231], v9
  ds_read_b64_tr_b16 v[44:45], v12 offset:18432
  ds_read_b64_tr_b16 v[46:47], v12 offset:18944
  v_mfma_f32_32x32x16_bf16 v[84:99], v[60:63], v[220:223], v[84:99]
  ds_read_b64_tr_b16 v[48:49], v13 offset:18432
  ds_read_b64_tr_b16 v[50:51], v13 offset:18944
  v_mfma_f32_32x32x16_bf16 v[100:115], v[64:67], v[220:223], v[100:115]
  ds_read_b64_tr_b16 v[52:53], v14 offset:33792
  ds_read_b64_tr_b16 v[54:55], v14 offset:34048
  s_cmp_lg_u32 s75, 3
  s_cbranch_scc1 L_skip_157
  s_call_b64 s[96:97], L_DMA2
  v_mfma_f32_4x4x4_16b_bf16 v[116:119], v[16:17], v[56:57], v[116:119]
  v_mfma_f32_4x4x4_16b_bf16 v[120:123], v[16:17], v[60:61], v[120:123]
  v_mfma_f32_4x4x4_16b_bf16 v[26:29], v[16:17], v[64:65], v[26:29]
  v_mfma_f32_4x4x4_16b_bf16 v[116:119], v[16:17], v[58:59], v[116:119]
  v_mfma_f32_4x4x4_16b_bf16 v[120:123], v[16:17], v[62:63], v[120:123]
  v_mfma_f32_4x4x4_16b_bf16 v[26:29], v[16:17], v[66:67], v[26:29]
L_skip_157:
  s_barrier
  s_waitcnt lgkmcnt(7)
  v_mfma_f32_32x32x16_bf16 v[68:83], v[32:35], v[224:227], v[68:83]
  ds_read_b128 v[232:235], v10
  ds_read_b64_tr_b16 v[56:57], v12 offset:20480
  ds_read_b64_tr_b16 v[58:59], v12 offset:20992
  v_mfma_f32_32x32x16_bf16 v[84:99], v[36:39], v[224:227], v[84:99]
  ds_read_b64_tr_b16 v[60:61], v13 offset:20480
  ds_read_b64_tr_b16 v[62:63], v13 offset:20992
  v_mfma_f32_32x32x16_bf16 v[100:115], v[40:43], v[224:227], v[100:115]
  ds_read_b64_tr_b16 v[64:65], v14 offset:34816
  ds_read_b64_tr_b16 v[66:67], v14 offset:35072
  s_cmp_lg_u32 s75, 0
  s_cbranch_scc1 L_skip_158
  v_mfma_f32_4x4x4_16b_bf16 v[116:119], v[16:17], v[32:33], v[116:119]
  v_mfma_f32_4x4x4_16b_bf16 v[120:123], v[16:17], v[36:37], v[120:123]
  v_mfma_f32_4x4x4_16b_bf16 v[26:29], v[16:17], v[40:41], v[26:29]
  v_mfma_f32_4x4x4_16b_bf16 v[116:119], v[16:17], v[34:35], v[116:119]
  v_mfma_f32_4x4x4_16b_bf16 v[120:123], v[16:17], v[38:39], v[120:123]
  v_mfma_f32_4x4x4_16b_bf16 v[26:29], v[16:17], v[42:43], v[26:29]
L_skip_158:
  s_waitcnt lgkmcnt(7)
  v_mfma_f32_32x32x16_bf16 v[68:83], v[44:47], v[228:231], v[68:83]
  ds_read_b128 v[236:239], v11
  ds_read_b64_tr_b16 v[32:33], v12 offset:22528
  ds_read_b64_tr_b16 v[34:35], v12 offset:23040
  v_mfma_f32_32x32x16_bf16 v[84:99], v[48:51], v[228:231], v[84:99]
  ds_read_b64_tr_b16 v[36:37], v13 offset:22528
  ds_read_b64_tr_b16 v[38:39], v13 offset:23040
  v_mfma_f32_32x32x16_bf16 v[100:115], v[52:55], v[228:231], v[100:115]
  ds_read_b64_tr_b16 v[40:41], v14 offset:35840
  ds_read_b64_tr_b16 v[42:43], v14 offset:36096
  s_cmp_lg_u32 s75, 1
  s_cbranch_scc1 L_skip_159
  v_mfma_f32_4x4x4_16b_bf16 v[116:119], v[16:17], v[44:45], v[116:119]
  v_mfma_f32_4x4x4_16b_bf16 v[120:123], v[16:17], v[48:49], v[120:123]
  v_mfma_f32_4x4x4_16b_bf16 v[26:29], v[16:17], v[52:53], v[26:29]
  v_mfma_f32_4x4x4_16b_bf16 v[116:119], v[16:17], v[46:47], v[116:119]
  v_mfma_f32_4x4x4_16b_bf16 v[120:123], v[16:17], v[50:51], v[120:123]
  v_mfma_f32_4x4x4_16b_bf16 v[26:29], v[16:17], v[54:55], v[26:29]
L_skip_159:
  s_waitcnt lgkmcnt(7)
  v_mfma_f32_32x32x16_bf16 v[68:83], v[56:59], v[232:235], v[68:83]
  v_mfma_f32_32x32x16_bf16 v[84:99], v[60:63], v[232:235], v[84:99]
  v_mfma_f32_32x32x16_bf16 v[100:115], v[64:67], v[232:235], v[100:115]
  s_cmp_lg_u32 s75, 2
  s_cbranch_scc1 L_skip_160
  v_mfma_f32_4x4x4_16b_bf16 v[116:119], v[16:17], v[56:57], v[116:119]
  v_mfma_f32_4x4x4_16b_bf16 v[120:123], v[16:17], v[60:61], v[120:123]
  v_mfma_f32_4x4x4_16b_bf16 v[26:29], v[16:17], v[64:65], v[26:29]
  v_mfma_f32_4x4x4_16b_bf16 v[116:119], v[16:17], v[58:59], v[116:119]
  v_mfma_f32_4x4x4_16b_bf16 v[120:123], v[16:17], v[62:63], v[120:123]
  v_mfma_f32_4x4x4_16b_bf16 v[26:29], v[16:17], v[66:67], v[26:29]
L_skip_160:
  s_waitcnt lgkmcnt(0)
  v_mfma_f32_32x32x16_bf16 v[68:83], v[32:35], v[236:239], v[68:83]
  v_mfma_f32_32x32x16_bf16 v[84:99], v[36:39], v[236:239], v[84:99]
  v_mfma_f32_32x32x16_bf16 v[100:115], v[40:43], v[236:239], v[100:115]
  s_cmp_lg_u32 s75, 3
  s_cbranch_scc1 L_skip_161
  v_mfma_f32_4x4x4_16b_bf16 v[116:119], v[16:17], v[32:33], v[116:119]
  v_mfma_f32_4x4x4_16b_bf16 v[120:123], v[16:17], v[36:37], v[120:123]
  v_mfma_f32_4x4x4_16b_bf16 v[26:29], v[16:17], v[40:41], v[26:29]
  v_mfma_f32_4x4x4_16b_bf16 v[116:119], v[16:17], v[34:35], v[116:119]
  v_mfma_f32_4x4x4_16b_bf16 v[120:123], v[16:17], v[38:39], v[120:123]
  v_mfma_f32_4x4x4_16b_bf16 v[26:29], v[16:17], v[42:43], v[26:29]
L_skip_161:
  s_nop 4
  s_lshl_b32 s90, s71, 2
  v_lshlrev_b32 v125, 4, v2
  v_add_u32 v125, s90, v125
  v_add_u32 v125, 152320, v125
  v_mov_b32 v124, v116
  s_nop 1
  v_permlane32_swap_b32 v116, v124
  v_add_f32 v116, v116, v124
  ds_write_b32 v125, v116 offset:0
  v_mov_b32 v124, v120
  s_nop 1
  v_permlane32_swap_b32 v120, v124
  v_add_f32 v120, v120, v124
  ds_write_b32 v125, v120 offset:512
  v_mov_b32 v124, v26
  s_nop 1
  v_permlane32_swap_b32 v26, v124
  v_add_f32 v26, v26, v124
  ds_write_b32 v125, v26 offset:2048
  s_waitcnt lgkmcnt(0)
  s_waitcnt vmcnt(0)
  s_barrier
  s_mul_i32 s90, s70, 384
  v_lshlrev_b32 v8, 4, v3
  v_add_u32 v8, s90, v8
  v_add_u32 v8, 155904, v8
  v_lshlrev_b32 v125, 4, v2
  v_add_u32 v125, 152320, v125
  ds_read_b128 v[116:119], v125 offset:0
  ds_read_b128 v[120:123], v125 offset:512
  ds_read_b128 v[26:29], v125 offset:2048
  s_mul_i32 s90, s70, 384
  v_lshlrev_b32 v124, 2, v2
  v_add_u32 v124, s90, v124
  v_add_u32 v124, 155904, v124
  s_waitcnt lgkmcnt(2)
  v_add_f32 v116, v116, v117
  v_add_f32 v118, v118, v119
  v_add_f32 v116, v116, v118
  ds_write_b32 v124, v116 offset:0
  s_waitcnt lgkmcnt(2)
  v_add_f32 v120, v120, v121
  v_add_f32 v122, v122, v123
  v_add_f32 v120, v120, v122
  ds_write_b32 v124, v120 offset:128
  s_waitcnt lgkmcnt(2)
  v_add_f32 v26, v26, v27
  v_add_f32 v28, v28, v29
  v_add_f32 v26, v26, v28
  ds_write_b32 v124, v26 offset:256
  s_waitcnt lgkmcnt(0)
  s_mov_b32 s95, 0
L_gr_162:
  v_cmp_ne_u32 vcc, s74, v19
  s_add_u32 s95, s95, 1
  s_cmp_eq_u64 vcc, 0
  s_cbranch_scc1 L_grdone_163
  buffer_load_dwordx2 v[18:19], v24, s[48:51], s3 offen sc1
  s_waitcnt vmcnt(0)
  s_cmp_lt_u32 s95, 0x20000
  s_cbranch_scc1 L_gr_162
L_grdone_163:
  v_and_b32 v30, s6, v18
  v_lshlrev_b32 v124, 16, v18
  v_xor_b32 v30, 0x80000000, v30
  v_rcp_f32 v31, v124
  v_lshrrev_b32 v124, 4, v1
  v_and_b32 v124, 1, v124
  v_lshlrev_b32 v124, 5, v124
  v_and_b32 v125, 3, v1
  v_lshl_add_u32 v124, v125, 3, v124
  v_lshlrev_b32 v125, 3, v1
  v_and_b32 v125, 64, v125
  v_xor_b32 v124, v124, v125
  v_lshrrev_b32 v125, 2, v1
  v_and_b32 v125, 3, v125
  v_mad_u32_u24 v15, v3, 8, v125
  v_lshl_add_u32 v15, v15, 7, v124
  v_add_u32 v12, 110592, v15
  v_mov_b32 v26, 0
  v_mov_b32 v27, 0
  v_mov_b32 v28, 0
  v_mov_b32 v29, 0
  ds_read_b64_tr_b16 v[32:33], v12 offset:0
  ds_read_b64_tr_b16 v[34:35], v12 offset:512
  ds_read_b64_tr_b16 v[36:37], v12 offset:2048
  ds_read_b64_tr_b16 v[38:39], v12 offset:2560
  ds_read_b64_tr_b16 v[40:41], v12 offset:4096
  ds_read_b64_tr_b16 v[42:43], v12 offset:4608
  v_lshlrev_b32 v9, 4, v3
  v_add_u32 v9, 151680, v9
  v_lshlrev_b32 v10, 4, v1
  ds_read_b128 v[48:51], v8 offset:0
  ds_read_b128 v[52:55], v8 offset:32
  ds_read_b128 v[56:59], v9 offset:0
  ds_read_b128 v[60:63], v9 offset:32
  s_waitcnt lgkmcnt(2)
  v_fma_f32 v68, v48, v30, v68
  v_fma_f32 v69, v49, v30, v69
  v_mfma_f32_32x32x16_bf16 v[240:255], v[32:35], v[128:131], 0
  s_cmp_lg_u32 s71, 0
  s_cbranch_scc1 L_skip_164
  v_mfma_f32_4x4x4_16b_bf16 v[26:29], v[16:17], v[32:33], v[26:29]
  s_nop 1
  v_mfma_f32_4x4x4_16b_bf16 v[26:29], v[16:17], v[34:35], v[26:29]
L_skip_164:
  ds_read_b64_tr_b16 v[44:45], v12 offset:6144
  ds_read_b64_tr_b16 v[46:47], v12 offset:6656
  v_fma_f32 v70, v50, v30, v70
  v_fma_f32 v71, v51, v30, v71
  v_fma_f32 v72, v52, v30, v72
  v_fma_f32 v73, v53, v30, v73
  v_fma_f32 v74, v54, v30, v74
  v_fma_f32 v75, v55, v30, v75
  ds_read_b128 v[48:51], v8 offset:64
  ds_read_b128 v[52:55], v8 offset:96
  s_waitcnt lgkmcnt(4)
  v_fma_f32 v68, v68, v31, v56
  v_fma_f32 v69, v69, v31, v57
  v_mfma_f32_32x32x16_bf16 v[240:255], v[36:39], v[132:135], v[240:255]
  s_cmp_lg_u32 s71, 1
  s_cbranch_scc1 L_skip_165
  v_mfma_f32_4x4x4_16b_bf16 v[26:29], v[16:17], v[36:37], v[26:29]
  s_nop 1
  v_mfma_f32_4x4x4_16b_bf16 v[26:29], v[16:17], v[38:39], v[26:29]
L_skip_165:
  ds_read_b64_tr_b16 v[32:33], v12 offset:8192
  ds_read_b64_tr_b16 v[34:35], v12 offset:8704
  s_lshr_b32 s92, s2, 3
  s_mul_i32 s93, s92, 50176
  s_mul_i32 s94, s70, 6272
  s_add_u32 s80, s93, s94
  s_mul_i32 s93, s92, 12544
  s_mul_i32 s94, s70, 1568
  s_add_u32 s81, s93, s94
  v_lshlrev_b32 v6, 4, v1
  v_fma_f32 v70, v70, v31, v58
  v_fma_f32 v71, v71, v31, v59
  v_fma_f32 v72, v72, v31, v60
  v_fma_f32 v73, v73, v31, v61
  v_fma_f32 v74, v74, v31, v62
  v_fma_f32 v75, v75, v31, v63
  ds_read_b128 v[56:59], v9 offset:64
  ds_read_b128 v[60:63], v9 offset:96
  v_max_f32 v68, 0, v68
  v_max_f32 v69, 0, v69
  v_mfma_f32_32x32x16_bf16 v[240:255], v[40:43], v[136:139], v[240:255]
  s_cmp_lg_u32 s71, 2
  s_cbranch_scc1 L_skip_166
  v_mfma_f32_4x4x4_16b_bf16 v[26:29], v[16:17], v[40:41], v[26:29]
  s_nop 1
  v_mfma_f32_4x4x4_16b_bf16 v[26:29], v[16:17], v[42:43], v[26:29]
L_skip_166:
  ds_read_b64_tr_b16 v[36:37], v12 offset:10240
  ds_read_b64_tr_b16 v[38:39], v12 offset:10752
  v_max_f32 v70, 0, v70
  v_max_f32 v71, 0, v71
  v_max_f32 v72, 0, v72
  v_max_f32 v73, 0, v73
  v_max_f32 v74, 0, v74
  v_max_f32 v75, 0, v75
  v_mul_f32 v68, v68, v68
  v_mul_f32 v69, v69, v69
  s_waitcnt lgkmcnt(8)
  v_mfma_f32_32x32x16_bf16 v[240:255], v[44:47], v[140:143], v[240:255]
  s_cmp_lg_u32 s71, 3
  s_cbranch_scc1 L_skip_167
  v_mfma_f32_4x4x4_16b_bf16 v[26:29], v[16:17], v[44:45], v[26:29]
  s_nop 1
  v_mfma_f32_4x4x4_16b_bf16 v[26:29], v[16:17], v[46:47], v[26:29]
L_skip_167:
  ds_read_b64_tr_b16 v[40:41], v12 offset:12288
  ds_read_b64_tr_b16 v[42:43], v12 offset:12800
  v_mul_f32 v70, v70, v70
  v_mul_f32 v71, v71, v71
  v_mul_f32 v72, v72, v72
  v_mul_f32 v73, v73, v73
  v_mul_f32 v74, v74, v74
  v_mul_f32 v75, v75, v75
  v_cvt_pk_bf16_f32 v68, v68, v69
  v_cvt_pk_bf16_f32 v69, v70, v71
  s_waitcnt lgkmcnt(6)
  v_mfma_f32_32x32x16_bf16 v[240:255], v[32:35], v[144:147], v[240:255]
  s_cmp_lg_u32 s71, 0
  s_cbranch_scc1 L_skip_168
  v_mfma_f32_4x4x4_16b_bf16 v[26:29], v[16:17], v[32:33], v[26:29]
  s_nop 1
  v_mfma_f32_4x4x4_16b_bf16 v[26:29], v[16:17], v[34:35], v[26:29]
L_skip_168:
  ds_read_b64_tr_b16 v[44:45], v12 offset:14336
  ds_read_b64_tr_b16 v[46:47], v12 offset:14848
  s_add_u32 s82, s80, 0
  s_mov_b32 m0, 160000
  s_nop 0
  buffer_load_dwordx4 v6, s[40:43], s82 offen lds
  v_cvt_pk_bf16_f32 v70, v72, v73
  v_cvt_pk_bf16_f32 v71, v74, v75
  s_lshl_b32 s90, s12, 10
  s_add_u32 s90, s90, s15
  buffer_store_dwordx4 v[68:71], v10, s[48:51], s90 offen offset:0 sc1
  v_fma_f32 v76, v48, v30, v76
  v_fma_f32 v77, v49, v30, v77
  v_fma_f32 v78, v50, v30, v78
  v_fma_f32 v79, v51, v30, v79
  v_fma_f32 v80, v52, v30, v80
  s_waitcnt lgkmcnt(4)
  v_mfma_f32_32x32x16_bf16 v[240:255], v[36:39], v[148:151], v[240:255]
  s_cmp_lg_u32 s71, 1
  s_cbranch_scc1 L_skip_169
  v_mfma_f32_4x4x4_16b_bf16 v[26:29], v[16:17], v[36:37], v[26:29]
  s_nop 1
  v_mfma_f32_4x4x4_16b_bf16 v[26:29], v[16:17], v[38:39], v[26:29]
L_skip_169:
  ds_read_b64_tr_b16 v[32:33], v12 offset:16384
  ds_read_b64_tr_b16 v[34:35], v12 offset:16896
  v_fma_f32 v81, v53, v30, v81
  v_fma_f32 v82, v54, v30, v82
  v_fma_f32 v83, v55, v30, v83
  ds_read_b128 v[48:51], v8 offset:128
  ds_read_b128 v[52:55], v8 offset:160
  v_fma_f32 v76, v76, v31, v56
  v_fma_f32 v77, v77, v31, v57
  v_fma_f32 v78, v78, v31, v58
  v_fma_f32 v79, v79, v31, v59
  s_waitcnt lgkmcnt(6)
  v_mfma_f32_32x32x16_bf16 v[240:255], v[40:43], v[152:155], v[240:255]
  s_cmp_lg_u32 s71, 2
  s_cbranch_scc1 L_skip_170
  v_mfma_f32_4x4x4_16b_bf16 v[26:29], v[16:17], v[40:41], v[26:29]
  s_nop 1
  v_mfma_f32_4x4x4_16b_bf16 v[26:29], v[16:17], v[42:43], v[26:29]
L_skip_170:
  ds_read_b64_tr_b16 v[36:37], v12 offset:18432
  ds_read_b64_tr_b16 v[38:39], v12 offset:18944
  v_fma_f32 v80, v80, v31, v60
  v_fma_f32 v81, v81, v31, v61
  v_fma_f32 v82, v82, v31, v62
  v_fma_f32 v83, v83, v31, v63
  ds_read_b128 v[56:59], v9 offset:128
  ds_read_b128 v[60:63], v9 offset:160
  v_max_f32 v76, 0, v76
  v_max_f32 v77, 0, v77
  v_max_f32 v78, 0, v78
  v_max_f32 v79, 0, v79
  s_waitcnt lgkmcnt(8)
  v_mfma_f32_32x32x16_bf16 v[240:255], v[44:47], v[156:159], v[240:255]
  s_cmp_lg_u32 s71, 3
  s_cbranch_scc1 L_skip_171
  v_mfma_f32_4x4x4_16b_bf16 v[26:29], v[16:17], v[44:45], v[26:29]
  s_nop 1
  v_mfma_f32_4x4x4_16b_bf16 v[26:29], v[16:17], v[46:47], v[26:29]
L_skip_171:
  ds_read_b64_tr_b16 v[40:41], v12 offset:20480
  ds_read_b64_tr_b16 v[42:43], v12 offset:20992
  s_add_u32 s82, s80, 1024
  s_mov_b32 m0, 160000
  s_nop 0
  buffer_load_dwordx4 v6, s[40:43], s82 offen lds
  v_max_f32 v80, 0, v80
  v_max_f32 v81, 0, v81
  v_max_f32 v82, 0, v82
  v_max_f32 v83, 0, v83
  v_mul_f32 v76, v76, v76
  v_mul_f32 v77, v77, v77
  v_mul_f32 v78, v78, v78
  v_mul_f32 v79, v79, v79
  s_waitcnt lgkmcnt(8)
  v_mfma_f32_32x32x16_bf16 v[240:255], v[32:35], v[160:163], v[240:255]
  s_cmp_lg_u32 s71, 0
  s_cbranch_scc1 L_skip_172
  v_mfma_f32_4x4x4_16b_bf16 v[26:29], v[16:17], v[32:33], v[26:29]
  s_nop 1
  v_mfma_f32_4x4x4_16b_bf16 v[26:29], v[16:17], v[34:35], v[26:29]
L_skip_172:
  ds_read_b64_tr_b16 v[44:45], v12 offset:22528
  ds_read_b64_tr_b16 v[46:47], v12 offset:23040
  v_mul_f32 v80, v80, v80
  v_mul_f32 v81, v81, v81
  v_mul_f32 v82, v82, v82
  v_mul_f32 v83, v83, v83
  v_cvt_pk_bf16_f32 v72, v76, v77
  v_cvt_pk_bf16_f32 v73, v78, v79
  v_cvt_pk_bf16_f32 v74, v80, v81
  v_cvt_pk_bf16_f32 v75, v82, v83
  s_waitcnt lgkmcnt(6)
  v_mfma_f32_32x32x16_bf16 v[240:255], v[36:39], v[164:167], v[240:255]
  s_cmp_lg_u32 s71, 1
  s_cbranch_scc1 L_skip_173
  v_mfma_f32_4x4x4_16b_bf16 v[26:29], v[16:17], v[36:37], v[26:29]
  s_nop 1
  v_mfma_f32_4x4x4_16b_bf16 v[26:29], v[16:17], v[38:39], v[26:29]
L_skip_173:
  ds_read_b64_tr_b16 v[32:33], v12 offset:24576
  ds_read_b64_tr_b16 v[34:35], v12 offset:25088
  s_lshl_b32 s90, s12, 10
  s_add_u32 s90, s90, s15
  buffer_store_dwordx4 v[72:75], v10, s[48:51], s90 offen offset:1024 sc1
  v_fma_f32 v84, v48, v30, v84
  v_fma_f32 v85, v49, v30, v85
  v_fma_f32 v86, v50, v30, v86
  v_fma_f32 v87, v51, v30, v87
  v_fma_f32 v88, v52, v30, v88
  v_fma_f32 v89, v53, v30, v89
  v_fma_f32 v90, v54, v30, v90
  s_waitcnt lgkmcnt(4)
  v_mfma_f32_32x32x16_bf16 v[240:255], v[40:43], v[168:171], v[240:255]
  s_cmp_lg_u32 s71, 2
  s_cbranch_scc1 L_skip_174
  v_mfma_f32_4x4x4_16b_bf16 v[26:29], v[16:17], v[40:41], v[26:29]
  s_nop 1
  v_mfma_f32_4x4x4_16b_bf16 v[26:29], v[16:17], v[42:43], v[26:29]
L_skip_174:
  ds_read_b64_tr_b16 v[36:37], v12 offset:26624
  ds_read_b64_tr_b16 v[38:39], v12 offset:27136
  s_add_u32 s82, s80, 2048
  s_mov_b32 m0, 160000
  s_nop 0
  buffer_load_dwordx4 v6, s[40:43], s82 offen lds
  v_fma_f32 v91, v55, v30, v91
  ds_read_b128 v[48:51], v8 offset:192
  ds_read_b128 v[52:55], v8 offset:224
  v_fma_f32 v84, v84, v31, v56
  v_fma_f32 v85, v85, v31, v57
  v_fma_f32 v86, v86, v31, v58
  v_fma_f32 v87, v87, v31, v59
  v_fma_f32 v88, v88, v31, v60
  v_fma_f32 v89, v89, v31, v61
  v_fma_f32 v90, v90, v31, v62
  s_waitcnt lgkmcnt(6)
  v_mfma_f32_32x32x16_bf16 v[240:255], v[44:47], v[172:175], v[240:255]
  s_cmp_lg_u32 s71, 3
  s_cbranch_scc1 L_skip_175
  v_mfma_f32_4x4x4_16b_bf16 v[26:29], v[16:17], v[44:45], v[26:29]
  s_nop 1
  v_mfma_f32_4x4x4_16b_bf16 v[26:29], v[16:17], v[46:47], v[26:29]
L_skip_175:
  ds_read_b64_tr_b16 v[40:41], v12 offset:28672
  ds_read_b64_tr_b16 v[42:43], v12 offset:29184
  v_fma_f32 v91, v91, v31, v63
  ds_read_b128 v[56:59], v9 offset:192
  ds_read_b128 v[60:63], v9 offset:224
  v_max_f32 v84, 0, v84
  v_max_f32 v85, 0, v85
  v_max_f32 v86, 0, v86
  v_max_f32 v87, 0, v87
  v_max_f32 v88, 0, v88
  v_max_f32 v89, 0, v89
  v_max_f32 v90, 0, v90
  s_waitcnt lgkmcnt(8)
  v_mfma_f32_32x32x16_bf16 v[240:255], v[32:35], v[176:179], v[240:255]
  s_cmp_lg_u32 s71, 0
  s_cbranch_scc1 L_skip_176
  v_mfma_f32_4x4x4_16b_bf16 v[26:29], v[16:17], v[32:33], v[26:29]
  s_nop 1
  v_mfma_f32_4x4x4_16b_bf16 v[26:29], v[16:17], v[34:35], v[26:29]
L_skip_176:
  ds_read_b64_tr_b16 v[44:45], v12 offset:30720
  ds_read_b64_tr_b16 v[46:47], v12 offset:31232
  v_max_f32 v91, 0, v91
  v_mul_f32 v84, v84, v84
  v_mul_f32 v85, v85, v85
  v_mul_f32 v86, v86, v86
  v_mul_f32 v87, v87, v87
  v_mul_f32 v88, v88, v88
  v_mul_f32 v89, v89, v89
  v_mul_f32 v90, v90, v90
  s_waitcnt lgkmcnt(8)
  v_mfma_f32_32x32x16_bf16 v[240:255], v[36:39], v[180:183], v[240:255]
  s_cmp_lg_u32 s71, 1
  s_cbranch_scc1 L_skip_177
  v_mfma_f32_4x4x4_16b_bf16 v[26:29], v[16:17], v[36:37], v[26:29]
  s_nop 1
  v_mfma_f32_4x4x4_16b_bf16 v[26:29], v[16:17], v[38:39], v[26:29]
L_skip_177:
  ds_read_b64_tr_b16 v[32:33], v15 offset:0
  ds_read_b64_tr_b16 v[34:35], v15 offset:512
  s_add_u32 s82, s80, 3072
  s_mov_b32 m0, 160000
  s_nop 0
  buffer_load_dwordx4 v6, s[40:43], s82 offen lds
  v_mul_f32 v91, v91, v91
  v_cvt_pk_bf16_f32 v84, v84, v85
  v_cvt_pk_bf16_f32 v85, v86, v87
  v_cvt_pk_bf16_f32 v86, v88, v89
  v_cvt_pk_bf16_f32 v87, v90, v91
  s_lshl_b32 s90, s13, 10
  s_add_u32 s90, s90, s15
  buffer_store_dwordx4 v[84:87], v10, s[48:51], s90 offen offset:0 sc1
  s_waitcnt lgkmcnt(8)
  v_fma_f32 v92, v48, v30, v92
  v_fma_f32 v93, v49, v30, v93
  s_waitcnt lgkmcnt(6)
  v_mfma_f32_32x32x16_bf16 v[240:255], v[40:43], v[184:187], v[240:255]
  s_cmp_lg_u32 s71, 2
  s_cbranch_scc1 L_skip_178
  v_mfma_f32_4x4x4_16b_bf16 v[26:29], v[16:17], v[40:41], v[26:29]
  s_nop 1
  v_mfma_f32_4x4x4_16b_bf16 v[26:29], v[16:17], v[42:43], v[26:29]
L_skip_178:
  ds_read_b64_tr_b16 v[36:37], v15 offset:2048
  ds_read_b64_tr_b16 v[38:39], v15 offset:2560
  v_fma_f32 v94, v50, v30, v94
  v_fma_f32 v95, v51, v30, v95
  v_fma_f32 v96, v52, v30, v96
  v_fma_f32 v97, v53, v30, v97
  v_fma_f32 v98, v54, v30, v98
  v_fma_f32 v99, v55, v30, v99
  ds_read_b128 v[48:51], v8 offset:256
  ds_read_b128 v[52:55], v8 offset:288
  s_waitcnt lgkmcnt(8)
  v_fma_f32 v92, v92, v31, v56
  v_fma_f32 v93, v93, v31, v57
  s_waitcnt lgkmcnt(6)
  v_mfma_f32_32x32x16_bf16 v[240:255], v[44:47], v[188:191], v[240:255]
  s_cmp_lg_u32 s71, 3
  s_cbranch_scc1 L_skip_179
  v_mfma_f32_4x4x4_16b_bf16 v[26:29], v[16:17], v[44:45], v[26:29]
  s_nop 1
  v_mfma_f32_4x4x4_16b_bf16 v[26:29], v[16:17], v[46:47], v[26:29]
L_skip_179:
  ds_read_b64_tr_b16 v[40:41], v15 offset:4096
  ds_read_b64_tr_b16 v[42:43], v15 offset:4608
  v_fma_f32 v94, v94, v31, v58
  v_fma_f32 v95, v95, v31, v59
  v_fma_f32 v96, v96, v31, v60
  v_fma_f32 v97, v97, v31, v61
  v_fma_f32 v98, v98, v31, v62
  v_fma_f32 v99, v99, v31, v63
  ds_read_b128 v[56:59], v9 offset:512
  ds_read_b128 v[60:63], v9 offset:544
  v_max_f32 v92, 0, v92
  v_max_f32 v93, 0, v93
  s_waitcnt lgkmcnt(8)
  v_mfma_f32_32x32x16_bf16 v[240:255], v[32:35], v[192:195], v[240:255]
  s_cmp_lg_u32 s71, 0
  s_cbranch_scc1 L_skip_180
  v_mfma_f32_4x4x4_16b_bf16 v[26:29], v[16:17], v[32:33], v[26:29]
  s_nop 1
  v_mfma_f32_4x4x4_16b_bf16 v[26:29], v[16:17], v[34:35], v[26:29]
L_skip_180:
  ds_read_b64_tr_b16 v[44:45], v15 offset:6144
  ds_read_b64_tr_b16 v[46:47], v15 offset:6656
  s_add_u32 s82, s80, 4096
  s_mov_b32 m0, 160000
  s_nop 0
  buffer_load_dwordx4 v6, s[40:43], s82 offen lds
  v_max_f32 v94, 0, v94
  v_max_f32 v95, 0, v95
  v_max_f32 v96, 0, v96
  v_max_f32 v97, 0, v97
  v_max_f32 v98, 0, v98
  v_max_f32 v99, 0, v99
  v_mul_f32 v92, v92, v92
  v_mul_f32 v93, v93, v93
  s_waitcnt lgkmcnt(8)
  v_mfma_f32_32x32x16_bf16 v[240:255], v[36:39], v[196:199], v[240:255]
  s_cmp_lg_u32 s71, 1
  s_cbranch_scc1 L_skip_181
  v_mfma_f32_4x4x4_16b_bf16 v[26:29], v[16:17], v[36:37], v[26:29]
  s_nop 1
  v_mfma_f32_4x4x4_16b_bf16 v[26:29], v[16:17], v[38:39], v[26:29]
L_skip_181:
  ds_read_b64_tr_b16 v[32:33], v15 offset:8192
  ds_read_b64_tr_b16 v[34:35], v15 offset:8704
  v_mul_f32 v94, v94, v94
  v_mul_f32 v95, v95, v95
  v_mul_f32 v96, v96, v96
  v_mul_f32 v97, v97, v97
  v_mul_f32 v98, v98, v98
  v_mul_f32 v99, v99, v99
  v_cvt_pk_bf16_f32 v88, v92, v93
  v_cvt_pk_bf16_f32 v89, v94, v95
  s_waitcnt lgkmcnt(6)
  v_mfma_f32_32x32x16_bf16 v[240:255], v[40:43], v[200:203], v[240:255]
  s_cmp_lg_u32 s71, 2
  s_cbranch_scc1 L_skip_182
  v_mfma_f32_4x4x4_16b_bf16 v[26:29], v[16:17], v[40:41], v[26:29]
  s_nop 1
  v_mfma_f32_4x4x4_16b_bf16 v[26:29], v[16:17], v[42:43], v[26:29]
L_skip_182:
  ds_read_b64_tr_b16 v[36:37], v15 offset:10240
  ds_read_b64_tr_b16 v[38:39], v15 offset:10752
  v_cvt_pk_bf16_f32 v90, v96, v97
  v_cvt_pk_bf16_f32 v91, v98, v99
  s_lshl_b32 s90, s13, 10
  s_add_u32 s90, s90, s15
  buffer_store_dwordx4 v[88:91], v10, s[48:51], s90 offen offset:1024 sc1
  v_fma_f32 v100, v48, v30, v100
  v_fma_f32 v101, v49, v30, v101
  v_fma_f32 v102, v50, v30, v102
  v_fma_f32 v103, v51, v30, v103
  v_fma_f32 v104, v52, v30, v104
  s_waitcnt lgkmcnt(4)
  v_mfma_f32_32x32x16_bf16 v[240:255], v[44:47], v[204:207], v[240:255]
  s_cmp_lg_u32 s71, 3
  s_cbranch_scc1 L_skip_183
  v_mfma_f32_4x4x4_16b_bf16 v[26:29], v[16:17], v[44:45], v[26:29]
  s_nop 1
  v_mfma_f32_4x4x4_16b_bf16 v[26:29], v[16:17], v[46:47], v[26:29]
L_skip_183:
  ds_read_b64_tr_b16 v[40:41], v15 offset:12288
  ds_read_b64_tr_b16 v[42:43], v15 offset:12800
  s_add_u32 s82, s80, 5120
  s_mov_b32 m0, 160000
  s_nop 0
  buffer_load_dwordx4 v6, s[40:43], s82 offen lds
  v_fma_f32 v105, v53, v30, v105
  v_fma_f32 v106, v54, v30, v106
  v_fma_f32 v107, v55, v30, v107
  ds_read_b128 v[48:51], v8 offset:320
  ds_read_b128 v[52:55], v8 offset:352
  v_fma_f32 v100, v100, v31, v56
  v_fma_f32 v101, v101, v31, v57
  v_fma_f32 v102, v102, v31, v58
  v_fma_f32 v103, v103, v31, v59
  s_waitcnt lgkmcnt(6)
  v_mfma_f32_32x32x16_bf16 v[240:255], v[32:35], v[208:211], v[240:255]
  s_cmp_lg_u32 s71, 0
  s_cbranch_scc1 L_skip_184
  v_mfma_f32_4x4x4_16b_bf16 v[26:29], v[16:17], v[32:33], v[26:29]
  s_nop 1
  v_mfma_f32_4x4x4_16b_bf16 v[26:29], v[16:17], v[34:35], v[26:29]
L_skip_184:
  ds_read_b64_tr_b16 v[44:45], v15 offset:14336
  ds_read_b64_tr_b16 v[46:47], v15 offset:14848
  v_fma_f32 v104, v104, v31, v60
  v_fma_f32 v105, v105, v31, v61
  v_fma_f32 v106, v106, v31, v62
  v_fma_f32 v107, v107, v31, v63
  ds_read_b128 v[56:59], v9 offset:576
  ds_read_b128 v[60:63], v9 offset:608
  v_max_f32 v100, 0, v100
  v_max_f32 v101, 0, v101
  v_max_f32 v102, 0, v102
  v_max_f32 v103, 0, v103
  s_waitcnt lgkmcnt(8)
  v_mfma_f32_32x32x16_bf16 v[240:255], v[36:39], v[212:215], v[240:255]
  s_cmp_lg_u32 s71, 1
  s_cbranch_scc1 L_skip_185
  v_mfma_f32_4x4x4_16b_bf16 v[26:29], v[16:17], v[36:37], v[26:29]
  s_nop 1
  v_mfma_f32_4x4x4_16b_bf16 v[26:29], v[16:17], v[38:39], v[26:29]
L_skip_185:
  ds_read_b64_tr_b16 v[32:33], v15 offset:16384
  ds_read_b64_tr_b16 v[34:35], v15 offset:16896
  v_max_f32 v104, 0, v104
  v_max_f32 v105, 0, v105
  v_max_f32 v106, 0, v106
  v_max_f32 v107, 0, v107
  v_mul_f32 v100, v100, v100
  v_mul_f32 v101, v101, v101
  v_mul_f32 v102, v102, v102
  v_mul_f32 v103, v103, v103
  s_waitcnt lgkmcnt(8)
  v_mfma_f32_32x32x16_bf16 v[240:255], v[40:43], v[216:219], v[240:255]
  s_cmp_lg_u32 s71, 2
  s_cbranch_scc1 L_skip_186
  v_mfma_f32_4x4x4_16b_bf16 v[26:29], v[16:17], v[40:41], v[26:29]
  s_nop 1
  v_mfma_f32_4x4x4_16b_bf16 v[26:29], v[16:17], v[42:43], v[26:29]
L_skip_186:
  ds_read_b64_tr_b16 v[36:37], v15 offset:18432
  ds_read_b64_tr_b16 v[38:39], v15 offset:18944
  s_add_u32 s82, s80, 5248
  s_mov_b32 m0, 160000
  s_nop 0
  buffer_load_dwordx4 v6, s[40:43], s82 offen lds
  v_mul_f32 v104, v104, v104
  v_mul_f32 v105, v105, v105
  v_mul_f32 v106, v106, v106
  v_mul_f32 v107, v107, v107
  v_cvt_pk_bf16_f32 v100, v100, v101
  v_cvt_pk_bf16_f32 v101, v102, v103
  v_cvt_pk_bf16_f32 v102, v104, v105
  v_cvt_pk_bf16_f32 v103, v106, v107
  s_waitcnt lgkmcnt(6)
  v_mfma_f32_32x32x16_bf16 v[240:255], v[44:47], v[220:223], v[240:255]
  s_cmp_lg_u32 s71, 3
  s_cbranch_scc1 L_skip_187
  v_mfma_f32_4x4x4_16b_bf16 v[26:29], v[16:17], v[44:45], v[26:29]
  s_nop 1
  v_mfma_f32_4x4x4_16b_bf16 v[26:29], v[16:17], v[46:47], v[26:29]
L_skip_187:
  ds_read_b64_tr_b16 v[40:41], v15 offset:20480
  ds_read_b64_tr_b16 v[42:43], v15 offset:20992
  s_lshl_b32 s90, s14, 10
  s_add_u32 s90, s90, s15
  buffer_store_dwordx4 v[100:103], v10, s[48:51], s90 offen offset:0 sc1
  v_fma_f32 v108, v48, v30, v108
  v_fma_f32 v109, v49, v30, v109
  v_fma_f32 v110, v50, v30, v110
  v_fma_f32 v111, v51, v30, v111
  v_fma_f32 v112, v52, v30, v112
  v_fma_f32 v113, v53, v30, v113
  v_fma_f32 v114, v54, v30, v114
  s_waitcnt lgkmcnt(4)
  v_mfma_f32_32x32x16_bf16 v[240:255], v[32:35], v[224:227], v[240:255]
  s_cmp_lg_u32 s71, 0
  s_cbranch_scc1 L_skip_188
  v_mfma_f32_4x4x4_16b_bf16 v[26:29], v[16:17], v[32:33], v[26:29]
  s_nop 1
  v_mfma_f32_4x4x4_16b_bf16 v[26:29], v[16:17], v[34:35], v[26:29]
L_skip_188:
  ds_read_b64_tr_b16 v[44:45], v15 offset:22528
  ds_read_b64_tr_b16 v[46:47], v15 offset:23040
  v_fma_f32 v115, v55, v30, v115
  v_fma_f32 v108, v108, v31, v56
  v_fma_f32 v109, v109, v31, v57
  v_fma_f32 v110, v110, v31, v58
  v_fma_f32 v111, v111, v31, v59
  v_fma_f32 v112, v112, v31, v60
  v_fma_f32 v113, v113, v31, v61
  v_fma_f32 v114, v114, v31, v62
  s_waitcnt lgkmcnt(4)
  v_mfma_f32_32x32x16_bf16 v[240:255], v[36:39], v[228:231], v[240:255]
  s_cmp_lg_u32 s71, 1
  s_cbranch_scc1 L_skip_189
  v_mfma_f32_4x4x4_16b_bf16 v[26:29], v[16:17], v[36:37], v[26:29]
  s_nop 1
  v_mfma_f32_4x4x4_16b_bf16 v[26:29], v[16:17], v[38:39], v[26:29]
L_skip_189:
  s_add_u32 s82, s81, 0
  s_mov_b32 m0, 160000
  s_nop 0
  buffer_load_dwordx4 v6, s[44:47], s82 offen lds
  v_fma_f32 v115, v115, v31, v63
  v_max_f32 v108, 0, v108
  v_max_f32 v109, 0, v109
  v_max_f32 v110, 0, v110
  v_max_f32 v111, 0, v111
  v_max_f32 v112, 0, v112
  v_max_f32 v113, 0, v113
  v_max_f32 v114, 0, v114
  s_waitcnt lgkmcnt(2)
  v_mfma_f32_32x32x16_bf16 v[240:255], v[40:43], v[232:235], v[240:255]
  s_cmp_lg_u32 s71, 2
  s_cbranch_scc1 L_skip_190
  v_mfma_f32_4x4x4_16b_bf16 v[26:29], v[16:17], v[40:41], v[26:29]
  s_nop 1
  v_mfma_f32_4x4x4_16b_bf16 v[26:29], v[16:17], v[42:43], v[26:29]
L_skip_190:
  v_max_f32 v115, 0, v115
  v_mul_f32 v108, v108, v108
  v_mul_f32 v109, v109, v109
  v_mul_f32 v110, v110, v110
  v_mul_f32 v111, v111, v111
  v_mul_f32 v112, v112, v112
  v_mul_f32 v113, v113, v113
  v_mul_f32 v114, v114, v114
  s_waitcnt lgkmcnt(0)
  v_mfma_f32_32x32x16_bf16 v[240:255], v[44:47], v[236:239], v[240:255]
  s_cmp_lg_u32 s71, 3
  s_cbranch_scc1 L_skip_191
  v_mfma_f32_4x4x4_16b_bf16 v[26:29], v[16:17], v[44:45], v[26:29]
  s_nop 1
  v_mfma_f32_4x4x4_16b_bf16 v[26:29], v[16:17], v[46:47], v[26:29]
L_skip_191:
  v_mul_f32 v115, v115, v115
  v_cvt_pk_bf16_f32 v104, v108, v109
  v_cvt_pk_bf16_f32 v105, v110, v111
  v_cvt_pk_bf16_f32 v106, v112, v113
  v_cvt_pk_bf16_f32 v107, v114, v115
  s_lshl_b32 s90, s14, 10
  s_add_u32 s90, s90, s15
  buffer_store_dwordx4 v[104:107], v10, s[48:51], s90 offen offset:1024 sc1
  s_add_u32 s82, s81, 544
  s_mov_b32 m0, 160000
  s_nop 0
  buffer_load_dwordx4 v6, s[44:47], s82 offen lds
  s_lshl_b32 s90, s71, 2
  v_lshlrev_b32 v125, 4, v2
  v_add_u32 v125, s90, v125
  v_add_u32 v125, 152320, v125
  v_mov_b32 v124, v26
  s_nop 1
  v_permlane32_swap_b32 v26, v124
  v_add_f32 v26, v26, v124
  ds_write_b32 v125, v26 offset:2560
  s_waitcnt lgkmcnt(0)
  s_barrier
  v_lshlrev_b32 v125, 4, v2
  v_add_u32 v125, 152320, v125
  ds_read_b128 v[116:119], v125 offset:2560
  s_mul_i32 s90, s70, 384
  v_lshlrev_b32 v124, 2, v2
  v_add_u32 v124, s90, v124
  v_add_u32 v124, 155904, v124
  s_waitcnt lgkmcnt(0)
  v_add_f32 v116, v116, v117
  v_add_f32 v118, v118, v119
  v_add_f32 v116, v116, v118
  ds_write_b32 v124, v116 offset:0
  s_waitcnt lgkmcnt(0)
  ds_read_b128 v[32:35], v8 offset:0
  ds_read_b128 v[36:39], v8 offset:32
  ds_read_b128 v[40:43], v8 offset:64
  ds_read_b128 v[44:47], v8 offset:96
  v_lshrrev_b32 v124, 4, v1
  v_and_b32 v124, 1, v124
  v_and_b32 v125, 3, v1
  v_lshlrev_b32 v124, 2, v124
  v_add_u32 v124, v124, v125
  v_min_u32 v124, 6, v124
  v_lshlrev_b32 v124, 3, v124
  v_lshrrev_b32 v125, 2, v1
  v_and_b32 v125, 3, v125
  v_lshl_add_u32 v125, v3, 2, v125
  v_mul_u32_u24 v125, 56, v125
  v_add_u32 v124, v124, v125
  v_add_u32 v124, 147456, v124
  v_mov_b32 v125, 150208
  v_cndmask_b32 v123, v124, v125, s[4:5]
  ds_read_b64_tr_b16 v[56:57], v124
  ds_read_b64_tr_b16 v[58:59], v124 offset:448
  ds_read_b64_tr_b16 v[60:61], v124 offset:896
  ds_read_b64_tr_b16 v[62:63], v123 offset:1344
  s_waitcnt lgkmcnt(4)
  v_pk_fma_f32 v[240:241], v[32:33], v[30:31], v[240:241] op_sel:[0,0,0] op_sel_hi:[1,0,1]
  v_pk_fma_f32 v[242:243], v[34:35], v[30:31], v[242:243] op_sel:[0,0,0] op_sel_hi:[1,0,1]
  v_pk_fma_f32 v[244:245], v[36:37], v[30:31], v[244:245] op_sel:[0,0,0] op_sel_hi:[1,0,1]
  v_pk_fma_f32 v[246:247], v[38:39], v[30:31], v[246:247] op_sel:[0,0,0] op_sel_hi:[1,0,1]
  v_pk_fma_f32 v[248:249], v[40:41], v[30:31], v[248:249] op_sel:[0,0,0] op_sel_hi:[1,0,1]
  v_pk_fma_f32 v[250:251], v[42:43], v[30:31], v[250:251] op_sel:[0,0,0] op_sel_hi:[1,0,1]
  v_pk_fma_f32 v[252:253], v[44:45], v[30:31], v[252:253] op_sel:[0,0,0] op_sel_hi:[1,0,1]
  v_pk_fma_f32 v[254:255], v[46:47], v[30:31], v[254:255] op_sel:[0,0,0] op_sel_hi:[1,0,1]
  v_cvt_pk_bf16_f32 v48, v240, v241
  v_cvt_pk_bf16_f32 v49, v242, v243
  v_cvt_pk_bf16_f32 v50, v244, v245
  v_cvt_pk_bf16_f32 v51, v246, v247
  v_cvt_pk_bf16_f32 v52, v248, v249
  v_cvt_pk_bf16_f32 v53, v250, v251
  v_cvt_pk_bf16_f32 v54, v252, v253
  v_cvt_pk_bf16_f32 v55, v254, v255
  s_waitcnt lgkmcnt(0)
  v_mfma_f32_32x32x16_bf16 v[240:255], v[56:59], v[48:51], 0
  v_mfma_f32_32x32x16_bf16 v[240:255], v[60:63], v[52:55], v[240:255]
  v_mul_f32 v116, 0x3fb8aa3b, v31
  s_nop 10
  v_max3_f32 v22, v240, v241, v242
  v_min3_f32 v23, v240, v241, v242
  v_max3_f32 v22, v22, v243, v244
  v_min3_f32 v23, v23, v243, v244
  v_max3_f32 v22, v22, v245, v246
  v_min3_f32 v23, v23, v245, v246
  v_max3_f32 v22, v22, v247, v248
  v_min3_f32 v23, v23, v247, v248
  v_max3_f32 v22, v22, v249, v250
  v_min3_f32 v23, v23, v249, v250
  v_max3_f32 v22, v22, v251, v252
  v_min3_f32 v23, v23, v251, v252
  v_max3_f32 v22, v22, v253, v254
  v_min3_f32 v23, v23, v253, v254
  v_max_f32 v22, v22, v255
  v_min_f32 v23, v23, v255
  s_waitcnt vmcnt(1)
  v_mov_b32 v124, 151616
  v_mov_b32 v125, 1
  s_mov_b64 s[100:101], exec
  s_mov_b64 exec, 1
  ds_add_rtn_u32 v125, v124, v125
  s_mov_b64 exec, s[100:101]
  s_waitcnt lgkmcnt(0)
  v_readfirstlane_b32 s90, v125
  s_nop 0
  s_cmp_lg_u32 s90, 7
  s_cbranch_scc1 L_notlast_192
  s_cmp_lg_u32 s74, 0
  s_cbranch_scc1 L_tagok_193
  s_mov_b32 s95, 0
L_tagloop_194:
  v_mov_b32 v124, 0
  buffer_load_dword v125, v124, s[60:63], 0 offen sc1
  s_waitcnt vmcnt(0)
  v_readfirstlane_b32 s74, v125
  s_add_u32 s95, s95, 1
  s_cmp_lg_u32 s74, 0
  s_cbranch_scc1 L_tagok_193
  s_cmp_lt_u32 s95, 0x40000
  s_cbranch_scc1 L_tagloop_194
L_tagok_193:
  s_lshl_b32 s90, s68, 4
  s_add_u32 s90, s90, s69
  s_lshl_b32 s90, s90, 7
  s_add_u32 s90, s90, 86016
  v_mov_b32 v124, 0
  v_mov_b32 v125, s74
  s_mov_b64 s[100:101], exec
  s_mov_b64 exec, 1
  buffer_store_dword v125, v124, s[48:51], s90 offen sc1
  s_mov_b64 exec, s[100:101]
L_notlast_192:
  v_mov_b32 v24, v22
  s_nop 1
  v_permlane32_swap_b32 v22, v24
  v_max_f32 v22, v22, v24
  v_mov_b32 v24, v23
  s_nop 1
  v_permlane32_swap_b32 v23, v24
  v_min_f32 v23, v23, v24
  v_mul_f32 v118, -v22, v116
  v_mul_f32 v119, v23, v116
  v_pk_fma_f32 v[32:33], v[240:241], v[116:117], v[118:119] op_sel:[0,0,0] op_sel_hi:[1,0,0]
  v_pk_fma_f32 v[48:49], v[240:241], v[116:117], v[118:119] op_sel:[0,0,1] op_sel_hi:[1,0,1] neg_lo:[0,1,0] neg_hi:[0,1,0]
  v_pk_fma_f32 v[34:35], v[242:243], v[116:117], v[118:119] op_sel:[0,0,0] op_sel_hi:[1,0,0]
  v_pk_fma_f32 v[50:51], v[242:243], v[116:117], v[118:119] op_sel:[0,0,1] op_sel_hi:[1,0,1] neg_lo:[0,1,0] neg_hi:[0,1,0]
  v_pk_fma_f32 v[36:37], v[244:245], v[116:117], v[118:119] op_sel:[0,0,0] op_sel_hi:[1,0,0]
  v_pk_fma_f32 v[52:53], v[244:245], v[116:117], v[118:119] op_sel:[0,0,1] op_sel_hi:[1,0,1] neg_lo:[0,1,0] neg_hi:[0,1,0]
  v_pk_fma_f32 v[38:39], v[246:247], v[116:117], v[118:119] op_sel:[0,0,0] op_sel_hi:[1,0,0]
  v_pk_fma_f32 v[54:55], v[246:247], v[116:117], v[118:119] op_sel:[0,0,1] op_sel_hi:[1,0,1] neg_lo:[0,1,0] neg_hi:[0,1,0]
  v_pk_fma_f32 v[40:41], v[248:249], v[116:117], v[118:119] op_sel:[0,0,0] op_sel_hi:[1,0,0]
  v_pk_fma_f32 v[56:57], v[248:249], v[116:117], v[118:119] op_sel:[0,0,1] op_sel_hi:[1,0,1] neg_lo:[0,1,0] neg_hi:[0,1,0]
  v_pk_fma_f32 v[42:43], v[250:251], v[116:117], v[118:119] op_sel:[0,0,0] op_sel_hi:[1,0,0]
  v_pk_fma_f32 v[58:59], v[250:251], v[116:117], v[118:119] op_sel:[0,0,1] op_sel_hi:[1,0,1] neg_lo:[0,1,0] neg_hi:[0,1,0]
  v_pk_fma_f32 v[44:45], v[252:253], v[116:117], v[118:119] op_sel:[0,0,0] op_sel_hi:[1,0,0]
  v_pk_fma_f32 v[60:61], v[252:253], v[116:117], v[118:119] op_sel:[0,0,1] op_sel_hi:[1,0,1] neg_lo:[0,1,0] neg_hi:[0,1,0]
  v_pk_fma_f32 v[46:47], v[254:255], v[116:117], v[118:119] op_sel:[0,0,0] op_sel_hi:[1,0,0]
  v_pk_fma_f32 v[62:63], v[254:255], v[116:117], v[118:119] op_sel:[0,0,1] op_sel_hi:[1,0,1] neg_lo:[0,1,0] neg_hi:[0,1,0]
  v_exp_f32 v32, v32
  v_exp_f32 v48, v48
  v_exp_f32 v33, v33
  v_exp_f32 v49, v49
  v_exp_f32 v34, v34
  v_exp_f32 v50, v50
  v_exp_f32 v35, v35
  v_exp_f32 v51, v51
  v_exp_f32 v36, v36
  v_exp_f32 v52, v52
  v_exp_f32 v37, v37
  v_exp_f32 v53, v53
  v_exp_f32 v38, v38
  v_exp_f32 v54, v54
  v_exp_f32 v39, v39
  v_exp_f32 v55, v55
  v_exp_f32 v40, v40
  v_exp_f32 v56, v56
  v_exp_f32 v41, v41
  v_exp_f32 v57, v57
  v_exp_f32 v42, v42
  v_exp_f32 v58, v58
  v_exp_f32 v43, v43
  v_exp_f32 v59, v59
  v_exp_f32 v44, v44
  v_exp_f32 v60, v60
  v_exp_f32 v45, v45
  v_exp_f32 v61, v61
  v_exp_f32 v46, v46
  v_exp_f32 v62, v62
  v_exp_f32 v47, v47
  v_exp_f32 v63, v63
  v_cndmask_b32 v125, 1.0, 0, s[4:5]
  v_pk_add_f32 v[240:241], v[32:33], v[34:35]
  v_pk_add_f32 v[242:243], v[44:45], v[46:47]
  v_pk_add_f32 v[240:241], v[240:241], v[36:37]
  v_pk_add_f32 v[240:241], v[240:241], v[38:39]
  v_pk_add_f32 v[240:241], v[240:241], v[40:41]
  v_pk_add_f32 v[240:241], v[240:241], v[42:43]
  v_add_f32 v242, v242, v243
  v_add_f32 v120, v240, v241
  v_fmac_f32 v120, v242, v125
  v_pk_add_f32 v[244:245], v[48:49], v[50:51]
  v_pk_add_f32 v[246:247], v[60:61], v[62:63]
  v_pk_add_f32 v[244:245], v[244:245], v[52:53]
  v_pk_add_f32 v[244:245], v[244:245], v[54:55]
  v_pk_add_f32 v[244:245], v[244:245], v[56:57]
  v_pk_add_f32 v[244:245], v[244:245], v[58:59]
  v_add_f32 v246, v246, v247
  v_add_f32 v121, v244, v245
  v_fmac_f32 v121, v246, v125
  v_mov_b32 v24, v120
  s_nop 1
  v_permlane32_swap_b32 v120, v24
  v_add_f32 v120, v120, v24
  v_mov_b32 v24, v121
  s_nop 1
  v_permlane32_swap_b32 v121, v24
  v_add_f32 v121, v121, v24
  v_rcp_f32 v120, v120
  v_rcp_f32 v121, v121
  s_nop 0
  v_pk_mul_f32 v[32:33], v[32:33], v[120:121] op_sel:[0,0] op_sel_hi:[1,0]
  v_pk_mul_f32 v[48:49], v[48:49], v[120:121] op_sel:[0,1] op_sel_hi:[1,1]
  v_pk_mul_f32 v[34:35], v[34:35], v[120:121] op_sel:[0,0] op_sel_hi:[1,0]
  v_pk_mul_f32 v[50:51], v[50:51], v[120:121] op_sel:[0,1] op_sel_hi:[1,1]
  v_pk_mul_f32 v[36:37], v[36:37], v[120:121] op_sel:[0,0] op_sel_hi:[1,0]
  v_pk_mul_f32 v[52:53], v[52:53], v[120:121] op_sel:[0,1] op_sel_hi:[1,1]
  v_pk_mul_f32 v[38:39], v[38:39], v[120:121] op_sel:[0,0] op_sel_hi:[1,0]
  v_pk_mul_f32 v[54:55], v[54:55], v[120:121] op_sel:[0,1] op_sel_hi:[1,1]
  v_pk_mul_f32 v[40:41], v[40:41], v[120:121] op_sel:[0,0] op_sel_hi:[1,0]
  v_pk_mul_f32 v[56:57], v[56:57], v[120:121] op_sel:[0,1] op_sel_hi:[1,1]
  v_pk_mul_f32 v[42:43], v[42:43], v[120:121] op_sel:[0,0] op_sel_hi:[1,0]
  v_pk_mul_f32 v[58:59], v[58:59], v[120:121] op_sel:[0,1] op_sel_hi:[1,1]
  v_pk_mul_f32 v[44:45], v[44:45], v[120:121] op_sel:[0,0] op_sel_hi:[1,0]
  v_pk_mul_f32 v[60:61], v[60:61], v[120:121] op_sel:[0,1] op_sel_hi:[1,1]
  v_pk_mul_f32 v[46:47], v[46:47], v[120:121] op_sel:[0,0] op_sel_hi:[1,0]
  v_pk_mul_f32 v[62:63], v[62:63], v[120:121] op_sel:[0,1] op_sel_hi:[1,1]
  v_cvt_pk_bf16_f32 v240, v32, v33
  v_cvt_pk_bf16_f32 v248, v48, v49
  v_cvt_pk_bf16_f32 v241, v34, v35
  v_cvt_pk_bf16_f32 v249, v50, v51
  v_cvt_pk_bf16_f32 v242, v36, v37
  v_cvt_pk_bf16_f32 v250, v52, v53
  v_cvt_pk_bf16_f32 v243, v38, v39
  v_cvt_pk_bf16_f32 v251, v54, v55
  v_cvt_pk_bf16_f32 v244, v40, v41
  v_cvt_pk_bf16_f32 v252, v56, v57
  v_cvt_pk_bf16_f32 v245, v42, v43
  v_cvt_pk_bf16_f32 v253, v58, v59
  v_cvt_pk_bf16_f32 v246, v44, v45
  v_cvt_pk_bf16_f32 v254, v60, v61
  v_cvt_pk_bf16_f32 v247, v46, v47
  v_cvt_pk_bf16_f32 v255, v62, v63
  s_mul_i32 s90, s71, 15360
  v_lshlrev_b32 v124, 4, v1
  v_add_u32 v124, s90, v124
  v_add_u32 v124, 81920, v124
  ds_write_b128 v124, v[240:243] offset:0
  ds_write_b128 v124, v[244:247] offset:1024
  ds_write_b128 v124, v[248:251] offset:2048
  ds_write_b128 v124, v[252:255] offset:3072
  s_waitcnt lgkmcnt(0)
  s_barrier
  s_branch L_S2_FQ
L_Q1:
  s_mov_b32 s94, s93
  s_lshl_b32 s90, s71, 6
  v_add_u32 v244, s90, v1
  s_mul_i32 s90, s73, 160
  s_add_u32 s90, s90, 512
  s_and_b32 s91, s73, 1
  s_lshl_b32 s92, s91, 5
  s_add_u32 s92, s92, s90
  s_xor_b32 s93, s91, 1
  s_lshl_b32 s93, s93, 7
  s_add_u32 s93, s93, s90
  v_add_u32 v245, s92, v244
  s_sub_u32 s93, s93, 128
  v_add_u32 v246, s93, v244
  v_cmp_gt_u32 vcc, 128, v244
  s_nop 1
  v_cndmask_b32 v245, v246, v245, vcc
  v_lshlrev_b32 v245, 1, v245
  v_lshlrev_b32 v246, 2, v244
  v_add_u32 v246, 151680, v246
  s_mov_b32 s56, s16
  s_and_b32 s57, s17, 0xffff
  s_mov_b32 s58, 3584
  s_mov_b32 s59, 0x20000
  buffer_load_ushort v247, v245, s[56:59], 0 offen
  s_mov_b32 s40, s18
  s_and_b32 s41, s19, 0xffff
  s_mov_b32 s42, 1605632
  s_mov_b32 s43, 0x20000
  s_mov_b32 s32, s6
  s_and_b32 s33, s7, 0xffff
  s_mov_b32 s34, 1204224
  s_mov_b32 s35, 0x20000
  s_mov_b32 s36, s14
  s_and_b32 s37, s15, 0xffff
  s_mov_b32 s38, 1605632
  s_mov_b32 s39, 0x20000
  s_mov_b32 s7, s94
  s_mov_b32 s44, s10
  s_and_b32 s45, s11, 0xffff
  s_mov_b32 s46, 401408
  s_mov_b32 s47, 0x20000
  s_mov_b32 s48, s26
  s_and_b32 s49, s27, 0xffff
  s_mov_b32 s50, 16121856
  s_mov_b32 s51, 0x20000
  s_mov_b32 s52, s22
  s_and_b32 s53, s23, 0xffff
  s_mov_b32 s54, 1835008
  s_mov_b32 s55, 0x20000
  s_mov_b32 s60, s24
  s_and_b32 s61, s25, 0xffff
  s_mov_b32 s62, 256
  s_mov_b32 s63, 0x20000
  v_cmp_eq_u32 s[4:5], 1, v3
  s_mov_b32 s6, 0xffff0000
  s_mul_i32 s10, s73, 112
  s_mul_i32 s90, s70, 21504
  s_add_u32 s10, s10, s90
  s_mov_b32 s11, 172032
  s_mul_i32 s90, s73, 160
  s_add_u32 s90, s90, 512
  s_and_b32 s91, s73, 1
  s_lshl_b32 s92, s91, 5
  s_add_u32 s92, s92, s90
  s_xor_b32 s93, s91, 1
  s_lshl_b32 s93, s93, 7
  s_add_u32 s93, s93, s90
  s_lshr_b32 s12, s92, 4
  s_add_u32 s12, s12, 4
  s_add_u32 s13, s12, 2
  s_mov_b32 s22, s7
  s_lshl_b32 s90, s68, 2
  s_add_u32 s90, s90, s71
  s_mul_i32 s15, s90, 114688
  s_add_u32 s15, s15, 4587520
  v_and_b32 v124, 7, v1
  v_lshrrev_b32 v125, 2, v1
  v_and_b32 v125, 4, v125
  v_xor_b32 v124, v124, v125
  v_min_u32 v124, 6, v124
  v_lshlrev_b32 v124, 4, v124
  v_lshrrev_b32 v125, 3, v1
  s_movk_i32 s90, 2688
  v_mad_u32_u24 v7, v125, s90, v124
  v_lshlrev_b32 v124, 4, v1
  s_mul_i32 s90, s2, 6272
  s_lshl_b32 s91, s71, 10
  s_cmp_eq_u32 s71, 2
  s_cselect_b32 s91, 1152, s91
  s_add_u32 s90, s90, s91
  s_add_u32 s90, s90, 4096
  s_mul_i32 s92, s2, 1568
  s_cmp_eq_u32 s71, 3
  s_cbranch_scc1 L_mpw_195
  s_mov_b32 m0, 160000
  s_nop 0
  buffer_load_dwordx4 v124, s[40:43], s90 offen lds
  s_branch L_mpe_196
L_mpw_195:
  s_mov_b32 m0, 160000
  s_nop 0
  buffer_load_dwordx4 v124, s[44:47], s92 offen lds
  s_add_u32 s92, s92, 544
  s_mov_b32 m0, 160000
  s_nop 0
  buffer_load_dwordx4 v124, s[44:47], s92 offen lds
L_mpe_196:
  s_cmp_lg_u32 s71, 3
  s_cbranch_scc1 L_tlb_197
  v_lshlrev_b32 v124, 18, v1
  s_mov_b32 m0, 160000
  s_nop 0
  buffer_load_dwordx4 v124, s[48:51], 0 offen lds
  v_lshlrev_b32 v124, 15, v1
  s_mov_b32 m0, 160000
  s_nop 0
  buffer_load_dwordx4 v124, s[40:43], 0 offen lds
  v_lshlrev_b32 v124, 13, v1
  s_mov_b32 m0, 160000
  s_nop 0
  buffer_load_dwordx4 v124, s[44:47], 0 offen lds
  v_lshlrev_b32 v124, 15, v1
  s_mov_b32 m0, 160000
  s_nop 0
  buffer_load_dwordx4 v124, s[52:55], 0 offen lds
L_tlb_197:
  s_lshl_b32 s90, s71, 12
  v_lshrrev_b32 v124, 1, v2
  v_and_b32 v124, 7, v124
  v_xor_b32 v124, v124, v3
  v_lshlrev_b32 v124, 4, v124
  v_lshl_add_u32 v124, v2, 7, v124
  v_add_u32 v8, s90, v124
  v_xor_b32 v9, 32, v8
  v_xor_b32 v10, 64, v8
  v_xor_b32 v11, 96, v8
  v_lshrrev_b32 v124, 4, v1
  v_and_b32 v124, 1, v124
  v_lshlrev_b32 v124, 5, v124
  v_and_b32 v125, 3, v1
  v_lshl_add_u32 v124, v125, 3, v124
  v_lshlrev_b32 v125, 3, v1
  v_and_b32 v125, 64, v125
  v_xor_b32 v124, v124, v125
  v_lshrrev_b32 v125, 2, v1
  v_and_b32 v125, 3, v125
  v_mad_u32_u24 v12, v3, 8, v125
  v_lshl_add_u32 v12, v12, 7, v124
  v_lshrrev_b32 v124, 4, v1
  v_and_b32 v124, 1, v124
  v_lshlrev_b32 v124, 5, v124
  v_and_b32 v125, 3, v1
  v_lshl_add_u32 v124, v125, 3, v124
  v_add_u32 v124, 64, v124
  v_lshlrev_b32 v125, 3, v1
  v_and_b32 v125, 64, v125
  v_xor_b32 v124, v124, v125
  v_lshrrev_b32 v125, 2, v1
  v_and_b32 v125, 3, v125
  v_mad_u32_u24 v13, v3, 8, v125
  v_lshl_add_u32 v13, v13, 7, v124
  v_mov_b32 v16, 0x3f803f80
  v_mov_b32 v17, 0x3f803f80
  s_mov_b32 s56, s32
  s_mov_b32 s57, s33
  s_mov_b32 s58, s34
  s_mov_b32 s59, s35
  v_mov_b32 v116, 0
  v_mov_b32 v117, 0
  v_mov_b32 v118, 0
  v_mov_b32 v119, 0
  v_mov_b32 v120, 0
  v_mov_b32 v121, 0
  v_mov_b32 v122, 0
  v_mov_b32 v123, 0
  s_waitcnt vmcnt(7)
  s_barrier
  ds_read_b128 v[128:131], v8
  ds_read_b64_tr_b16 v[32:33], v12 offset:24576
  ds_read_b64_tr_b16 v[34:35], v12 offset:25088
  ds_read_b64_tr_b16 v[36:37], v13 offset:24576
  ds_read_b64_tr_b16 v[38:39], v13 offset:25088
  ds_read_b128 v[132:135], v9
  ds_read_b64_tr_b16 v[40:41], v12 offset:26624
  ds_read_b64_tr_b16 v[42:43], v12 offset:27136
  ds_read_b64_tr_b16 v[44:45], v13 offset:26624
  ds_read_b64_tr_b16 v[46:47], v13 offset:27136
  ds_read_b128 v[136:139], v10
  ds_read_b64_tr_b16 v[48:49], v12 offset:28672
  ds_read_b64_tr_b16 v[50:51], v12 offset:29184
  ds_read_b64_tr_b16 v[52:53], v13 offset:28672
  ds_read_b64_tr_b16 v[54:55], v13 offset:29184
  v_mov_b32 v124, 0
  buffer_load_dword v126, v124, s[60:63], 0 offen sc1
  s_waitcnt lgkmcnt(10)
  v_mfma_f32_32x32x16_bf16 v[68:83], v[32:35], v[128:131], 0
  ds_read_b128 v[140:143], v11
  ds_read_b64_tr_b16 v[56:57], v12 offset:30720
  ds_read_b64_tr_b16 v[58:59], v12 offset:31232
  v_mfma_f32_32x32x16_bf16 v[84:99], v[36:39], v[128:131], 0
  ds_read_b64_tr_b16 v[60:61], v13 offset:30720
  ds_read_b64_tr_b16 v[62:63], v13 offset:31232
  s_cmp_lg_u32 s75, 0
  s_cbranch_scc1 L_skip_198
  s_call_b64 s[96:97], L_DMA
  v_mfma_f32_4x4x4_16b_bf16 v[116:119], v[16:17], v[32:33], v[116:119]
  v_mfma_f32_4x4x4_16b_bf16 v[120:123], v[16:17], v[36:37], v[120:123]
  s_nop 0
  v_mfma_f32_4x4x4_16b_bf16 v[116:119], v[16:17], v[34:35], v[116:119]
  v_mfma_f32_4x4x4_16b_bf16 v[120:123], v[16:17], v[38:39], v[120:123]
L_skip_198:
  s_waitcnt lgkmcnt(10)
  v_mfma_f32_32x32x16_bf16 v[68:83], v[40:43], v[132:135], v[68:83]
  v_add_u32 v8, 36864, v8
  v_add_u32 v9, 36864, v9
  v_add_u32 v10, 36864, v10
  v_add_u32 v11, 36864, v11
  v_add_u32 v12, 36864, v12
  v_add_u32 v13, 36864, v13
  ds_read_b128 v[144:147], v8
  ds_read_b64_tr_b16 v[32:33], v12 offset:24576
  ds_read_b64_tr_b16 v[34:35], v12 offset:25088
  v_mfma_f32_32x32x16_bf16 v[84:99], v[44:47], v[132:135], v[84:99]
  ds_read_b64_tr_b16 v[36:37], v13 offset:24576
  ds_read_b64_tr_b16 v[38:39], v13 offset:25088
  s_cmp_lg_u32 s75, 1
  s_cbranch_scc1 L_skip_199
  s_call_b64 s[96:97], L_DMA
  v_mfma_f32_4x4x4_16b_bf16 v[116:119], v[16:17], v[40:41], v[116:119]
  v_mfma_f32_4x4x4_16b_bf16 v[120:123], v[16:17], v[44:45], v[120:123]
  s_nop 0
  v_mfma_f32_4x4x4_16b_bf16 v[116:119], v[16:17], v[42:43], v[116:119]
  v_mfma_f32_4x4x4_16b_bf16 v[120:123], v[16:17], v[46:47], v[120:123]
L_skip_199:
  s_waitcnt lgkmcnt(10)
  v_mfma_f32_32x32x16_bf16 v[68:83], v[48:51], v[136:139], v[68:83]
  ds_read_b128 v[148:151], v9
  ds_read_b64_tr_b16 v[40:41], v12 offset:26624
  ds_read_b64_tr_b16 v[42:43], v12 offset:27136
  v_mfma_f32_32x32x16_bf16 v[84:99], v[52:55], v[136:139], v[84:99]
  ds_read_b64_tr_b16 v[44:45], v13 offset:26624
  ds_read_b64_tr_b16 v[46:47], v13 offset:27136
  s_cmp_lg_u32 s75, 2
  s_cbranch_scc1 L_skip_200
  s_call_b64 s[96:97], L_DMA
  v_mfma_f32_4x4x4_16b_bf16 v[116:119], v[16:17], v[48:49], v[116:119]
  v_mfma_f32_4x4x4_16b_bf16 v[120:123], v[16:17], v[52:53], v[120:123]
  s_nop 0
  v_mfma_f32_4x4x4_16b_bf16 v[116:119], v[16:17], v[50:51], v[116:119]
  v_mfma_f32_4x4x4_16b_bf16 v[120:123], v[16:17], v[54:55], v[120:123]
L_skip_200:
  s_waitcnt lgkmcnt(10)
  v_mfma_f32_32x32x16_bf16 v[68:83], v[56:59], v[140:143], v[68:83]
  ds_read_b128 v[152:155], v10
  ds_read_b64_tr_b16 v[48:49], v12 offset:28672
  ds_read_b64_tr_b16 v[50:51], v12 offset:29184
  v_mfma_f32_32x32x16_bf16 v[84:99], v[60:63], v[140:143], v[84:99]
  ds_read_b64_tr_b16 v[52:53], v13 offset:28672
  ds_read_b64_tr_b16 v[54:55], v13 offset:29184
  s_cmp_lg_u32 s75, 3
  s_cbranch_scc1 L_skip_201
  s_call_b64 s[96:97], L_DMA
  v_mfma_f32_4x4x4_16b_bf16 v[116:119], v[16:17], v[56:57], v[116:119]
  v_mfma_f32_4x4x4_16b_bf16 v[120:123], v[16:17], v[60:61], v[120:123]
  s_nop 0
  v_mfma_f32_4x4x4_16b_bf16 v[116:119], v[16:17], v[58:59], v[116:119]
  v_mfma_f32_4x4x4_16b_bf16 v[120:123], v[16:17], v[62:63], v[120:123]
L_skip_201:
  s_waitcnt vmcnt(8)
  s_barrier
  s_waitcnt vmcnt(7)
  v_lshlrev_b32 v247, 16, v247
  v_cmp_gt_u32 vcc, 160, v244
  s_nop 0
  s_and_saveexec_b64 s[100:101], vcc
  s_cbranch_execz L_b1skip_202
  ds_write_b32 v246, v247
L_b1skip_202:
  s_mov_b64 exec, s[100:101]
  s_waitcnt lgkmcnt(10)
  v_mfma_f32_32x32x16_bf16 v[68:83], v[32:35], v[144:147], v[68:83]
  ds_read_b128 v[156:159], v11
  ds_read_b64_tr_b16 v[56:57], v12 offset:30720
  ds_read_b64_tr_b16 v[58:59], v12 offset:31232
  v_mfma_f32_32x32x16_bf16 v[84:99], v[36:39], v[144:147], v[84:99]
  ds_read_b64_tr_b16 v[60:61], v13 offset:30720
  ds_read_b64_tr_b16 v[62:63], v13 offset:31232
  s_waitcnt vmcnt(5)
  v_readfirstlane_b32 s74, v126
  s_nop 0
  s_cmp_lg_u32 s74, 0
  s_cbranch_scc1 L_tagok_203
  s_mov_b32 s95, 0
L_tagloop_204:
  v_mov_b32 v124, 0
  buffer_load_dword v125, v124, s[60:63], 0 offen sc1
  s_waitcnt vmcnt(0)
  v_readfirstlane_b32 s74, v125
  s_add_u32 s95, s95, 1
  s_cmp_lg_u32 s74, 0
  s_cbranch_scc1 L_tagok_203
  s_cmp_lt_u32 s95, 0x40000
  s_cbranch_scc1 L_tagloop_204
L_tagok_203:
  v_mov_b32 v22, 0
  v_mov_b32 v23, 0
  v_lshlrev_b32 v20, 16, v240
  v_and_b32 v21, s6, v240
  v_add_f32 v22, v22, v20
  v_fmac_f32 v23, v20, v20
  v_add_f32 v22, v22, v21
  v_fmac_f32 v23, v21, v21
  s_cmp_lg_u32 s75, 0
  s_cbranch_scc1 L_skip_205
  s_call_b64 s[96:97], L_DMA
  v_mfma_f32_4x4x4_16b_bf16 v[116:119], v[16:17], v[32:33], v[116:119]
  v_mfma_f32_4x4x4_16b_bf16 v[120:123], v[16:17], v[36:37], v[120:123]
  s_nop 0
  v_mfma_f32_4x4x4_16b_bf16 v[116:119], v[16:17], v[34:35], v[116:119]
  v_mfma_f32_4x4x4_16b_bf16 v[120:123], v[16:17], v[38:39], v[120:123]
L_skip_205:
  s_waitcnt lgkmcnt(10)
  v_mfma_f32_32x32x16_bf16 v[68:83], v[40:43], v[148:151], v[68:83]
  v_add_u32 v8, 36864, v8
  v_add_u32 v9, 36864, v9
  v_add_u32 v10, 36864, v10
  v_add_u32 v11, 36864, v11
  v_add_u32 v12, 36864, v12
  v_add_u32 v13, 36864, v13
  ds_read_b128 v[160:163], v8
  ds_read_b64_tr_b16 v[32:33], v12 offset:24576
  ds_read_b64_tr_b16 v[34:35], v12 offset:25088
  v_mfma_f32_32x32x16_bf16 v[84:99], v[44:47], v[148:151], v[84:99]
  ds_read_b64_tr_b16 v[36:37], v13 offset:24576
  ds_read_b64_tr_b16 v[38:39], v13 offset:25088
  v_lshlrev_b32 v20, 16, v241
  v_and_b32 v21, s6, v241
  v_add_f32 v22, v22, v20
  v_fmac_f32 v23, v20, v20
  v_add_f32 v22, v22, v21
  v_fmac_f32 v23, v21, v21
  v_lshlrev_b32 v20, 16, v242
  v_and_b32 v21, s6, v242
  v_add_f32 v22, v22, v20
  v_fmac_f32 v23, v20, v20
  v_add_f32 v22, v22, v21
  v_fmac_f32 v23, v21, v21
  s_cmp_lg_u32 s75, 1
  s_cbranch_scc1 L_skip_206
  s_call_b64 s[96:97], L_DMA
  v_mfma_f32_4x4x4_16b_bf16 v[116:119], v[16:17], v[40:41], v[116:119]
  v_mfma_f32_4x4x4_16b_bf16 v[120:123], v[16:17], v[44:45], v[120:123]
  s_nop 0
  v_mfma_f32_4x4x4_16b_bf16 v[116:119], v[16:17], v[42:43], v[116:119]
  v_mfma_f32_4x4x4_16b_bf16 v[120:123], v[16:17], v[46:47], v[120:123]
L_skip_206:
  s_waitcnt lgkmcnt(10)
  v_mfma_f32_32x32x16_bf16 v[68:83], v[48:51], v[152:155], v[68:83]
  ds_read_b128 v[164:167], v9
  ds_read_b64_tr_b16 v[40:41], v12 offset:26624
  ds_read_b64_tr_b16 v[42:43], v12 offset:27136
  v_mfma_f32_32x32x16_bf16 v[84:99], v[52:55], v[152:155], v[84:99]
  ds_read_b64_tr_b16 v[44:45], v13 offset:26624
  ds_read_b64_tr_b16 v[46:47], v13 offset:27136
  v_lshlrev_b32 v20, 16, v243
  v_and_b32 v21, s6, v243
  v_add_f32 v22, v22, v20
  v_fmac_f32 v23, v20, v20
  v_add_f32 v22, v22, v21
  v_fmac_f32 v23, v21, v21
  s_nop 0
  v_add_f32_dpp v22, v22, v22 quad_perm:[1,0,3,2] row_mask:0xf bank_mask:0xf
  v_add_f32_dpp v23, v23, v23 quad_perm:[1,0,3,2] row_mask:0xf bank_mask:0xf
  s_cmp_lg_u32 s75, 2
  s_cbranch_scc1 L_skip_207
  s_call_b64 s[96:97], L_DMA
  v_mfma_f32_4x4x4_16b_bf16 v[116:119], v[16:17], v[48:49], v[116:119]
  v_mfma_f32_4x4x4_16b_bf16 v[120:123], v[16:17], v[52:53], v[120:123]
  s_nop 0
  v_mfma_f32_4x4x4_16b_bf16 v[116:119], v[16:17], v[50:51], v[116:119]
  v_mfma_f32_4x4x4_16b_bf16 v[120:123], v[16:17], v[54:55], v[120:123]
L_skip_207:
  s_waitcnt lgkmcnt(10)
  v_mfma_f32_32x32x16_bf16 v[68:83], v[56:59], v[156:159], v[68:83]
  ds_read_b128 v[168:171], v10
  ds_read_b64_tr_b16 v[48:49], v12 offset:28672
  ds_read_b64_tr_b16 v[50:51], v12 offset:29184
  v_mfma_f32_32x32x16_bf16 v[84:99], v[60:63], v[156:159], v[84:99]
  ds_read_b64_tr_b16 v[52:53], v13 offset:28672
  ds_read_b64_tr_b16 v[54:55], v13 offset:29184
  v_add_f32_dpp v22, v22, v22 quad_perm:[2,3,0,1] row_mask:0xf bank_mask:0xf
  v_add_f32_dpp v23, v23, v23 quad_perm:[2,3,0,1] row_mask:0xf bank_mask:0xf
  s_nop 0
  v_add_f32_dpp v22, v22, v22 row_half_mirror row_mask:0xf bank_mask:0xf
  v_add_f32_dpp v23, v23, v23 row_half_mirror row_mask:0xf bank_mask:0xf
  s_cmp_lg_u32 s75, 3
  s_cbranch_scc1 L_skip_208
  s_call_b64 s[96:97], L_DMA
  v_mfma_f32_4x4x4_16b_bf16 v[116:119], v[16:17], v[56:57], v[116:119]
  v_mfma_f32_4x4x4_16b_bf16 v[120:123], v[16:17], v[60:61], v[120:123]
  s_nop 0
  v_mfma_f32_4x4x4_16b_bf16 v[116:119], v[16:17], v[58:59], v[116:119]
  v_mfma_f32_4x4x4_16b_bf16 v[120:123], v[16:17], v[62:63], v[120:123]
L_skip_208:
  s_waitcnt vmcnt(5)
  s_barrier
  s_waitcnt lgkmcnt(10)
  v_mfma_f32_32x32x16_bf16 v[68:83], v[32:35], v[160:163], v[68:83]
  ds_read_b128 v[172:175], v11
  ds_read_b64_tr_b16 v[56:57], v12 offset:30720
  ds_read_b64_tr_b16 v[58:59], v12 offset:31232
  v_mfma_f32_32x32x16_bf16 v[84:99], v[36:39], v[160:163], v[84:99]
  ds_read_b64_tr_b16 v[60:61], v13 offset:30720
  ds_read_b64_tr_b16 v[62:63], v13 offset:31232
  v_add_f32_dpp v22, v22, v22 row_mirror row_mask:0xf bank_mask:0xf
  v_add_f32_dpp v23, v23, v23 row_mirror row_mask:0xf bank_mask:0xf
  v_mov_b32 v20, v22
  s_nop 1
  v_permlane16_swap_b32 v22, v20
  v_add_f32 v22, v22, v20
  v_mov_b32 v20, v23
  s_nop 1
  v_permlane16_swap_b32 v23, v20
  v_add_f32 v23, v23, v20
  s_cmp_lg_u32 s75, 0
  s_cbranch_scc1 L_skip_209
  s_call_b64 s[96:97], L_DMA
  v_mfma_f32_4x4x4_16b_bf16 v[116:119], v[16:17], v[32:33], v[116:119]
  v_mfma_f32_4x4x4_16b_bf16 v[120:123], v[16:17], v[36:37], v[120:123]
  s_nop 0
  v_mfma_f32_4x4x4_16b_bf16 v[116:119], v[16:17], v[34:35], v[116:119]
  v_mfma_f32_4x4x4_16b_bf16 v[120:123], v[16:17], v[38:39], v[120:123]
L_skip_209:
  s_waitcnt lgkmcnt(10)
  v_mfma_f32_32x32x16_bf16 v[68:83], v[40:43], v[164:167], v[68:83]
  v_add_u32 v8, 36864, v8
  v_add_u32 v9, 36864, v9
  v_add_u32 v10, 36864, v10
  v_add_u32 v11, 36864, v11
  v_add_u32 v12, 36864, v12
  v_add_u32 v13, 36864, v13
  ds_read_b128 v[176:179], v8
  ds_read_b64_tr_b16 v[32:33], v12 offset:24576
  ds_read_b64_tr_b16 v[34:35], v12 offset:25088
  v_mfma_f32_32x32x16_bf16 v[84:99], v[44:47], v[164:167], v[84:99]
  ds_read_b64_tr_b16 v[36:37], v13 offset:24576
  ds_read_b64_tr_b16 v[38:39], v13 offset:25088
  v_mov_b32 v20, v22
  s_nop 1
  v_permlane32_swap_b32 v22, v20
  v_add_f32 v22, v22, v20
  v_mov_b32 v20, v23
  s_nop 1
  v_permlane32_swap_b32 v23, v20
  v_add_f32 v23, v23, v20
  v_mul_f32 v22, 0x3b124925, v22
  v_mul_f32 v23, 0x3b124925, v23
  v_fma_f32 v23, -v22, v22, v23
  v_max_f32 v23, 0, v23
  v_cvt_pk_bf16_f32 v23, v23, v23
  v_lshlrev_b32 v23, 16, v23
  v_add_f32 v23, 0x3727c5ac, v23
  v_cvt_pk_bf16_f32 v23, v23, v23
  v_lshlrev_b32 v23, 16, v23
  s_cmp_lg_u32 s75, 1
  s_cbranch_scc1 L_skip_210
  s_call_b64 s[96:97], L_DMA
  v_mfma_f32_4x4x4_16b_bf16 v[116:119], v[16:17], v[40:41], v[116:119]
  v_mfma_f32_4x4x4_16b_bf16 v[120:123], v[16:17], v[44:45], v[120:123]
  s_nop 0
  v_mfma_f32_4x4x4_16b_bf16 v[116:119], v[16:17], v[42:43], v[116:119]
  v_mfma_f32_4x4x4_16b_bf16 v[120:123], v[16:17], v[46:47], v[120:123]
L_skip_210:
  s_waitcnt lgkmcnt(10)
  v_mfma_f32_32x32x16_bf16 v[68:83], v[48:51], v[168:171], v[68:83]
  ds_read_b128 v[180:183], v9
  ds_read_b64_tr_b16 v[40:41], v12 offset:26624
  ds_read_b64_tr_b16 v[42:43], v12 offset:27136
  v_mfma_f32_32x32x16_bf16 v[84:99], v[52:55], v[168:171], v[84:99]
  ds_read_b64_tr_b16 v[44:45], v13 offset:26624
  ds_read_b64_tr_b16 v[46:47], v13 offset:27136
  v_sqrt_f32 v23, v23
  v_mov_b32 v20, 0
  v_mov_b32 v25, s74
  v_cvt_pk_bf16_f32 v24, v23, v22
  s_mov_b64 s[100:101], exec
  s_mov_b64 exec, 1
  buffer_store_dwordx2 v[24:25], v20, s[48:51], s3 offen sc1
  s_mov_b64 exec, s[100:101]
  s_cmp_lg_u32 s75, 2
  s_cbranch_scc1 L_skip_211
  s_call_b64 s[96:97], L_DMA
  v_mfma_f32_4x4x4_16b_bf16 v[116:119], v[16:17], v[48:49], v[116:119]
  v_mfma_f32_4x4x4_16b_bf16 v[120:123], v[16:17], v[52:53], v[120:123]
  s_nop 0
  v_mfma_f32_4x4x4_16b_bf16 v[116:119], v[16:17], v[50:51], v[116:119]
  v_mfma_f32_4x4x4_16b_bf16 v[120:123], v[16:17], v[54:55], v[120:123]
L_skip_211:
  s_waitcnt lgkmcnt(10)
  v_mfma_f32_32x32x16_bf16 v[68:83], v[56:59], v[172:175], v[68:83]
  ds_read_b128 v[184:187], v10
  ds_read_b64_tr_b16 v[48:49], v12 offset:28672
  ds_read_b64_tr_b16 v[50:51], v12 offset:29184
  v_mfma_f32_32x32x16_bf16 v[84:99], v[60:63], v[172:175], v[84:99]
  ds_read_b64_tr_b16 v[52:53], v13 offset:28672
  ds_read_b64_tr_b16 v[54:55], v13 offset:29184
  s_cmp_lg_u32 s75, 3
  s_cbranch_scc1 L_skip_212
  s_call_b64 s[96:97], L_DMA
  v_mfma_f32_4x4x4_16b_bf16 v[116:119], v[16:17], v[56:57], v[116:119]
  v_mfma_f32_4x4x4_16b_bf16 v[120:123], v[16:17], v[60:61], v[120:123]
  s_nop 0
  v_mfma_f32_4x4x4_16b_bf16 v[116:119], v[16:17], v[58:59], v[116:119]
  v_mfma_f32_4x4x4_16b_bf16 v[120:123], v[16:17], v[62:63], v[120:123]
L_skip_212:
  s_waitcnt vmcnt(5)
  s_barrier
  s_waitcnt lgkmcnt(10)
  v_mfma_f32_32x32x16_bf16 v[68:83], v[32:35], v[176:179], v[68:83]
  ds_read_b128 v[188:191], v11
  ds_read_b64_tr_b16 v[56:57], v12 offset:30720
  ds_read_b64_tr_b16 v[58:59], v12 offset:31232
  v_mfma_f32_32x32x16_bf16 v[84:99], v[36:39], v[176:179], v[84:99]
  ds_read_b64_tr_b16 v[60:61], v13 offset:30720
  ds_read_b64_tr_b16 v[62:63], v13 offset:31232
  s_cmp_lg_u32 s75, 0
  s_cbranch_scc1 L_skip_213
  s_call_b64 s[96:97], L_DMA
  v_mfma_f32_4x4x4_16b_bf16 v[116:119], v[16:17], v[32:33], v[116:119]
  v_mfma_f32_4x4x4_16b_bf16 v[120:123], v[16:17], v[36:37], v[120:123]
  s_nop 0
  v_mfma_f32_4x4x4_16b_bf16 v[116:119], v[16:17], v[34:35], v[116:119]
  v_mfma_f32_4x4x4_16b_bf16 v[120:123], v[16:17], v[38:39], v[120:123]
L_skip_213:
  s_waitcnt lgkmcnt(10)
  v_mfma_f32_32x32x16_bf16 v[68:83], v[40:43], v[180:183], v[68:83]
  v_subrev_u32 v8, 110592, v8
  v_subrev_u32 v9, 110592, v9
  v_subrev_u32 v10, 110592, v10
  v_subrev_u32 v11, 110592, v11
  v_subrev_u32 v12, 110592, v12
  v_subrev_u32 v13, 110592, v13
  ds_read_b128 v[192:195], v8
  ds_read_b64_tr_b16 v[32:33], v12 offset:24576
  ds_read_b64_tr_b16 v[34:35], v12 offset:25088
  v_mfma_f32_32x32x16_bf16 v[84:99], v[44:47], v[180:183], v[84:99]
  ds_read_b64_tr_b16 v[36:37], v13 offset:24576
  ds_read_b64_tr_b16 v[38:39], v13 offset:25088
  s_cmp_lg_u32 s75, 1
  s_cbranch_scc1 L_skip_214
  s_call_b64 s[96:97], L_DMA
  v_mfma_f32_4x4x4_16b_bf16 v[116:119], v[16:17], v[40:41], v[116:119]
  v_mfma_f32_4x4x4_16b_bf16 v[120:123], v[16:17], v[44:45], v[120:123]
  s_nop 0
  v_mfma_f32_4x4x4_16b_bf16 v[116:119], v[16:17], v[42:43], v[116:119]
  v_mfma_f32_4x4x4_16b_bf16 v[120:123], v[16:17], v[46:47], v[120:123]
L_skip_214:
  s_waitcnt lgkmcnt(10)
  v_mfma_f32_32x32x16_bf16 v[68:83], v[48:51], v[184:187], v[68:83]
  ds_read_b128 v[196:199], v9
  ds_read_b64_tr_b16 v[40:41], v12 offset:26624
  ds_read_b64_tr_b16 v[42:43], v12 offset:27136
  v_mfma_f32_32x32x16_bf16 v[84:99], v[52:55], v[184:187], v[84:99]
  ds_read_b64_tr_b16 v[44:45], v13 offset:26624
  ds_read_b64_tr_b16 v[46:47], v13 offset:27136
  s_cmp_lg_u32 s75, 2
  s_cbranch_scc1 L_skip_215
  s_call_b64 s[96:97], L_DMA
  v_mfma_f32_4x4x4_16b_bf16 v[116:119], v[16:17], v[48:49], v[116:119]
  v_mfma_f32_4x4x4_16b_bf16 v[120:123], v[16:17], v[52:53], v[120:123]
  s_nop 0
  v_mfma_f32_4x4x4_16b_bf16 v[116:119], v[16:17], v[50:51], v[116:119]
  v_mfma_f32_4x4x4_16b_bf16 v[120:123], v[16:17], v[54:55], v[120:123]
L_skip_215:
  s_waitcnt lgkmcnt(10)
  v_mfma_f32_32x32x16_bf16 v[68:83], v[56:59], v[188:191], v[68:83]
  ds_read_b128 v[200:203], v10
  ds_read_b64_tr_b16 v[48:49], v12 offset:28672
  ds_read_b64_tr_b16 v[50:51], v12 offset:29184
  v_mfma_f32_32x32x16_bf16 v[84:99], v[60:63], v[188:191], v[84:99]
  ds_read_b64_tr_b16 v[52:53], v13 offset:28672
  ds_read_b64_tr_b16 v[54:55], v13 offset:29184
  s_cmp_lg_u32 s75, 3
  s_cbranch_scc1 L_skip_216
  s_call_b64 s[96:97], L_DMA
  v_mfma_f32_4x4x4_16b_bf16 v[116:119], v[16:17], v[56:57], v[116:119]
  v_mfma_f32_4x4x4_16b_bf16 v[120:123], v[16:17], v[60:61], v[120:123]
  s_nop 0
  v_mfma_f32_4x4x4_16b_bf16 v[116:119], v[16:17], v[58:59], v[116:119]
  v_mfma_f32_4x4x4_16b_bf16 v[120:123], v[16:17], v[62:63], v[120:123]
L_skip_216:
  s_waitcnt vmcnt(5)
  s_barrier
  s_lshl_b32 s90, s68, 10
  s_lshl_b32 s91, s71, 8
  s_add_u32 s90, s90, s91
  s_add_u32 s3, s90, 184320
  v_lshlrev_b32 v24, 3, v2
  buffer_load_dwordx2 v[18:19], v24, s[48:51], s3 offen sc1
  s_mov_b32 s24, 4
  s_lshl_b32 s23, s70, 10
  s_add_u32 s23, s23, 110592
  s_waitcnt lgkmcnt(10)
  v_mfma_f32_32x32x16_bf16 v[68:83], v[32:35], v[192:195], v[68:83]
  ds_read_b128 v[204:207], v11
  ds_read_b64_tr_b16 v[56:57], v12 offset:30720
  ds_read_b64_tr_b16 v[58:59], v12 offset:31232
  v_mfma_f32_32x32x16_bf16 v[84:99], v[36:39], v[192:195], v[84:99]
  ds_read_b64_tr_b16 v[60:61], v13 offset:30720
  ds_read_b64_tr_b16 v[62:63], v13 offset:31232
  s_cmp_lg_u32 s75, 0
  s_cbranch_scc1 L_skip_217
  s_call_b64 s[96:97], L_DMA2
  v_mfma_f32_4x4x4_16b_bf16 v[116:119], v[16:17], v[32:33], v[116:119]
  v_mfma_f32_4x4x4_16b_bf16 v[120:123], v[16:17], v[36:37], v[120:123]
  s_nop 0
  v_mfma_f32_4x4x4_16b_bf16 v[116:119], v[16:17], v[34:35], v[116:119]
  v_mfma_f32_4x4x4_16b_bf16 v[120:123], v[16:17], v[38:39], v[120:123]
L_skip_217:
  s_waitcnt lgkmcnt(10)
  v_mfma_f32_32x32x16_bf16 v[68:83], v[40:43], v[196:199], v[68:83]
  v_add_u32 v8, 36864, v8
  v_add_u32 v9, 36864, v9
  v_add_u32 v10, 36864, v10
  v_add_u32 v11, 36864, v11
  v_add_u32 v12, 36864, v12
  v_add_u32 v13, 36864, v13
  ds_read_b128 v[208:211], v8
  ds_read_b64_tr_b16 v[32:33], v12 offset:24576
  ds_read_b64_tr_b16 v[34:35], v12 offset:25088
  v_mfma_f32_32x32x16_bf16 v[84:99], v[44:47], v[196:199], v[84:99]
  ds_read_b64_tr_b16 v[36:37], v13 offset:24576
  ds_read_b64_tr_b16 v[38:39], v13 offset:25088
  s_cmp_lg_u32 s75, 1
  s_cbranch_scc1 L_skip_218
  s_call_b64 s[96:97], L_DMA2
  v_mfma_f32_4x4x4_16b_bf16 v[116:119], v[16:17], v[40:41], v[116:119]
  v_mfma_f32_4x4x4_16b_bf16 v[120:123], v[16:17], v[44:45], v[120:123]
  s_nop 0
  v_mfma_f32_4x4x4_16b_bf16 v[116:119], v[16:17], v[42:43], v[116:119]
  v_mfma_f32_4x4x4_16b_bf16 v[120:123], v[16:17], v[46:47], v[120:123]
L_skip_218:
  s_waitcnt lgkmcnt(10)
  v_mfma_f32_32x32x16_bf16 v[68:83], v[48:51], v[200:203], v[68:83]
  ds_read_b128 v[212:215], v9
  ds_read_b64_tr_b16 v[40:41], v12 offset:26624
  ds_read_b64_tr_b16 v[42:43], v12 offset:27136
  v_mfma_f32_32x32x16_bf16 v[84:99], v[52:55], v[200:203], v[84:99]
  ds_read_b64_tr_b16 v[44:45], v13 offset:26624
  ds_read_b64_tr_b16 v[46:47], v13 offset:27136
  s_cmp_lg_u32 s75, 2
  s_cbranch_scc1 L_skip_219
  s_call_b64 s[96:97], L_DMA2
  v_mfma_f32_4x4x4_16b_bf16 v[116:119], v[16:17], v[48:49], v[116:119]
  v_mfma_f32_4x4x4_16b_bf16 v[120:123], v[16:17], v[52:53], v[120:123]
  s_nop 0
  v_mfma_f32_4x4x4_16b_bf16 v[116:119], v[16:17], v[50:51], v[116:119]
  v_mfma_f32_4x4x4_16b_bf16 v[120:123], v[16:17], v[54:55], v[120:123]
L_skip_219:
  s_waitcnt lgkmcnt(10)
  v_mfma_f32_32x32x16_bf16 v[68:83], v[56:59], v[204:207], v[68:83]
  ds_read_b128 v[216:219], v10
  ds_read_b64_tr_b16 v[48:49], v12 offset:28672
  ds_read_b64_tr_b16 v[50:51], v12 offset:29184
  v_mfma_f32_32x32x16_bf16 v[84:99], v[60:63], v[204:207], v[84:99]
  ds_read_b64_tr_b16 v[52:53], v13 offset:28672
  ds_read_b64_tr_b16 v[54:55], v13 offset:29184
  s_cmp_lg_u32 s75, 3
  s_cbranch_scc1 L_skip_220
  s_call_b64 s[96:97], L_DMA2
  v_mfma_f32_4x4x4_16b_bf16 v[116:119], v[16:17], v[56:57], v[116:119]
  v_mfma_f32_4x4x4_16b_bf16 v[120:123], v[16:17], v[60:61], v[120:123]
  s_nop 0
  v_mfma_f32_4x4x4_16b_bf16 v[116:119], v[16:17], v[58:59], v[116:119]
  v_mfma_f32_4x4x4_16b_bf16 v[120:123], v[16:17], v[62:63], v[120:123]
L_skip_220:
  s_waitcnt vmcnt(5)
  s_barrier
  s_mov_b32 s24, 3
  s_lshl_b32 s23, s70, 10
  s_waitcnt lgkmcnt(10)
  v_mfma_f32_32x32x16_bf16 v[68:83], v[32:35], v[208:211], v[68:83]
  ds_read_b128 v[220:223], v11
  ds_read_b64_tr_b16 v[56:57], v12 offset:30720
  ds_read_b64_tr_b16 v[58:59], v12 offset:31232
  v_mfma_f32_32x32x16_bf16 v[84:99], v[36:39], v[208:211], v[84:99]
  ds_read_b64_tr_b16 v[60:61], v13 offset:30720
  ds_read_b64_tr_b16 v[62:63], v13 offset:31232
  s_cmp_lg_u32 s75, 0
  s_cbranch_scc1 L_skip_221
  s_call_b64 s[96:97], L_DMA2
  v_mfma_f32_4x4x4_16b_bf16 v[116:119], v[16:17], v[32:33], v[116:119]
  v_mfma_f32_4x4x4_16b_bf16 v[120:123], v[16:17], v[36:37], v[120:123]
  s_nop 0
  v_mfma_f32_4x4x4_16b_bf16 v[116:119], v[16:17], v[34:35], v[116:119]
  v_mfma_f32_4x4x4_16b_bf16 v[120:123], v[16:17], v[38:39], v[120:123]
L_skip_221:
  s_waitcnt lgkmcnt(10)
  v_mfma_f32_32x32x16_bf16 v[68:83], v[40:43], v[212:215], v[68:83]
  v_add_u32 v8, 36864, v8
  v_add_u32 v9, 36864, v9
  v_add_u32 v10, 36864, v10
  v_add_u32 v11, 36864, v11
  v_add_u32 v12, 36864, v12
  v_add_u32 v13, 36864, v13
  ds_read_b128 v[224:227], v8
  ds_read_b64_tr_b16 v[32:33], v12 offset:24576
  ds_read_b64_tr_b16 v[34:35], v12 offset:25088
  v_mfma_f32_32x32x16_bf16 v[84:99], v[44:47], v[212:215], v[84:99]
  ds_read_b64_tr_b16 v[36:37], v13 offset:24576
  ds_read_b64_tr_b16 v[38:39], v13 offset:25088
  s_cmp_lg_u32 s75, 1
  s_cbranch_scc1 L_skip_222
  s_call_b64 s[96:97], L_DMA2
  v_mfma_f32_4x4x4_16b_bf16 v[116:119], v[16:17], v[40:41], v[116:119]
  v_mfma_f32_4x4x4_16b_bf16 v[120:123], v[16:17], v[44:45], v[120:123]
  s_nop 0
  v_mfma_f32_4x4x4_16b_bf16 v[116:119], v[16:17], v[42:43], v[116:119]
  v_mfma_f32_4x4x4_16b_bf16 v[120:123], v[16:17], v[46:47], v[120:123]
L_skip_222:
  s_waitcnt lgkmcnt(10)
  v_mfma_f32_32x32x16_bf16 v[68:83], v[48:51], v[216:219], v[68:83]
  ds_read_b128 v[228:231], v9
  ds_read_b64_tr_b16 v[40:41], v12 offset:26624
  ds_read_b64_tr_b16 v[42:43], v12 offset:27136
  v_mfma_f32_32x32x16_bf16 v[84:99], v[52:55], v[216:219], v[84:99]
  ds_read_b64_tr_b16 v[44:45], v13 offset:26624
  ds_read_b64_tr_b16 v[46:47], v13 offset:27136
  s_cmp_lg_u32 s75, 2
  s_cbranch_scc1 L_skip_223
  s_call_b64 s[96:97], L_DMA2
  v_mfma_f32_4x4x4_16b_bf16 v[116:119], v[16:17], v[48:49], v[116:119]
  v_mfma_f32_4x4x4_16b_bf16 v[120:123], v[16:17], v[52:53], v[120:123]
  s_nop 0
  v_mfma_f32_4x4x4_16b_bf16 v[116:119], v[16:17], v[50:51], v[116:119]
  v_mfma_f32_4x4x4_16b_bf16 v[120:123], v[16:17], v[54:55], v[120:123]
L_skip_223:
  s_waitcnt lgkmcnt(10)
  v_mfma_f32_32x32x16_bf16 v[68:83], v[56:59], v[220:223], v[68:83]
  ds_read_b128 v[232:235], v10
  ds_read_b64_tr_b16 v[48:49], v12 offset:28672
  ds_read_b64_tr_b16 v[50:51], v12 offset:29184
  v_mfma_f32_32x32x16_bf16 v[84:99], v[60:63], v[220:223], v[84:99]
  ds_read_b64_tr_b16 v[52:53], v13 offset:28672
  ds_read_b64_tr_b16 v[54:55], v13 offset:29184
  s_cmp_lg_u32 s75, 3
  s_cbranch_scc1 L_skip_224
  s_call_b64 s[96:97], L_DMA2
  v_mfma_f32_4x4x4_16b_bf16 v[116:119], v[16:17], v[56:57], v[116:119]
  v_mfma_f32_4x4x4_16b_bf16 v[120:123], v[16:17], v[60:61], v[120:123]
  s_nop 0
  v_mfma_f32_4x4x4_16b_bf16 v[116:119], v[16:17], v[58:59], v[116:119]
  v_mfma_f32_4x4x4_16b_bf16 v[120:123], v[16:17], v[62:63], v[120:123]
L_skip_224:
  s_barrier
  s_waitcnt lgkmcnt(10)
  v_mfma_f32_32x32x16_bf16 v[68:83], v[32:35], v[224:227], v[68:83]
  ds_read_b128 v[236:239], v11
  ds_read_b64_tr_b16 v[56:57], v12 offset:30720
  ds_read_b64_tr_b16 v[58:59], v12 offset:31232
  v_mfma_f32_32x32x16_bf16 v[84:99], v[36:39], v[224:227], v[84:99]
  ds_read_b64_tr_b16 v[60:61], v13 offset:30720
  ds_read_b64_tr_b16 v[62:63], v13 offset:31232
  s_cmp_lg_u32 s75, 0
  s_cbranch_scc1 L_skip_225
  v_mfma_f32_4x4x4_16b_bf16 v[116:119], v[16:17], v[32:33], v[116:119]
  v_mfma_f32_4x4x4_16b_bf16 v[120:123], v[16:17], v[36:37], v[120:123]
  s_nop 0
  v_mfma_f32_4x4x4_16b_bf16 v[116:119], v[16:17], v[34:35], v[116:119]
  v_mfma_f32_4x4x4_16b_bf16 v[120:123], v[16:17], v[38:39], v[120:123]
L_skip_225:
  s_waitcnt lgkmcnt(10)
  v_mfma_f32_32x32x16_bf16 v[68:83], v[40:43], v[228:231], v[68:83]
  v_mfma_f32_32x32x16_bf16 v[84:99], v[44:47], v[228:231], v[84:99]
  s_cmp_lg_u32 s75, 1
  s_cbranch_scc1 L_skip_226
  v_mfma_f32_4x4x4_16b_bf16 v[116:119], v[16:17], v[40:41], v[116:119]
  v_mfma_f32_4x4x4_16b_bf16 v[120:123], v[16:17], v[44:45], v[120:123]
  s_nop 0
  v_mfma_f32_4x4x4_16b_bf16 v[116:119], v[16:17], v[42:43], v[116:119]
  v_mfma_f32_4x4x4_16b_bf16 v[120:123], v[16:17], v[46:47], v[120:123]
L_skip_226:
  s_waitcnt lgkmcnt(5)
  v_mfma_f32_32x32x16_bf16 v[68:83], v[48:51], v[232:235], v[68:83]
  v_mfma_f32_32x32x16_bf16 v[84:99], v[52:55], v[232:235], v[84:99]
  s_cmp_lg_u32 s75, 2
  s_cbranch_scc1 L_skip_227
  v_mfma_f32_4x4x4_16b_bf16 v[116:119], v[16:17], v[48:49], v[116:119]
  v_mfma_f32_4x4x4_16b_bf16 v[120:123], v[16:17], v[52:53], v[120:123]
  s_nop 0
  v_mfma_f32_4x4x4_16b_bf16 v[116:119], v[16:17], v[50:51], v[116:119]
  v_mfma_f32_4x4x4_16b_bf16 v[120:123], v[16:17], v[54:55], v[120:123]
L_skip_227:
  s_waitcnt lgkmcnt(0)
  v_mfma_f32_32x32x16_bf16 v[68:83], v[56:59], v[236:239], v[68:83]
  v_mfma_f32_32x32x16_bf16 v[84:99], v[60:63], v[236:239], v[84:99]
  s_cmp_lg_u32 s75, 3
  s_cbranch_scc1 L_skip_228
  v_mfma_f32_4x4x4_16b_bf16 v[116:119], v[16:17], v[56:57], v[116:119]
  v_mfma_f32_4x4x4_16b_bf16 v[120:123], v[16:17], v[60:61], v[120:123]
  s_nop 0
  v_mfma_f32_4x4x4_16b_bf16 v[116:119], v[16:17], v[58:59], v[116:119]
  v_mfma_f32_4x4x4_16b_bf16 v[120:123], v[16:17], v[62:63], v[120:123]
L_skip_228:
  s_nop 4
  s_lshl_b32 s90, s71, 2
  v_lshlrev_b32 v125, 4, v2
  v_add_u32 v125, s90, v125
  v_add_u32 v125, 152320, v125
  v_mov_b32 v124, v116
  s_nop 1
  v_permlane32_swap_b32 v116, v124
  v_add_f32 v116, v116, v124
  ds_write_b32 v125, v116 offset:1024
  v_mov_b32 v124, v120
  s_nop 1
  v_permlane32_swap_b32 v120, v124
  v_add_f32 v120, v120, v124
  ds_write_b32 v125, v120 offset:1536
  s_waitcnt lgkmcnt(0)
  s_waitcnt vmcnt(0)
  s_barrier
  s_mul_i32 s90, s70, 384
  v_lshlrev_b32 v8, 4, v3
  v_add_u32 v8, s90, v8
  v_add_u32 v8, 155904, v8
  v_lshlrev_b32 v125, 4, v2
  v_add_u32 v125, 152320, v125
  ds_read_b128 v[116:119], v125 offset:1024
  ds_read_b128 v[120:123], v125 offset:1536
  s_mul_i32 s90, s70, 384
  v_lshlrev_b32 v124, 2, v2
  v_add_u32 v124, s90, v124
  v_add_u32 v124, 155904, v124
  s_waitcnt lgkmcnt(1)
  v_add_f32 v116, v116, v117
  v_add_f32 v118, v118, v119
  v_add_f32 v116, v116, v118
  ds_write_b32 v124, v116 offset:0
  s_waitcnt lgkmcnt(1)
  v_add_f32 v120, v120, v121
  v_add_f32 v122, v122, v123
  v_add_f32 v120, v120, v122
  ds_write_b32 v124, v120 offset:128
  s_waitcnt lgkmcnt(0)
  s_mov_b32 s95, 0
L_gr_229:
  v_cmp_ne_u32 vcc, s74, v19
  s_add_u32 s95, s95, 1
  s_cmp_eq_u64 vcc, 0
  s_cbranch_scc1 L_grdone_230
  buffer_load_dwordx2 v[18:19], v24, s[48:51], s3 offen sc1
  s_waitcnt vmcnt(0)
  s_cmp_lt_u32 s95, 0x20000
  s_cbranch_scc1 L_gr_229
L_grdone_230:
  v_and_b32 v30, s6, v18
  v_lshlrev_b32 v124, 16, v18
  v_xor_b32 v30, 0x80000000, v30
  v_rcp_f32 v31, v124
  v_lshrrev_b32 v124, 4, v1
  v_and_b32 v124, 1, v124
  v_lshlrev_b32 v124, 5, v124
  v_and_b32 v125, 3, v1
  v_lshl_add_u32 v124, v125, 3, v124
  v_add_u32 v124, 56, v124
  v_lshlrev_b32 v125, 3, v1
  v_and_b32 v125, 64, v125
  v_xor_b32 v124, v124, v125
  v_lshrrev_b32 v125, 2, v1
  v_and_b32 v125, 3, v125
  v_mad_u32_u24 v15, v3, 8, v125
  v_lshl_add_u32 v15, v15, 7, v124
  v_add_u32 v12, 110592, v15
  v_mov_b32 v26, 0
  v_mov_b32 v27, 0
  v_mov_b32 v28, 0
  v_mov_b32 v29, 0
  ds_read_b64_tr_b16 v[32:33], v12 offset:0
  ds_read_b64_tr_b16 v[34:35], v12 offset:512
  ds_read_b64_tr_b16 v[36:37], v12 offset:2048
  ds_read_b64_tr_b16 v[38:39], v12 offset:2560
  ds_read_b64_tr_b16 v[40:41], v12 offset:4096
  ds_read_b64_tr_b16 v[42:43], v12 offset:4608
  v_lshlrev_b32 v9, 4, v3
  v_add_u32 v9, 151680, v9
  v_lshlrev_b32 v10, 4, v1
  ds_read_b128 v[48:51], v8 offset:0
  ds_read_b128 v[52:55], v8 offset:32
  ds_read_b128 v[56:59], v9 offset:256
  ds_read_b128 v[60:63], v9 offset:288
  s_waitcnt lgkmcnt(2)
  v_fma_f32 v68, v48, v30, v68
  v_mfma_f32_32x32x16_bf16 v[240:255], v[32:35], v[128:131], 0
  s_cmp_lg_u32 s71, 0
  s_cbranch_scc1 L_skip_231
  v_mfma_f32_4x4x4_16b_bf16 v[26:29], v[16:17], v[32:33], v[26:29]
  s_nop 1
  v_mfma_f32_4x4x4_16b_bf16 v[26:29], v[16:17], v[34:35], v[26:29]
L_skip_231:
  ds_read_b64_tr_b16 v[44:45], v12 offset:6144
  ds_read_b64_tr_b16 v[46:47], v12 offset:6656
  v_fma_f32 v69, v49, v30, v69
  v_fma_f32 v70, v50, v30, v70
  v_fma_f32 v71, v51, v30, v71
  v_fma_f32 v72, v52, v30, v72
  v_fma_f32 v73, v53, v30, v73
  v_mfma_f32_32x32x16_bf16 v[240:255], v[36:39], v[132:135], v[240:255]
  s_cmp_lg_u32 s71, 1
  s_cbranch_scc1 L_skip_232
  v_mfma_f32_4x4x4_16b_bf16 v[26:29], v[16:17], v[36:37], v[26:29]
  s_nop 1
  v_mfma_f32_4x4x4_16b_bf16 v[26:29], v[16:17], v[38:39], v[26:29]
L_skip_232:
  ds_read_b64_tr_b16 v[32:33], v12 offset:8192
  ds_read_b64_tr_b16 v[34:35], v12 offset:8704
  s_lshr_b32 s92, s2, 3
  s_mul_i32 s93, s92, 50176
  s_mul_i32 s94, s70, 6272
  s_add_u32 s80, s93, s94
  s_mul_i32 s93, s92, 12544
  s_mul_i32 s94, s70, 1568
  s_add_u32 s81, s93, s94
  v_lshlrev_b32 v6, 4, v1
  v_fma_f32 v74, v54, v30, v74
  v_fma_f32 v75, v55, v30, v75
  ds_read_b128 v[48:51], v8 offset:64
  ds_read_b128 v[52:55], v8 offset:96
  s_waitcnt lgkmcnt(6)
  v_fma_f32 v68, v68, v31, v56
  v_fma_f32 v69, v69, v31, v57
  v_fma_f32 v70, v70, v31, v58
  v_fma_f32 v71, v71, v31, v59
  v_mfma_f32_32x32x16_bf16 v[240:255], v[40:43], v[136:139], v[240:255]
  s_cmp_lg_u32 s71, 2
  s_cbranch_scc1 L_skip_233
  v_mfma_f32_4x4x4_16b_bf16 v[26:29], v[16:17], v[40:41], v[26:29]
  s_nop 1
  v_mfma_f32_4x4x4_16b_bf16 v[26:29], v[16:17], v[42:43], v[26:29]
L_skip_233:
  ds_read_b64_tr_b16 v[36:37], v12 offset:10240
  ds_read_b64_tr_b16 v[38:39], v12 offset:10752
  v_fma_f32 v72, v72, v31, v60
  v_fma_f32 v73, v73, v31, v61
  v_fma_f32 v74, v74, v31, v62
  v_fma_f32 v75, v75, v31, v63
  ds_read_b128 v[56:59], v9 offset:320
  ds_read_b128 v[60:63], v9 offset:352
  v_max_f32 v68, 0, v68
  s_waitcnt lgkmcnt(8)
  v_mfma_f32_32x32x16_bf16 v[240:255], v[44:47], v[140:143], v[240:255]
  s_cmp_lg_u32 s71, 3
  s_cbranch_scc1 L_skip_234
  v_mfma_f32_4x4x4_16b_bf16 v[26:29], v[16:17], v[44:45], v[26:29]
  s_nop 1
  v_mfma_f32_4x4x4_16b_bf16 v[26:29], v[16:17], v[46:47], v[26:29]
L_skip_234:
  ds_read_b64_tr_b16 v[40:41], v12 offset:12288
  ds_read_b64_tr_b16 v[42:43], v12 offset:12800
  v_max_f32 v69, 0, v69
  v_max_f32 v70, 0, v70
  v_max_f32 v71, 0, v71
  v_max_f32 v72, 0, v72
  v_max_f32 v73, 0, v73
  s_waitcnt lgkmcnt(8)
  v_mfma_f32_32x32x16_bf16 v[240:255], v[32:35], v[144:147], v[240:255]
  s_cmp_lg_u32 s71, 0
  s_cbranch_scc1 L_skip_235
  v_mfma_f32_4x4x4_16b_bf16 v[26:29], v[16:17], v[32:33], v[26:29]
  s_nop 1
  v_mfma_f32_4x4x4_16b_bf16 v[26:29], v[16:17], v[34:35], v[26:29]
L_skip_235:
  ds_read_b64_tr_b16 v[44:45], v12 offset:14336
  ds_read_b64_tr_b16 v[46:47], v12 offset:14848
  s_add_u32 s82, s80, 0
  s_mov_b32 m0, 160000
  s_nop 0
  buffer_load_dwordx4 v6, s[40:43], s82 offen lds
  v_max_f32 v74, 0, v74
  v_max_f32 v75, 0, v75
  v_mul_f32 v68, v68, v68
  v_mul_f32 v69, v69, v69
  v_mul_f32 v70, v70, v70
  v_mul_f32 v71, v71, v71
  s_waitcnt lgkmcnt(6)
  v_mfma_f32_32x32x16_bf16 v[240:255], v[36:39], v[148:151], v[240:255]
  s_cmp_lg_u32 s71, 1
  s_cbranch_scc1 L_skip_236
  v_mfma_f32_4x4x4_16b_bf16 v[26:29], v[16:17], v[36:37], v[26:29]
  s_nop 1
  v_mfma_f32_4x4x4_16b_bf16 v[26:29], v[16:17], v[38:39], v[26:29]
L_skip_236:
  ds_read_b64_tr_b16 v[32:33], v12 offset:16384
  ds_read_b64_tr_b16 v[34:35], v12 offset:16896
  v_mul_f32 v72, v72, v72
  v_mul_f32 v73, v73, v73
  v_mul_f32 v74, v74, v74
  v_mul_f32 v75, v75, v75
  v_cvt_pk_bf16_f32 v68, v68, v69
  s_waitcnt lgkmcnt(4)
  v_mfma_f32_32x32x16_bf16 v[240:255], v[40:43], v[152:155], v[240:255]
  s_cmp_lg_u32 s71, 2
  s_cbranch_scc1 L_skip_237
  v_mfma_f32_4x4x4_16b_bf16 v[26:29], v[16:17], v[40:41], v[26:29]
  s_nop 1
  v_mfma_f32_4x4x4_16b_bf16 v[26:29], v[16:17], v[42:43], v[26:29]
L_skip_237:
  ds_read_b64_tr_b16 v[36:37], v12 offset:18432
  ds_read_b64_tr_b16 v[38:39], v12 offset:18944
  v_cvt_pk_bf16_f32 v69, v70, v71
  v_cvt_pk_bf16_f32 v70, v72, v73
  v_cvt_pk_bf16_f32 v71, v74, v75
  s_lshl_b32 s90, s12, 10
  s_add_u32 s90, s90, s15
  buffer_store_dwordx4 v[68:71], v10, s[48:51], s90 offen offset:0 sc1
  v_fma_f32 v76, v48, v30, v76
  s_waitcnt lgkmcnt(4)
  v_mfma_f32_32x32x16_bf16 v[240:255], v[44:47], v[156:159], v[240:255]
  s_cmp_lg_u32 s71, 3
  s_cbranch_scc1 L_skip_238
  v_mfma_f32_4x4x4_16b_bf16 v[26:29], v[16:17], v[44:45], v[26:29]
  s_nop 1
  v_mfma_f32_4x4x4_16b_bf16 v[26:29], v[16:17], v[46:47], v[26:29]
L_skip_238:
  ds_read_b64_tr_b16 v[40:41], v12 offset:20480
  ds_read_b64_tr_b16 v[42:43], v12 offset:20992
  s_add_u32 s82, s80, 1024
  s_mov_b32 m0, 160000
  s_nop 0
  buffer_load_dwordx4 v6, s[40:43], s82 offen lds
  v_fma_f32 v77, v49, v30, v77
  v_fma_f32 v78, v50, v30, v78
  v_fma_f32 v79, v51, v30, v79
  v_fma_f32 v80, v52, v30, v80
  v_fma_f32 v81, v53, v30, v81
  s_waitcnt lgkmcnt(4)
  v_mfma_f32_32x32x16_bf16 v[240:255], v[32:35], v[160:163], v[240:255]
  s_cmp_lg_u32 s71, 0
  s_cbranch_scc1 L_skip_239
  v_mfma_f32_4x4x4_16b_bf16 v[26:29], v[16:17], v[32:33], v[26:29]
  s_nop 1
  v_mfma_f32_4x4x4_16b_bf16 v[26:29], v[16:17], v[34:35], v[26:29]
L_skip_239:
  ds_read_b64_tr_b16 v[44:45], v12 offset:22528
  ds_read_b64_tr_b16 v[46:47], v12 offset:23040
  v_fma_f32 v82, v54, v30, v82
  v_fma_f32 v83, v55, v30, v83
  ds_read_b128 v[48:51], v8 offset:128
  ds_read_b128 v[52:55], v8 offset:160
  v_fma_f32 v76, v76, v31, v56
  v_fma_f32 v77, v77, v31, v57
  v_fma_f32 v78, v78, v31, v58
  v_fma_f32 v79, v79, v31, v59
  s_waitcnt lgkmcnt(6)
  v_mfma_f32_32x32x16_bf16 v[240:255], v[36:39], v[164:167], v[240:255]
  s_cmp_lg_u32 s71, 1
  s_cbranch_scc1 L_skip_240
  v_mfma_f32_4x4x4_16b_bf16 v[26:29], v[16:17], v[36:37], v[26:29]
  s_nop 1
  v_mfma_f32_4x4x4_16b_bf16 v[26:29], v[16:17], v[38:39], v[26:29]
L_skip_240:
  ds_read_b64_tr_b16 v[32:33], v12 offset:24576
  ds_read_b64_tr_b16 v[34:35], v12 offset:25088
  v_fma_f32 v80, v80, v31, v60
  v_fma_f32 v81, v81, v31, v61
  v_fma_f32 v82, v82, v31, v62
  v_fma_f32 v83, v83, v31, v63
  ds_read_b128 v[56:59], v9 offset:384
  ds_read_b128 v[60:63], v9 offset:416
  v_max_f32 v76, 0, v76
  s_waitcnt lgkmcnt(8)
  v_mfma_f32_32x32x16_bf16 v[240:255], v[40:43], v[168:171], v[240:255]
  s_cmp_lg_u32 s71, 2
  s_cbranch_scc1 L_skip_241
  v_mfma_f32_4x4x4_16b_bf16 v[26:29], v[16:17], v[40:41], v[26:29]
  s_nop 1
  v_mfma_f32_4x4x4_16b_bf16 v[26:29], v[16:17], v[42:43], v[26:29]
L_skip_241:
  ds_read_b64_tr_b16 v[36:37], v12 offset:26624
  ds_read_b64_tr_b16 v[38:39], v12 offset:27136
  s_add_u32 s82, s80, 2048
  s_mov_b32 m0, 160000
  s_nop 0
  buffer_load_dwordx4 v6, s[40:43], s82 offen lds
  v_max_f32 v77, 0, v77
  v_max_f32 v78, 0, v78
  v_max_f32 v79, 0, v79
  v_max_f32 v80, 0, v80
  v_max_f32 v81, 0, v81
  s_waitcnt lgkmcnt(8)
  v_mfma_f32_32x32x16_bf16 v[240:255], v[44:47], v[172:175], v[240:255]
  s_cmp_lg_u32 s71, 3
  s_cbranch_scc1 L_skip_242
  v_mfma_f32_4x4x4_16b_bf16 v[26:29], v[16:17], v[44:45], v[26:29]
  s_nop 1
  v_mfma_f32_4x4x4_16b_bf16 v[26:29], v[16:17], v[46:47], v[26:29]
L_skip_242:
  ds_read_b64_tr_b16 v[40:41], v12 offset:28672
  ds_read_b64_tr_b16 v[42:43], v12 offset:29184
  v_max_f32 v82, 0, v82
  v_max_f32 v83, 0, v83
  v_mul_f32 v76, v76, v76
  v_mul_f32 v77, v77, v77
  v_mul_f32 v78, v78, v78
  v_mul_f32 v79, v79, v79
  s_waitcnt lgkmcnt(6)
  v_mfma_f32_32x32x16_bf16 v[240:255], v[32:35], v[176:179], v[240:255]
  s_cmp_lg_u32 s71, 0
  s_cbranch_scc1 L_skip_243
  v_mfma_f32_4x4x4_16b_bf16 v[26:29], v[16:17], v[32:33], v[26:29]
  s_nop 1
  v_mfma_f32_4x4x4_16b_bf16 v[26:29], v[16:17], v[34:35], v[26:29]
L_skip_243:
  ds_read_b64_tr_b16 v[44:45], v12 offset:30720
  ds_read_b64_tr_b16 v[46:47], v12 offset:31232
  v_mul_f32 v80, v80, v80
  v_mul_f32 v81, v81, v81
  v_mul_f32 v82, v82, v82
  v_mul_f32 v83, v83, v83
  v_cvt_pk_bf16_f32 v72, v76, v77
  s_waitcnt lgkmcnt(4)
  v_mfma_f32_32x32x16_bf16 v[240:255], v[36:39], v[180:183], v[240:255]
  s_cmp_lg_u32 s71, 1
  s_cbranch_scc1 L_skip_244
  v_mfma_f32_4x4x4_16b_bf16 v[26:29], v[16:17], v[36:37], v[26:29]
  s_nop 1
  v_mfma_f32_4x4x4_16b_bf16 v[26:29], v[16:17], v[38:39], v[26:29]
L_skip_244:
  ds_read_b64_tr_b16 v[32:33], v15 offset:0
  ds_read_b64_tr_b16 v[34:35], v15 offset:512
  s_add_u32 s82, s80, 3072
  s_mov_b32 m0, 160000
  s_nop 0
  buffer_load_dwordx4 v6, s[40:43], s82 offen lds
  v_cvt_pk_bf16_f32 v73, v78, v79
  v_cvt_pk_bf16_f32 v74, v80, v81
  v_cvt_pk_bf16_f32 v75, v82, v83
  s_lshl_b32 s90, s12, 10
  s_add_u32 s90, s90, s15
  buffer_store_dwordx4 v[72:75], v10, s[48:51], s90 offen offset:1024 sc1
  v_fma_f32 v84, v48, v30, v84
  s_waitcnt lgkmcnt(4)
  v_mfma_f32_32x32x16_bf16 v[240:255], v[40:43], v[184:187], v[240:255]
  s_cmp_lg_u32 s71, 2
  s_cbranch_scc1 L_skip_245
  v_mfma_f32_4x4x4_16b_bf16 v[26:29], v[16:17], v[40:41], v[26:29]
  s_nop 1
  v_mfma_f32_4x4x4_16b_bf16 v[26:29], v[16:17], v[42:43], v[26:29]
L_skip_245:
  ds_read_b64_tr_b16 v[36:37], v15 offset:2048
  ds_read_b64_tr_b16 v[38:39], v15 offset:2560
  v_fma_f32 v85, v49, v30, v85
  v_fma_f32 v86, v50, v30, v86
  v_fma_f32 v87, v51, v30, v87
  v_fma_f32 v88, v52, v30, v88
  v_fma_f32 v89, v53, v30, v89
  s_waitcnt lgkmcnt(4)
  v_mfma_f32_32x32x16_bf16 v[240:255], v[44:47], v[188:191], v[240:255]
  s_cmp_lg_u32 s71, 3
  s_cbranch_scc1 L_skip_246
  v_mfma_f32_4x4x4_16b_bf16 v[26:29], v[16:17], v[44:45], v[26:29]
  s_nop 1
  v_mfma_f32_4x4x4_16b_bf16 v[26:29], v[16:17], v[46:47], v[26:29]
L_skip_246:
  ds_read_b64_tr_b16 v[40:41], v15 offset:4096
  ds_read_b64_tr_b16 v[42:43], v15 offset:4608
  v_fma_f32 v90, v54, v30, v90
  v_fma_f32 v91, v55, v30, v91
  ds_read_b128 v[48:51], v8 offset:192
  ds_read_b128 v[52:55], v8 offset:224
  v_fma_f32 v84, v84, v31, v56
  v_fma_f32 v85, v85, v31, v57
  v_fma_f32 v86, v86, v31, v58
  v_fma_f32 v87, v87, v31, v59
  s_waitcnt lgkmcnt(6)
  v_mfma_f32_32x32x16_bf16 v[240:255], v[32:35], v[192:195], v[240:255]
  s_cmp_lg_u32 s71, 0
  s_cbranch_scc1 L_skip_247
  v_mfma_f32_4x4x4_16b_bf16 v[26:29], v[16:17], v[32:33], v[26:29]
  s_nop 1
  v_mfma_f32_4x4x4_16b_bf16 v[26:29], v[16:17], v[34:35], v[26:29]
L_skip_247:
  ds_read_b64_tr_b16 v[44:45], v15 offset:6144
  ds_read_b64_tr_b16 v[46:47], v15 offset:6656
  s_add_u32 s82, s80, 4096
  s_mov_b32 m0, 160000
  s_nop 0
  buffer_load_dwordx4 v6, s[40:43], s82 offen lds
  v_fma_f32 v88, v88, v31, v60
  v_fma_f32 v89, v89, v31, v61
  v_fma_f32 v90, v90, v31, v62
  v_fma_f32 v91, v91, v31, v63
  ds_read_b128 v[56:59], v9 offset:448
  ds_read_b128 v[60:63], v9 offset:480
  v_max_f32 v84, 0, v84
  s_waitcnt lgkmcnt(8)
  v_mfma_f32_32x32x16_bf16 v[240:255], v[36:39], v[196:199], v[240:255]
  s_cmp_lg_u32 s71, 1
  s_cbranch_scc1 L_skip_248
  v_mfma_f32_4x4x4_16b_bf16 v[26:29], v[16:17], v[36:37], v[26:29]
  s_nop 1
  v_mfma_f32_4x4x4_16b_bf16 v[26:29], v[16:17], v[38:39], v[26:29]
L_skip_248:
  ds_read_b64_tr_b16 v[32:33], v15 offset:8192
  ds_read_b64_tr_b16 v[34:35], v15 offset:8704
  v_max_f32 v85, 0, v85
  v_max_f32 v86, 0, v86
  v_max_f32 v87, 0, v87
  v_max_f32 v88, 0, v88
  v_max_f32 v89, 0, v89
  s_waitcnt lgkmcnt(8)
  v_mfma_f32_32x32x16_bf16 v[240:255], v[40:43], v[200:203], v[240:255]
  s_cmp_lg_u32 s71, 2
  s_cbranch_scc1 L_skip_249
  v_mfma_f32_4x4x4_16b_bf16 v[26:29], v[16:17], v[40:41], v[26:29]
  s_nop 1
  v_mfma_f32_4x4x4_16b_bf16 v[26:29], v[16:17], v[42:43], v[26:29]
L_skip_249:
  ds_read_b64_tr_b16 v[36:37], v15 offset:10240
  ds_read_b64_tr_b16 v[38:39], v15 offset:10752
  v_max_f32 v90, 0, v90
  v_max_f32 v91, 0, v91
  v_mul_f32 v84, v84, v84
  v_mul_f32 v85, v85, v85
  v_mul_f32 v86, v86, v86
  v_mul_f32 v87, v87, v87
  s_waitcnt lgkmcnt(6)
  v_mfma_f32_32x32x16_bf16 v[240:255], v[44:47], v[204:207], v[240:255]
  s_cmp_lg_u32 s71, 3
  s_cbranch_scc1 L_skip_250
  v_mfma_f32_4x4x4_16b_bf16 v[26:29], v[16:17], v[44:45], v[26:29]
  s_nop 1
  v_mfma_f32_4x4x4_16b_bf16 v[26:29], v[16:17], v[46:47], v[26:29]
L_skip_250:
  ds_read_b64_tr_b16 v[40:41], v15 offset:12288
  ds_read_b64_tr_b16 v[42:43], v15 offset:12800
  s_add_u32 s82, s80, 5120
  s_mov_b32 m0, 160000
  s_nop 0
  buffer_load_dwordx4 v6, s[40:43], s82 offen lds
  v_mul_f32 v88, v88, v88
  v_mul_f32 v89, v89, v89
  v_mul_f32 v90, v90, v90
  v_mul_f32 v91, v91, v91
  v_cvt_pk_bf16_f32 v84, v84, v85
  s_waitcnt lgkmcnt(4)
  v_mfma_f32_32x32x16_bf16 v[240:255], v[32:35], v[208:211], v[240:255]
  s_cmp_lg_u32 s71, 0
  s_cbranch_scc1 L_skip_251
  v_mfma_f32_4x4x4_16b_bf16 v[26:29], v[16:17], v[32:33], v[26:29]
  s_nop 1
  v_mfma_f32_4x4x4_16b_bf16 v[26:29], v[16:17], v[34:35], v[26:29]
L_skip_251:
  ds_read_b64_tr_b16 v[44:45], v15 offset:14336
  ds_read_b64_tr_b16 v[46:47], v15 offset:14848
  v_cvt_pk_bf16_f32 v85, v86, v87
  v_cvt_pk_bf16_f32 v86, v88, v89
  v_cvt_pk_bf16_f32 v87, v90, v91
  s_lshl_b32 s90, s13, 10
  s_add_u32 s90, s90, s15
  buffer_store_dwordx4 v[84:87], v10, s[48:51], s90 offen offset:0 sc1
  v_fma_f32 v92, v48, v30, v92
  s_waitcnt lgkmcnt(4)
  v_mfma_f32_32x32x16_bf16 v[240:255], v[36:39], v[212:215], v[240:255]
  s_cmp_lg_u32 s71, 1
  s_cbranch_scc1 L_skip_252
  v_mfma_f32_4x4x4_16b_bf16 v[26:29], v[16:17], v[36:37], v[26:29]
  s_nop 1
  v_mfma_f32_4x4x4_16b_bf16 v[26:29], v[16:17], v[38:39], v[26:29]
L_skip_252:
  ds_read_b64_tr_b16 v[32:33], v15 offset:16384
  ds_read_b64_tr_b16 v[34:35], v15 offset:16896
  v_fma_f32 v93, v49, v30, v93
  v_fma_f32 v94, v50, v30, v94
  v_fma_f32 v95, v51, v30, v95
  v_fma_f32 v96, v52, v30, v96
  v_fma_f32 v97, v53, v30, v97
  s_waitcnt lgkmcnt(4)
  v_mfma_f32_32x32x16_bf16 v[240:255], v[40:43], v[216:219], v[240:255]
  s_cmp_lg_u32 s71, 2
  s_cbranch_scc1 L_skip_253
  v_mfma_f32_4x4x4_16b_bf16 v[26:29], v[16:17], v[40:41], v[26:29]
  s_nop 1
  v_mfma_f32_4x4x4_16b_bf16 v[26:29], v[16:17], v[42:43], v[26:29]
L_skip_253:
  ds_read_b64_tr_b16 v[36:37], v15 offset:18432
  ds_read_b64_tr_b16 v[38:39], v15 offset:18944
  s_add_u32 s82, s80, 5248
  s_mov_b32 m0, 160000
  s_nop 0
  buffer_load_dwordx4 v6, s[40:43], s82 offen lds
  v_fma_f32 v98, v54, v30, v98
  v_fma_f32 v99, v55, v30, v99
  v_fma_f32 v92, v92, v31, v56
  v_fma_f32 v93, v93, v31, v57
  v_fma_f32 v94, v94, v31, v58
  v_fma_f32 v95, v95, v31, v59
  s_waitcnt lgkmcnt(4)
  v_mfma_f32_32x32x16_bf16 v[240:255], v[44:47], v[220:223], v[240:255]
  s_cmp_lg_u32 s71, 3
  s_cbranch_scc1 L_skip_254
  v_mfma_f32_4x4x4_16b_bf16 v[26:29], v[16:17], v[44:45], v[26:29]
  s_nop 1
  v_mfma_f32_4x4x4_16b_bf16 v[26:29], v[16:17], v[46:47], v[26:29]
L_skip_254:
  ds_read_b64_tr_b16 v[40:41], v15 offset:20480
  ds_read_b64_tr_b16 v[42:43], v15 offset:20992
  v_fma_f32 v96, v96, v31, v60
  v_fma_f32 v97, v97, v31, v61
  v_fma_f32 v98, v98, v31, v62
  v_fma_f32 v99, v99, v31, v63
  v_max_f32 v92, 0, v92
  s_waitcnt lgkmcnt(4)
  v_mfma_f32_32x32x16_bf16 v[240:255], v[32:35], v[224:227], v[240:255]
  s_cmp_lg_u32 s71, 0
  s_cbranch_scc1 L_skip_255
  v_mfma_f32_4x4x4_16b_bf16 v[26:29], v[16:17], v[32:33], v[26:29]
  s_nop 1
  v_mfma_f32_4x4x4_16b_bf16 v[26:29], v[16:17], v[34:35], v[26:29]
L_skip_255:
  ds_read_b64_tr_b16 v[44:45], v15 offset:22528
  ds_read_b64_tr_b16 v[46:47], v15 offset:23040
  v_max_f32 v93, 0, v93
  v_max_f32 v94, 0, v94
  v_max_f32 v95, 0, v95
  v_max_f32 v96, 0, v96
  v_max_f32 v97, 0, v97
  s_waitcnt lgkmcnt(4)
  v_mfma_f32_32x32x16_bf16 v[240:255], v[36:39], v[228:231], v[240:255]
  s_cmp_lg_u32 s71, 1
  s_cbranch_scc1 L_skip_256
  v_mfma_f32_4x4x4_16b_bf16 v[26:29], v[16:17], v[36:37], v[26:29]
  s_nop 1
  v_mfma_f32_4x4x4_16b_bf16 v[26:29], v[16:17], v[38:39], v[26:29]
L_skip_256:
  s_add_u32 s82, s81, 0
  s_mov_b32 m0, 160000
  s_nop 0
  buffer_load_dwordx4 v6, s[44:47], s82 offen lds
  v_max_f32 v98, 0, v98
  v_max_f32 v99, 0, v99
  v_mul_f32 v92, v92, v92
  v_mul_f32 v93, v93, v93
  v_mul_f32 v94, v94, v94
  v_mul_f32 v95, v95, v95
  s_waitcnt lgkmcnt(2)
  v_mfma_f32_32x32x16_bf16 v[240:255], v[40:43], v[232:235], v[240:255]
  s_cmp_lg_u32 s71, 2
  s_cbranch_scc1 L_skip_257
  v_mfma_f32_4x4x4_16b_bf16 v[26:29], v[16:17], v[40:41], v[26:29]
  s_nop 1
  v_mfma_f32_4x4x4_16b_bf16 v[26:29], v[16:17], v[42:43], v[26:29]
L_skip_257:
  v_mul_f32 v96, v96, v96
  v_mul_f32 v97, v97, v97
  v_mul_f32 v98, v98, v98
  v_mul_f32 v99, v99, v99
  v_cvt_pk_bf16_f32 v88, v92, v93
  s_waitcnt lgkmcnt(0)
  v_mfma_f32_32x32x16_bf16 v[240:255], v[44:47], v[236:239], v[240:255]
  s_cmp_lg_u32 s71, 3
  s_cbranch_scc1 L_skip_258
  v_mfma_f32_4x4x4_16b_bf16 v[26:29], v[16:17], v[44:45], v[26:29]
  s_nop 1
  v_mfma_f32_4x4x4_16b_bf16 v[26:29], v[16:17], v[46:47], v[26:29]
L_skip_258:
  v_cvt_pk_bf16_f32 v89, v94, v95
  v_cvt_pk_bf16_f32 v90, v96, v97
  v_cvt_pk_bf16_f32 v91, v98, v99
  s_lshl_b32 s90, s13, 10
  s_add_u32 s90, s90, s15
  buffer_store_dwordx4 v[88:91], v10, s[48:51], s90 offen offset:1024 sc1
  s_add_u32 s82, s81, 544
  s_mov_b32 m0, 160000
  s_nop 0
  buffer_load_dwordx4 v6, s[44:47], s82 offen lds
  s_lshl_b32 s90, s71, 2
  v_lshlrev_b32 v125, 4, v2
  v_add_u32 v125, s90, v125
  v_add_u32 v125, 152320, v125
  v_mov_b32 v124, v26
  s_nop 1
  v_permlane32_swap_b32 v26, v124
  v_add_f32 v26, v26, v124
  ds_write_b32 v125, v26 offset:3072
  s_waitcnt lgkmcnt(0)
  s_barrier
  v_lshlrev_b32 v125, 4, v2
  v_add_u32 v125, 152320, v125
  ds_read_b128 v[116:119], v125 offset:3072
  s_mul_i32 s90, s70, 384
  v_lshlrev_b32 v124, 2, v2
  v_add_u32 v124, s90, v124
  v_add_u32 v124, 155904, v124
  s_waitcnt lgkmcnt(0)
  v_add_f32 v116, v116, v117
  v_add_f32 v118, v118, v119
  v_add_f32 v116, v116, v118
  ds_write_b32 v124, v116 offset:0
  s_waitcnt lgkmcnt(0)
  ds_read_b128 v[32:35], v8 offset:0
  ds_read_b128 v[36:39], v8 offset:32
  ds_read_b128 v[40:43], v8 offset:64
  ds_read_b128 v[44:47], v8 offset:96
  v_lshrrev_b32 v124, 4, v1
  v_and_b32 v124, 1, v124
  v_and_b32 v125, 3, v1
  v_lshlrev_b32 v124, 2, v124
  v_add_u32 v124, v124, v125
  v_min_u32 v124, 6, v124
  v_lshlrev_b32 v124, 3, v124
  v_lshrrev_b32 v125, 2, v1
  v_and_b32 v125, 3, v125
  v_lshl_add_u32 v125, v3, 2, v125
  v_mul_u32_u24 v125, 56, v125
  v_add_u32 v124, v124, v125
  v_add_u32 v124, 149024, v124
  v_mov_b32 v125, 150208
  v_cndmask_b32 v123, v124, v125, s[4:5]
  ds_read_b64_tr_b16 v[56:57], v124
  ds_read_b64_tr_b16 v[58:59], v124 offset:448
  ds_read_b64_tr_b16 v[60:61], v124 offset:896
  ds_read_b64_tr_b16 v[62:63], v123 offset:1344
  s_waitcnt lgkmcnt(4)
  v_pk_fma_f32 v[240:241], v[32:33], v[30:31], v[240:241] op_sel:[0,0,0] op_sel_hi:[1,0,1]
  v_pk_fma_f32 v[242:243], v[34:35], v[30:31], v[242:243] op_sel:[0,0,0] op_sel_hi:[1,0,1]
  v_pk_fma_f32 v[244:245], v[36:37], v[30:31], v[244:245] op_sel:[0,0,0] op_sel_hi:[1,0,1]
  v_pk_fma_f32 v[246:247], v[38:39], v[30:31], v[246:247] op_sel:[0,0,0] op_sel_hi:[1,0,1]
  v_pk_fma_f32 v[248:249], v[40:41], v[30:31], v[248:249] op_sel:[0,0,0] op_sel_hi:[1,0,1]
  v_pk_fma_f32 v[250:251], v[42:43], v[30:31], v[250:251] op_sel:[0,0,0] op_sel_hi:[1,0,1]
  v_pk_fma_f32 v[252:253], v[44:45], v[30:31], v[252:253] op_sel:[0,0,0] op_sel_hi:[1,0,1]
  v_pk_fma_f32 v[254:255], v[46:47], v[30:31], v[254:255] op_sel:[0,0,0] op_sel_hi:[1,0,1]
  v_cvt_pk_bf16_f32 v48, v240, v241
  v_cvt_pk_bf16_f32 v49, v242, v243
  v_cvt_pk_bf16_f32 v50, v244, v245
  v_cvt_pk_bf16_f32 v51, v246, v247
  v_cvt_pk_bf16_f32 v52, v248, v249
  v_cvt_pk_bf16_f32 v53, v250, v251
  v_cvt_pk_bf16_f32 v54, v252, v253
  v_cvt_pk_bf16_f32 v55, v254, v255
  s_waitcnt lgkmcnt(0)
  v_mfma_f32_32x32x16_bf16 v[240:255], v[56:59], v[48:51], 0
  v_mfma_f32_32x32x16_bf16 v[240:255], v[60:63], v[52:55], v[240:255]
  v_mul_f32 v116, 0x3fb8aa3b, v31
  s_nop 10
  v_max3_f32 v22, v240, v241, v242
  v_min3_f32 v23, v240, v241, v242
  v_max3_f32 v22, v22, v243, v244
  v_min3_f32 v23, v23, v243, v244
  v_max3_f32 v22, v22, v245, v246
  v_min3_f32 v23, v23, v245, v246
  v_max3_f32 v22, v22, v247, v248
  v_min3_f32 v23, v23, v247, v248
  v_max3_f32 v22, v22, v249, v250
  v_min3_f32 v23, v23, v249, v250
  v_max3_f32 v22, v22, v251, v252
  v_min3_f32 v23, v23, v251, v252
  v_max3_f32 v22, v22, v253, v254
  v_min3_f32 v23, v23, v253, v254
  v_max_f32 v22, v22, v255
  v_min_f32 v23, v23, v255
  s_waitcnt vmcnt(1)
  v_mov_b32 v124, 151616
  v_mov_b32 v125, 1
  s_mov_b64 s[100:101], exec
  s_mov_b64 exec, 1
  ds_add_rtn_u32 v125, v124, v125
  s_mov_b64 exec, s[100:101]
  s_waitcnt lgkmcnt(0)
  v_readfirstlane_b32 s90, v125
  s_nop 0
  s_cmp_lg_u32 s90, 7
  s_cbranch_scc1 L_notlast_259
  s_cmp_lg_u32 s74, 0
  s_cbranch_scc1 L_tagok_260
  s_mov_b32 s95, 0
L_tagloop_261:
  v_mov_b32 v124, 0
  buffer_load_dword v125, v124, s[60:63], 0 offen sc1
  s_waitcnt vmcnt(0)
  v_readfirstlane_b32 s74, v125
  s_add_u32 s95, s95, 1
  s_cmp_lg_u32 s74, 0
  s_cbranch_scc1 L_tagok_260
  s_cmp_lt_u32 s95, 0x40000
  s_cbranch_scc1 L_tagloop_261
L_tagok_260:
  s_lshl_b32 s90, s68, 4
  s_add_u32 s90, s90, s69
  s_lshl_b32 s90, s90, 7
  s_add_u32 s90, s90, 86016
  v_mov_b32 v124, 0
  v_mov_b32 v125, s74
  s_mov_b64 s[100:101], exec
  s_mov_b64 exec, 1
  buffer_store_dword v125, v124, s[48:51], s90 offen sc1
  s_mov_b64 exec, s[100:101]
L_notlast_259:
  v_mov_b32 v24, v22
  s_nop 1
  v_permlane32_swap_b32 v22, v24
  v_max_f32 v22, v22, v24
  v_mov_b32 v24, v23
  s_nop 1
  v_permlane32_swap_b32 v23, v24
  v_min_f32 v23, v23, v24
  v_mul_f32 v118, -v22, v116
  v_mul_f32 v119, v23, v116
  v_pk_fma_f32 v[32:33], v[240:241], v[116:117], v[118:119] op_sel:[0,0,0] op_sel_hi:[1,0,0]
  v_pk_fma_f32 v[48:49], v[240:241], v[116:117], v[118:119] op_sel:[0,0,1] op_sel_hi:[1,0,1] neg_lo:[0,1,0] neg_hi:[0,1,0]
  v_pk_fma_f32 v[34:35], v[242:243], v[116:117], v[118:119] op_sel:[0,0,0] op_sel_hi:[1,0,0]
  v_pk_fma_f32 v[50:51], v[242:243], v[116:117], v[118:119] op_sel:[0,0,1] op_sel_hi:[1,0,1] neg_lo:[0,1,0] neg_hi:[0,1,0]
  v_pk_fma_f32 v[36:37], v[244:245], v[116:117], v[118:119] op_sel:[0,0,0] op_sel_hi:[1,0,0]
  v_pk_fma_f32 v[52:53], v[244:245], v[116:117], v[118:119] op_sel:[0,0,1] op_sel_hi:[1,0,1] neg_lo:[0,1,0] neg_hi:[0,1,0]
  v_pk_fma_f32 v[38:39], v[246:247], v[116:117], v[118:119] op_sel:[0,0,0] op_sel_hi:[1,0,0]
  v_pk_fma_f32 v[54:55], v[246:247], v[116:117], v[118:119] op_sel:[0,0,1] op_sel_hi:[1,0,1] neg_lo:[0,1,0] neg_hi:[0,1,0]
  v_pk_fma_f32 v[40:41], v[248:249], v[116:117], v[118:119] op_sel:[0,0,0] op_sel_hi:[1,0,0]
  v_pk_fma_f32 v[56:57], v[248:249], v[116:117], v[118:119] op_sel:[0,0,1] op_sel_hi:[1,0,1] neg_lo:[0,1,0] neg_hi:[0,1,0]
  v_pk_fma_f32 v[42:43], v[250:251], v[116:117], v[118:119] op_sel:[0,0,0] op_sel_hi:[1,0,0]
  v_pk_fma_f32 v[58:59], v[250:251], v[116:117], v[118:119] op_sel:[0,0,1] op_sel_hi:[1,0,1] neg_lo:[0,1,0] neg_hi:[0,1,0]
  v_pk_fma_f32 v[44:45], v[252:253], v[116:117], v[118:119] op_sel:[0,0,0] op_sel_hi:[1,0,0]
  v_pk_fma_f32 v[60:61], v[252:253], v[116:117], v[118:119] op_sel:[0,0,1] op_sel_hi:[1,0,1] neg_lo:[0,1,0] neg_hi:[0,1,0]
  v_pk_fma_f32 v[46:47], v[254:255], v[116:117], v[118:119] op_sel:[0,0,0] op_sel_hi:[1,0,0]
  v_pk_fma_f32 v[62:63], v[254:255], v[116:117], v[118:119] op_sel:[0,0,1] op_sel_hi:[1,0,1] neg_lo:[0,1,0] neg_hi:[0,1,0]
  v_exp_f32 v32, v32
  v_exp_f32 v48, v48
  v_exp_f32 v33, v33
  v_exp_f32 v49, v49
  v_exp_f32 v34, v34
  v_exp_f32 v50, v50
  v_exp_f32 v35, v35
  v_exp_f32 v51, v51
  v_exp_f32 v36, v36
  v_exp_f32 v52, v52
  v_exp_f32 v37, v37
  v_exp_f32 v53, v53
  v_exp_f32 v38, v38
  v_exp_f32 v54, v54
  v_exp_f32 v39, v39
  v_exp_f32 v55, v55
  v_exp_f32 v40, v40
  v_exp_f32 v56, v56
  v_exp_f32 v41, v41
  v_exp_f32 v57, v57
  v_exp_f32 v42, v42
  v_exp_f32 v58, v58
  v_exp_f32 v43, v43
  v_exp_f32 v59, v59
  v_exp_f32 v44, v44
  v_exp_f32 v60, v60
  v_exp_f32 v45, v45
  v_exp_f32 v61, v61
  v_exp_f32 v46, v46
  v_exp_f32 v62, v62
  v_exp_f32 v47, v47
  v_exp_f32 v63, v63
  v_cndmask_b32 v125, 1.0, 0, s[4:5]
  v_pk_add_f32 v[240:241], v[32:33], v[34:35]
  v_pk_add_f32 v[242:243], v[44:45], v[46:47]
  v_pk_add_f32 v[240:241], v[240:241], v[36:37]
  v_pk_add_f32 v[240:241], v[240:241], v[38:39]
  v_pk_add_f32 v[240:241], v[240:241], v[40:41]
  v_pk_add_f32 v[240:241], v[240:241], v[42:43]
  v_add_f32 v242, v242, v243
  v_add_f32 v120, v240, v241
  v_fmac_f32 v120, v242, v125
  v_pk_add_f32 v[244:245], v[48:49], v[50:51]
  v_pk_add_f32 v[246:247], v[60:61], v[62:63]
  v_pk_add_f32 v[244:245], v[244:245], v[52:53]
  v_pk_add_f32 v[244:245], v[244:245], v[54:55]
  v_pk_add_f32 v[244:245], v[244:245], v[56:57]
  v_pk_add_f32 v[244:245], v[244:245], v[58:59]
  v_add_f32 v246, v246, v247
  v_add_f32 v121, v244, v245
  v_fmac_f32 v121, v246, v125
  v_mov_b32 v24, v120
  s_nop 1
  v_permlane32_swap_b32 v120, v24
  v_add_f32 v120, v120, v24
  v_mov_b32 v24, v121
  s_nop 1
  v_permlane32_swap_b32 v121, v24
  v_add_f32 v121, v121, v24
  v_rcp_f32 v120, v120
  v_rcp_f32 v121, v121
  s_nop 0
  v_pk_mul_f32 v[32:33], v[32:33], v[120:121] op_sel:[0,0] op_sel_hi:[1,0]
  v_pk_mul_f32 v[48:49], v[48:49], v[120:121] op_sel:[0,1] op_sel_hi:[1,1]
  v_pk_mul_f32 v[34:35], v[34:35], v[120:121] op_sel:[0,0] op_sel_hi:[1,0]
  v_pk_mul_f32 v[50:51], v[50:51], v[120:121] op_sel:[0,1] op_sel_hi:[1,1]
  v_pk_mul_f32 v[36:37], v[36:37], v[120:121] op_sel:[0,0] op_sel_hi:[1,0]
  v_pk_mul_f32 v[52:53], v[52:53], v[120:121] op_sel:[0,1] op_sel_hi:[1,1]
  v_pk_mul_f32 v[38:39], v[38:39], v[120:121] op_sel:[0,0] op_sel_hi:[1,0]
  v_pk_mul_f32 v[54:55], v[54:55], v[120:121] op_sel:[0,1] op_sel_hi:[1,1]
  v_pk_mul_f32 v[40:41], v[40:41], v[120:121] op_sel:[0,0] op_sel_hi:[1,0]
  v_pk_mul_f32 v[56:57], v[56:57], v[120:121] op_sel:[0,1] op_sel_hi:[1,1]
  v_pk_mul_f32 v[42:43], v[42:43], v[120:121] op_sel:[0,0] op_sel_hi:[1,0]
  v_pk_mul_f32 v[58:59], v[58:59], v[120:121] op_sel:[0,1] op_sel_hi:[1,1]
  v_pk_mul_f32 v[44:45], v[44:45], v[120:121] op_sel:[0,0] op_sel_hi:[1,0]
  v_pk_mul_f32 v[60:61], v[60:61], v[120:121] op_sel:[0,1] op_sel_hi:[1,1]
  v_pk_mul_f32 v[46:47], v[46:47], v[120:121] op_sel:[0,0] op_sel_hi:[1,0]
  v_pk_mul_f32 v[62:63], v[62:63], v[120:121] op_sel:[0,1] op_sel_hi:[1,1]
  v_cvt_pk_bf16_f32 v240, v32, v33
  v_cvt_pk_bf16_f32 v248, v48, v49
  v_cvt_pk_bf16_f32 v241, v34, v35
  v_cvt_pk_bf16_f32 v249, v50, v51
  v_cvt_pk_bf16_f32 v242, v36, v37
  v_cvt_pk_bf16_f32 v250, v52, v53
  v_cvt_pk_bf16_f32 v243, v38, v39
  v_cvt_pk_bf16_f32 v251, v54, v55
  v_cvt_pk_bf16_f32 v244, v40, v41
  v_cvt_pk_bf16_f32 v252, v56, v57
  v_cvt_pk_bf16_f32 v245, v42, v43
  v_cvt_pk_bf16_f32 v253, v58, v59
  v_cvt_pk_bf16_f32 v246, v44, v45
  v_cvt_pk_bf16_f32 v254, v60, v61
  v_cvt_pk_bf16_f32 v247, v46, v47
  v_cvt_pk_bf16_f32 v255, v62, v63
  s_waitcnt lgkmcnt(0)
  s_barrier
  s_branch L_S2_TQ
L_S2_FK:
L_S2_FQ:
  s_cmp_lg_u32 s74, 0
  s_cbranch_scc1 L_tagok_262
  s_mov_b32 s95, 0
L_tagloop_263:
  v_mov_b32 v9, 0
  buffer_load_dword v10, v9, s[60:63], 0 offen sc1
  s_waitcnt vmcnt(0)
  v_readfirstlane_b32 s74, v10
  s_add_u32 s95, s95, 1
  s_cmp_lg_u32 s74, 0
  s_cbranch_scc1 L_tagok_262
  s_cmp_lt_u32 s95, 0x40000
  s_cbranch_scc1 L_tagloop_263
L_tagok_262:
  s_cmp_ge_u32 s2, 224
  s_cbranch_scc0 L_S2_FMAIN
  s_branch L_RED
L_S2_FMAIN:
  s_lshr_b32 s90, s2, 3
  s_mul_i32 s91, s90, 37
  s_lshr_b32 s91, s91, 8
  s_mul_i32 s92, s91, 7
  s_sub_u32 s92, s90, s92
  s_and_b32 s93, s2, 7
  s_lshl_b32 s93, s93, 2
  s_add_u32 s93, s93, s91
  s_and_b32 s91, s93, 1
  s_mov_b32 s12, s91
  s_mov_b32 s13, s92
  s_mov_b32 s14, s93
  s_lshr_b32 s19, s93, 1
  v_lshlrev_b32 v11, 7, v1
  s_lshl_b32 s83, s19, 11
  s_add_u32 s83, s83, 86016
  s_add_u32 s91, s83, 1024
  s_mov_b64 s[100:101], exec
  s_mov_b64 exec, 0xff
  buffer_load_dword v12, v11, s[48:51], s91 offen sc1
  s_mov_b64 exec, s[100:101]
  s_and_b32 s91, s14, 3
  s_mul_i32 s90, s13, 3
  s_mul_i32 s92, s91, 5
  s_add_u32 s94, s90, s92
  s_cmp_ge_u32 s94, 20
  s_cselect_b32 s90, 20, 0
  s_sub_u32 s94, s94, s90
  s_lshl_b32 s91, s91, 1
  s_add_u32 s93, s91, s13
  s_and_b32 s93, s93, 7
  v_and_b32 v9, 7, v1
  v_lshrrev_b32 v10, 2, v1
  v_and_b32 v10, 4, v10
  v_xor_b32 v9, v9, v10
  v_lshlrev_b32 v9, 4, v9
  v_lshrrev_b32 v10, 3, v1
  s_movk_i32 s90, 896
  v_mad_u32_u24 v4, v10, s90, v9
  s_lshl_b32 s92, s13, 7
  s_mul_i32 s90, s71, 286720
  s_add_u32 s81, s90, s92
  s_add_u32 s81, s81, 458752
  s_add_u32 s82, s81, 286720
  s_mul_i32 s90, s94, 14336
  s_add_u32 s80, s81, s90
  s_mul_i32 s90, s71, 114688
  s_add_u32 s84, s90, s92
  s_mul_i32 s15, s71, 20480
  s_mul_i32 s90, s14, 229376
  s_add_u32 s90, s90, 4587520
  s_mul_i32 s91, s71, 20480
  s_add_u32 s77, s90, s91
  s_add_u32 s77, s77, 32768
  s_add_u32 s78, s77, 20480
  s_lshl_b32 s91, s94, 10
  s_add_u32 s76, s77, s91
  s_lshl_b32 s91, s71, 13
  s_add_u32 s85, s90, s91
  s_mov_b32 s86, s93
  v_lshrrev_b32 v9, 4, v1
  v_and_b32 v9, 1, v9
  v_lshlrev_b32 v9, 5, v9
  v_and_b32 v10, 3, v1
  v_lshl_add_u32 v9, v10, 3, v9
  v_lshlrev_b32 v10, 3, v1
  v_and_b32 v10, 64, v10
  v_xor_b32 v9, v9, v10
  v_lshrrev_b32 v10, 2, v1
  v_and_b32 v10, 3, v10
  v_mad_u32_u24 v6, v3, 4, v10
  v_lshl_add_u32 v6, v6, 7, v9
  v_lshrrev_b32 v9, 4, v1
  v_and_b32 v9, 1, v9
  v_lshlrev_b32 v9, 5, v9
  v_and_b32 v10, 3, v1
  v_lshl_add_u32 v9, v10, 3, v9
  v_add_u32 v9, 64, v9
  v_lshlrev_b32 v10, 3, v1
  v_and_b32 v10, 64, v10
  v_xor_b32 v9, v9, v10
  v_lshrrev_b32 v10, 2, v1
  v_and_b32 v10, 3, v10
  v_mad_u32_u24 v7, v3, 4, v10
  v_lshl_add_u32 v7, v7, 7, v9
  v_add_u32 v6, s15, v6
  v_add_u32 v7, s15, v7
  v_lshlrev_b32 v5, 4, v1
  s_add_u32 s90, s80, 0
  s_add_u32 m0, s15, 0
  s_nop 0
  buffer_load_dwordx4 v4, s[40:43], s90 offen lds
  s_add_u32 s90, s80, 7168
  s_add_u32 m0, s15, 1024
  s_nop 0
  buffer_load_dwordx4 v4, s[40:43], s90 offen lds
  s_add_u32 s80, s80, 14336
  s_cmp_eq_u32 s80, s82
  s_cselect_b32 s80, s81, s80
  s_add_u32 s90, s80, 0
  s_add_u32 m0, s15, 2048
  s_nop 0
  buffer_load_dwordx4 v4, s[40:43], s90 offen lds
  s_add_u32 s90, s80, 7168
  s_add_u32 m0, s15, 3072
  s_nop 0
  buffer_load_dwordx4 v4, s[40:43], s90 offen lds
  s_add_u32 s80, s80, 14336
  s_cmp_eq_u32 s80, s82
  s_cselect_b32 s80, s81, s80
  s_add_u32 s90, s80, 0
  s_add_u32 m0, s15, 4096
  s_nop 0
  buffer_load_dwordx4 v4, s[40:43], s90 offen lds
  s_add_u32 s90, s80, 7168
  s_add_u32 m0, s15, 5120
  s_nop 0
  buffer_load_dwordx4 v4, s[40:43], s90 offen lds
  s_add_u32 s80, s80, 14336
  s_cmp_eq_u32 s80, s82
  s_cselect_b32 s80, s81, s80
  s_waitcnt vmcnt(6)
  s_add_u32 s91, s83, 1024
  v_cmp_ne_u32 vcc, s74, v12
  s_nop 0
  s_and_b32 s90, vcc_lo, 255
  s_cmp_eq_u32 s90, 0
  s_cbranch_scc1 L_fok_264
  s_mov_b64 s[100:101], exec
  s_mov_b64 exec, 255
  s_mov_b32 s95, 0
L_poll_265:
  buffer_load_dword v10, v11, s[48:51], s91 offen sc1
  s_waitcnt vmcnt(0)
  v_cmp_ne_u32 vcc, s74, v10
  s_add_u32 s95, s95, 1
  s_cmp_eq_u64 vcc, 0
  s_cbranch_scc1 L_polldone_266
  s_sleep 2
  s_cmp_lt_u32 s95, 0x20000
  s_cbranch_scc1 L_poll_265
L_polldone_266:
  s_mov_b64 exec, s[100:101]
L_fok_264:
  buffer_load_dwordx4 v[128:131], v5, s[48:51], s76 offen sc1
  s_add_u32 s90, s76, 114688
  buffer_load_dwordx4 v[132:135], v5, s[48:51], s90 offen sc1
  s_add_u32 s76, s76, 1024
  s_cmp_eq_u32 s76, s78
  s_cselect_b32 s76, s77, s76
  s_add_u32 s90, s80, 0
  s_add_u32 m0, s15, 6144
  s_nop 0
  buffer_load_dwordx4 v4, s[40:43], s90 offen lds
  s_add_u32 s90, s80, 7168
  s_add_u32 m0, s15, 7168
  s_nop 0
  buffer_load_dwordx4 v4, s[40:43], s90 offen lds
  s_add_u32 s80, s80, 14336
  s_cmp_eq_u32 s80, s82
  s_cselect_b32 s80, s81, s80
  buffer_load_dwordx4 v[136:139], v5, s[48:51], s76 offen sc1
  s_add_u32 s90, s76, 114688
  buffer_load_dwordx4 v[140:143], v5, s[48:51], s90 offen sc1
  s_add_u32 s76, s76, 1024
  s_cmp_eq_u32 s76, s78
  s_cselect_b32 s76, s77, s76
  s_add_u32 s90, s80, 0
  s_add_u32 m0, s15, 8192
  s_nop 0
  buffer_load_dwordx4 v4, s[40:43], s90 offen lds
  s_add_u32 s90, s80, 7168
  s_add_u32 m0, s15, 9216
  s_nop 0
  buffer_load_dwordx4 v4, s[40:43], s90 offen lds
  s_add_u32 s80, s80, 14336
  s_cmp_eq_u32 s80, s82
  s_cselect_b32 s80, s81, s80
  buffer_load_dwordx4 v[144:147], v5, s[48:51], s76 offen sc1
  s_add_u32 s90, s76, 114688
  buffer_load_dwordx4 v[148:151], v5, s[48:51], s90 offen sc1
  s_add_u32 s76, s76, 1024
  s_cmp_eq_u32 s76, s78
  s_cselect_b32 s76, s77, s76
  s_add_u32 s90, s80, 0
  s_add_u32 m0, s15, 10240
  s_nop 0
  buffer_load_dwordx4 v4, s[40:43], s90 offen lds
  s_add_u32 s90, s80, 7168
  s_add_u32 m0, s15, 11264
  s_nop 0
  buffer_load_dwordx4 v4, s[40:43], s90 offen lds
  s_add_u32 s80, s80, 14336
  s_cmp_eq_u32 s80, s82
  s_cselect_b32 s80, s81, s80
  buffer_load_dwordx4 v[152:155], v5, s[48:51], s76 offen sc1
  s_add_u32 s90, s76, 114688
  buffer_load_dwordx4 v[156:159], v5, s[48:51], s90 offen sc1
  s_add_u32 s76, s76, 1024
  s_cmp_eq_u32 s76, s78
  s_cselect_b32 s76, s77, s76
  s_add_u32 s90, s80, 0
  s_add_u32 m0, s15, 12288
  s_nop 0
  buffer_load_dwordx4 v4, s[40:43], s90 offen lds
  s_add_u32 s90, s80, 7168
  s_add_u32 m0, s15, 13312
  s_nop 0
  buffer_load_dwordx4 v4, s[40:43], s90 offen lds
  s_add_u32 s80, s80, 14336
  s_cmp_eq_u32 s80, s82
  s_cselect_b32 s80, s81, s80
  s_waitcnt vmcnt(18)
  ds_read_b64_tr_b16 v[32:33], v6 offset:0
  ds_read_b64_tr_b16 v[34:35], v6 offset:1024
  ds_read_b64_tr_b16 v[36:37], v7 offset:0
  ds_read_b64_tr_b16 v[38:39], v7 offset:1024
  ds_read_b64_tr_b16 v[40:41], v6 offset:2048
  ds_read_b64_tr_b16 v[42:43], v6 offset:3072
  ds_read_b64_tr_b16 v[44:45], v7 offset:2048
  ds_read_b64_tr_b16 v[46:47], v7 offset:3072
  s_waitcnt vmcnt(14)
  ds_read_b64_tr_b16 v[48:49], v6 offset:4096
  ds_read_b64_tr_b16 v[50:51], v6 offset:5120
  ds_read_b64_tr_b16 v[52:53], v7 offset:4096
  ds_read_b64_tr_b16 v[54:55], v7 offset:5120
  s_waitcnt lgkmcnt(8)
  v_mfma_f32_32x32x16_bf16 v[64:79], v[32:35], v[128:131], 0
  s_add_u32 s90, s80, 0
  s_add_u32 m0, s15, 14336
  s_nop 0
  buffer_load_dwordx4 v4, s[40:43], s90 offen lds
  v_mfma_f32_32x32x16_bf16 v[96:111], v[36:39], v[128:131], 0
  s_add_u32 s90, s80, 7168
  s_add_u32 m0, s15, 15360
  s_nop 0
  buffer_load_dwordx4 v4, s[40:43], s90 offen lds
  s_add_u32 s80, s80, 14336
  s_cmp_eq_u32 s80, s82
  s_cselect_b32 s80, s81, s80
  v_mfma_f32_32x32x16_bf16 v[80:95], v[32:35], v[132:135], 0
  s_add_u32 s90, s80, 0
  s_add_u32 m0, s15, 16384
  s_nop 0
  buffer_load_dwordx4 v4, s[40:43], s90 offen lds
  v_mfma_f32_32x32x16_bf16 v[112:127], v[36:39], v[132:135], 0
  s_add_u32 s90, s80, 7168
  s_add_u32 m0, s15, 17408
  s_nop 0
  buffer_load_dwordx4 v4, s[40:43], s90 offen lds
  s_add_u32 s80, s80, 14336
  s_cmp_eq_u32 s80, s82
  s_cselect_b32 s80, s81, s80
  buffer_load_dwordx4 v[160:163], v5, s[48:51], s76 offen sc1
  s_add_u32 s90, s76, 114688
  buffer_load_dwordx4 v[164:167], v5, s[48:51], s90 offen sc1
  s_add_u32 s76, s76, 1024
  s_cmp_eq_u32 s76, s78
  s_cselect_b32 s76, s77, s76
  buffer_load_dwordx4 v[168:171], v5, s[48:51], s76 offen sc1
  s_add_u32 s90, s76, 114688
  buffer_load_dwordx4 v[172:175], v5, s[48:51], s90 offen sc1
  s_add_u32 s76, s76, 1024
  s_cmp_eq_u32 s76, s78
  s_cselect_b32 s76, s77, s76
  s_waitcnt vmcnt(18)
  ds_read_b64_tr_b16 v[32:33], v6 offset:6144
  ds_read_b64_tr_b16 v[34:35], v6 offset:7168
  ds_read_b64_tr_b16 v[36:37], v7 offset:6144
  ds_read_b64_tr_b16 v[38:39], v7 offset:7168
  s_waitcnt lgkmcnt(8)
  v_mfma_f32_32x32x16_bf16 v[64:79], v[40:43], v[136:139], v[64:79]
  s_add_u32 s90, s80, 0
  s_add_u32 m0, s15, 18432
  s_nop 0
  buffer_load_dwordx4 v4, s[40:43], s90 offen lds
  v_mfma_f32_32x32x16_bf16 v[96:111], v[44:47], v[136:139], v[96:111]
  s_add_u32 s90, s80, 7168
  s_add_u32 m0, s15, 19456
  s_nop 0
  buffer_load_dwordx4 v4, s[40:43], s90 offen lds
  s_add_u32 s80, s80, 14336
  s_cmp_eq_u32 s80, s82
  s_cselect_b32 s80, s81, s80
  v_mfma_f32_32x32x16_bf16 v[80:95], v[40:43], v[140:143], v[80:95]
  buffer_load_dwordx4 v[176:179], v5, s[48:51], s76 offen sc1
  v_mfma_f32_32x32x16_bf16 v[112:127], v[44:47], v[140:143], v[112:127]
  s_add_u32 s90, s76, 114688
  buffer_load_dwordx4 v[180:183], v5, s[48:51], s90 offen sc1
  s_add_u32 s76, s76, 1024
  s_cmp_eq_u32 s76, s78
  s_cselect_b32 s76, s77, s76
  buffer_load_dwordx4 v[184:187], v5, s[48:51], s76 offen sc1
  s_add_u32 s90, s76, 114688
  buffer_load_dwordx4 v[188:191], v5, s[48:51], s90 offen sc1
  s_add_u32 s76, s76, 1024
  s_cmp_eq_u32 s76, s78
  s_cselect_b32 s76, s77, s76
  s_waitcnt vmcnt(20)
  ds_read_b64_tr_b16 v[40:41], v6 offset:8192
  ds_read_b64_tr_b16 v[42:43], v6 offset:9216
  ds_read_b64_tr_b16 v[44:45], v7 offset:8192
  ds_read_b64_tr_b16 v[46:47], v7 offset:9216
  s_waitcnt lgkmcnt(8)
  v_mfma_f32_32x32x16_bf16 v[64:79], v[48:51], v[144:147], v[64:79]
  s_add_u32 s90, s80, 0
  s_add_u32 m0, s15, 0
  s_nop 0
  buffer_load_dwordx4 v4, s[40:43], s90 offen lds
  v_mfma_f32_32x32x16_bf16 v[96:111], v[52:55], v[144:147], v[96:111]
  s_add_u32 s90, s80, 7168
  s_add_u32 m0, s15, 1024
  s_nop 0
  buffer_load_dwordx4 v4, s[40:43], s90 offen lds
  s_add_u32 s80, s80, 14336
  s_cmp_eq_u32 s80, s82
  s_cselect_b32 s80, s81, s80
  v_mfma_f32_32x32x16_bf16 v[80:95], v[48:51], v[148:151], v[80:95]
  buffer_load_dwordx4 v[192:195], v5, s[48:51], s76 offen sc1
  v_mfma_f32_32x32x16_bf16 v[112:127], v[52:55], v[148:151], v[112:127]
  s_add_u32 s90, s76, 114688
  buffer_load_dwordx4 v[196:199], v5, s[48:51], s90 offen sc1
  s_add_u32 s76, s76, 1024
  s_cmp_eq_u32 s76, s78
  s_cselect_b32 s76, s77, s76
  buffer_load_dwordx4 v[200:203], v5, s[48:51], s76 offen sc1
  s_add_u32 s90, s76, 114688
  buffer_load_dwordx4 v[204:207], v5, s[48:51], s90 offen sc1
  s_add_u32 s76, s76, 1024
  s_cmp_eq_u32 s76, s78
  s_cselect_b32 s76, s77, s76
  s_waitcnt vmcnt(22)
  ds_read_b64_tr_b16 v[48:49], v6 offset:10240
  ds_read_b64_tr_b16 v[50:51], v6 offset:11264
  ds_read_b64_tr_b16 v[52:53], v7 offset:10240
  ds_read_b64_tr_b16 v[54:55], v7 offset:11264
  s_waitcnt lgkmcnt(8)
  v_mfma_f32_32x32x16_bf16 v[64:79], v[32:35], v[152:155], v[64:79]
  s_add_u32 s90, s80, 0
  s_add_u32 m0, s15, 2048
  s_nop 0
  buffer_load_dwordx4 v4, s[40:43], s90 offen lds
  v_mfma_f32_32x32x16_bf16 v[96:111], v[36:39], v[152:155], v[96:111]
  s_add_u32 s90, s80, 7168
  s_add_u32 m0, s15, 3072
  s_nop 0
  buffer_load_dwordx4 v4, s[40:43], s90 offen lds
  s_add_u32 s80, s80, 14336
  s_cmp_eq_u32 s80, s82
  s_cselect_b32 s80, s81, s80
  v_mfma_f32_32x32x16_bf16 v[80:95], v[32:35], v[156:159], v[80:95]
  buffer_load_dwordx4 v[208:211], v5, s[48:51], s76 offen sc1
  v_mfma_f32_32x32x16_bf16 v[112:127], v[36:39], v[156:159], v[112:127]
  s_add_u32 s90, s76, 114688
  buffer_load_dwordx4 v[212:215], v5, s[48:51], s90 offen sc1
  s_add_u32 s76, s76, 1024
  s_cmp_eq_u32 s76, s78
  s_cselect_b32 s76, s77, s76
  buffer_load_dwordx4 v[128:131], v5, s[48:51], s76 offen sc1
  s_add_u32 s90, s76, 114688
  buffer_load_dwordx4 v[132:135], v5, s[48:51], s90 offen sc1
  s_add_u32 s76, s76, 1024
  s_cmp_eq_u32 s76, s78
  s_cselect_b32 s76, s77, s76
  s_waitcnt vmcnt(20)
  ds_read_b64_tr_b16 v[32:33], v6 offset:12288
  ds_read_b64_tr_b16 v[34:35], v6 offset:13312
  ds_read_b64_tr_b16 v[36:37], v7 offset:12288
  ds_read_b64_tr_b16 v[38:39], v7 offset:13312
  s_waitcnt lgkmcnt(8)
  v_mfma_f32_32x32x16_bf16 v[64:79], v[40:43], v[160:163], v[64:79]
  s_add_u32 s90, s80, 0
  s_add_u32 m0, s15, 4096
  s_nop 0
  buffer_load_dwordx4 v4, s[40:43], s90 offen lds
  v_mfma_f32_32x32x16_bf16 v[96:111], v[44:47], v[160:163], v[96:111]
  s_add_u32 s90, s80, 7168
  s_add_u32 m0, s15, 5120
  s_nop 0
  buffer_load_dwordx4 v4, s[40:43], s90 offen lds
  s_add_u32 s80, s80, 14336
  s_cmp_eq_u32 s80, s82
  s_cselect_b32 s80, s81, s80
  v_mfma_f32_32x32x16_bf16 v[80:95], v[40:43], v[164:167], v[80:95]
  buffer_load_dwordx4 v[136:139], v5, s[48:51], s76 offen sc1
  v_mfma_f32_32x32x16_bf16 v[112:127], v[44:47], v[164:167], v[112:127]
  s_add_u32 s90, s76, 114688
  buffer_load_dwordx4 v[140:143], v5, s[48:51], s90 offen sc1
  s_add_u32 s76, s76, 1024
  s_cmp_eq_u32 s76, s78
  s_cselect_b32 s76, s77, s76
  s_waitcnt vmcnt(22)
  ds_read_b64_tr_b16 v[40:41], v6 offset:14336
  ds_read_b64_tr_b16 v[42:43], v6 offset:15360
  ds_read_b64_tr_b16 v[44:45], v7 offset:14336
  ds_read_b64_tr_b16 v[46:47], v7 offset:15360
  s_waitcnt lgkmcnt(8)
  v_mfma_f32_32x32x16_bf16 v[64:79], v[48:51], v[168:171], v[64:79]
  s_add_u32 s90, s80, 0
  s_add_u32 m0, s15, 6144
  s_nop 0
  buffer_load_dwordx4 v4, s[40:43], s90 offen lds
  v_mfma_f32_32x32x16_bf16 v[96:111], v[52:55], v[168:171], v[96:111]
  s_add_u32 s90, s80, 7168
  s_add_u32 m0, s15, 7168
  s_nop 0
  buffer_load_dwordx4 v4, s[40:43], s90 offen lds
  s_add_u32 s80, s80, 14336
  s_cmp_eq_u32 s80, s82
  s_cselect_b32 s80, s81, s80
  v_mfma_f32_32x32x16_bf16 v[80:95], v[48:51], v[172:175], v[80:95]
  buffer_load_dwordx4 v[144:147], v5, s[48:51], s76 offen sc1
  v_mfma_f32_32x32x16_bf16 v[112:127], v[52:55], v[172:175], v[112:127]
  s_add_u32 s90, s76, 114688
  buffer_load_dwordx4 v[148:151], v5, s[48:51], s90 offen sc1
  s_add_u32 s76, s76, 1024
  s_cmp_eq_u32 s76, s78
  s_cselect_b32 s76, s77, s76
  s_waitcnt vmcnt(22)
  ds_read_b64_tr_b16 v[48:49], v6 offset:16384
  ds_read_b64_tr_b16 v[50:51], v6 offset:17408
  ds_read_b64_tr_b16 v[52:53], v7 offset:16384
  ds_read_b64_tr_b16 v[54:55], v7 offset:17408
  s_waitcnt lgkmcnt(8)
  v_mfma_f32_32x32x16_bf16 v[64:79], v[32:35], v[176:179], v[64:79]
  s_add_u32 s90, s80, 0
  s_add_u32 m0, s15, 8192
  s_nop 0
  buffer_load_dwordx4 v4, s[40:43], s90 offen lds
  v_mfma_f32_32x32x16_bf16 v[96:111], v[36:39], v[176:179], v[96:111]
  s_add_u32 s90, s80, 7168
  s_add_u32 m0, s15, 9216
  s_nop 0
  buffer_load_dwordx4 v4, s[40:43], s90 offen lds
  s_add_u32 s80, s80, 14336
  s_cmp_eq_u32 s80, s82
  s_cselect_b32 s80, s81, s80
  v_mfma_f32_32x32x16_bf16 v[80:95], v[32:35], v[180:183], v[80:95]
  buffer_load_dwordx4 v[152:155], v5, s[48:51], s76 offen sc1
  v_mfma_f32_32x32x16_bf16 v[112:127], v[36:39], v[180:183], v[112:127]
  s_add_u32 s90, s76, 114688
  buffer_load_dwordx4 v[156:159], v5, s[48:51], s90 offen sc1
  s_add_u32 s76, s76, 1024
  s_cmp_eq_u32 s76, s78
  s_cselect_b32 s76, s77, s76
  s_lshl_b32 s90, s14, 6
  s_lshl_b32 s91, s70, 3
  s_add_u32 s90, s90, s91
  s_mul_i32 s90, s90, 896
  s_lshl_b32 s91, s13, 7
  s_add_u32 s18, s90, s91
  v_lshrrev_b32 v9, 3, v1
  s_movk_i32 s90, 896
  v_mul_u32_u24 v9, s90, v9
  v_and_b32 v10, 7, v1
  v_lshlrev_b32 v10, 4, v10
  v_add_u32 v8, v9, v10
  buffer_load_dwordx4 v[248:251], v8, s[28:31], s18 offen
  s_mov_b32 s56, s20
  s_and_b32 s57, s21, 0xffff
  s_mov_b32 s58, 896
  s_mov_b32 s59, 0x20000
  s_lshl_b32 s91, s13, 7
  buffer_load_dwordx4 v[252:255], v10, s[56:59], s91 offen
  s_waitcnt vmcnt(26)
  ds_read_b64_tr_b16 v[32:33], v6 offset:18432
  ds_read_b64_tr_b16 v[34:35], v6 offset:19456
  ds_read_b64_tr_b16 v[36:37], v7 offset:18432
  ds_read_b64_tr_b16 v[38:39], v7 offset:19456
  s_waitcnt lgkmcnt(8)
  v_mfma_f32_32x32x16_bf16 v[64:79], v[40:43], v[184:187], v[64:79]
  s_add_u32 s90, s80, 0
  s_add_u32 m0, s15, 10240
  s_nop 0
  buffer_load_dwordx4 v4, s[40:43], s90 offen lds
  v_mfma_f32_32x32x16_bf16 v[96:111], v[44:47], v[184:187], v[96:111]
  s_add_u32 s90, s80, 7168
  s_add_u32 m0, s15, 11264
  s_nop 0
  buffer_load_dwordx4 v4, s[40:43], s90 offen lds
  s_add_u32 s80, s80, 14336
  s_cmp_eq_u32 s80, s82
  s_cselect_b32 s80, s81, s80
  v_mfma_f32_32x32x16_bf16 v[80:95], v[40:43], v[188:191], v[80:95]
  buffer_load_dwordx4 v[160:163], v5, s[48:51], s76 offen sc1
  v_mfma_f32_32x32x16_bf16 v[112:127], v[44:47], v[188:191], v[112:127]
  s_add_u32 s90, s76, 114688
  buffer_load_dwordx4 v[164:167], v5, s[48:51], s90 offen sc1
  s_add_u32 s76, s76, 1024
  s_cmp_eq_u32 s76, s78
  s_cselect_b32 s76, s77, s76
  s_waitcnt vmcnt(26)
  ds_read_b64_tr_b16 v[40:41], v6 offset:0
  ds_read_b64_tr_b16 v[42:43], v6 offset:1024
  ds_read_b64_tr_b16 v[44:45], v7 offset:0
  ds_read_b64_tr_b16 v[46:47], v7 offset:1024
  s_waitcnt lgkmcnt(8)
  v_mfma_f32_32x32x16_bf16 v[64:79], v[48:51], v[192:195], v[64:79]
  s_add_u32 s90, s80, 0
  s_add_u32 m0, s15, 12288
  s_nop 0
  buffer_load_dwordx4 v4, s[40:43], s90 offen lds
  v_mfma_f32_32x32x16_bf16 v[96:111], v[52:55], v[192:195], v[96:111]
  s_add_u32 s90, s80, 7168
  s_add_u32 m0, s15, 13312
  s_nop 0
  buffer_load_dwordx4 v4, s[40:43], s90 offen lds
  s_add_u32 s80, s80, 14336
  s_cmp_eq_u32 s80, s82
  s_cselect_b32 s80, s81, s80
  v_mfma_f32_32x32x16_bf16 v[80:95], v[48:51], v[196:199], v[80:95]
  s_mov_b64 s[100:101], exec
  s_mov_b64 exec, 0xff
  buffer_load_dword v13, v11, s[48:51], s83 offen sc1
  s_mov_b64 exec, s[100:101]
  v_mfma_f32_32x32x16_bf16 v[112:127], v[52:55], v[196:199], v[112:127]
  buffer_load_dwordx4 v[168:171], v5, s[48:51], s76 offen sc1
  s_add_u32 s90, s76, 114688
  buffer_load_dwordx4 v[172:175], v5, s[48:51], s90 offen sc1
  s_add_u32 s76, s76, 1024
  s_cmp_eq_u32 s76, s78
  s_cselect_b32 s76, s77, s76
  s_waitcnt vmcnt(27)
  ds_read_b64_tr_b16 v[48:49], v6 offset:2048
  ds_read_b64_tr_b16 v[50:51], v6 offset:3072
  ds_read_b64_tr_b16 v[52:53], v7 offset:2048
  ds_read_b64_tr_b16 v[54:55], v7 offset:3072
  s_waitcnt lgkmcnt(8)
  v_mfma_f32_32x32x16_bf16 v[64:79], v[32:35], v[200:203], v[64:79]
  s_add_u32 s90, s80, 0
  s_add_u32 m0, s15, 14336
  s_nop 0
  buffer_load_dwordx4 v4, s[40:43], s90 offen lds
  v_mfma_f32_32x32x16_bf16 v[96:111], v[36:39], v[200:203], v[96:111]
  s_add_u32 s90, s80, 7168
  s_add_u32 m0, s15, 15360
  s_nop 0
  buffer_load_dwordx4 v4, s[40:43], s90 offen lds
  s_add_u32 s80, s80, 14336
  s_cmp_eq_u32 s80, s82
  s_cselect_b32 s80, s81, s80
  v_mfma_f32_32x32x16_bf16 v[80:95], v[32:35], v[204:207], v[80:95]
  buffer_load_dwordx4 v[176:179], v5, s[48:51], s76 offen sc1
  v_mfma_f32_32x32x16_bf16 v[112:127], v[36:39], v[204:207], v[112:127]
  s_add_u32 s90, s76, 114688
  buffer_load_dwordx4 v[180:183], v5, s[48:51], s90 offen sc1
  s_add_u32 s76, s76, 1024
  s_cmp_eq_u32 s76, s78
  s_cselect_b32 s76, s77, s76
  s_waitcnt vmcnt(25)
  ds_read_b64_tr_b16 v[32:33], v6 offset:4096
  ds_read_b64_tr_b16 v[34:35], v6 offset:5120
  ds_read_b64_tr_b16 v[36:37], v7 offset:4096
  ds_read_b64_tr_b16 v[38:39], v7 offset:5120
  s_waitcnt lgkmcnt(8)
  v_mfma_f32_32x32x16_bf16 v[64:79], v[40:43], v[208:211], v[64:79]
  s_add_u32 s90, s80, 0
  s_add_u32 m0, s15, 16384
  s_nop 0
  buffer_load_dwordx4 v4, s[40:43], s90 offen lds
  v_mfma_f32_32x32x16_bf16 v[96:111], v[44:47], v[208:211], v[96:111]
  s_add_u32 s90, s80, 7168
  s_add_u32 m0, s15, 17408
  s_nop 0
  buffer_load_dwordx4 v4, s[40:43], s90 offen lds
  s_add_u32 s80, s80, 14336
  s_cmp_eq_u32 s80, s82
  s_cselect_b32 s80, s81, s80
  v_mfma_f32_32x32x16_bf16 v[80:95], v[40:43], v[212:215], v[80:95]
  buffer_load_dwordx4 v[184:187], v5, s[48:51], s76 offen sc1
  v_mfma_f32_32x32x16_bf16 v[112:127], v[44:47], v[212:215], v[112:127]
  s_add_u32 s90, s76, 114688
  buffer_load_dwordx4 v[188:191], v5, s[48:51], s90 offen sc1
  s_add_u32 s76, s76, 1024
  s_cmp_eq_u32 s76, s78
  s_cselect_b32 s76, s77, s76
  s_waitcnt vmcnt(25)
  ds_read_b64_tr_b16 v[40:41], v6 offset:6144
  ds_read_b64_tr_b16 v[42:43], v6 offset:7168
  ds_read_b64_tr_b16 v[44:45], v7 offset:6144
  ds_read_b64_tr_b16 v[46:47], v7 offset:7168
  s_waitcnt lgkmcnt(8)
  v_mfma_f32_32x32x16_bf16 v[64:79], v[48:51], v[128:131], v[64:79]
  s_add_u32 s90, s80, 0
  s_add_u32 m0, s15, 18432
  s_nop 0
  buffer_load_dwordx4 v4, s[40:43], s90 offen lds
  v_mfma_f32_32x32x16_bf16 v[96:111], v[52:55], v[128:131], v[96:111]
  s_add_u32 s90, s80, 7168
  s_add_u32 m0, s15, 19456
  s_nop 0
  buffer_load_dwordx4 v4, s[40:43], s90 offen lds
  s_add_u32 s80, s80, 14336
  s_cmp_eq_u32 s80, s82
  s_cselect_b32 s80, s81, s80
  v_mfma_f32_32x32x16_bf16 v[80:95], v[48:51], v[132:135], v[80:95]
  buffer_load_dwordx4 v[192:195], v5, s[48:51], s76 offen sc1
  v_mfma_f32_32x32x16_bf16 v[112:127], v[52:55], v[132:135], v[112:127]
  s_add_u32 s90, s76, 114688
  buffer_load_dwordx4 v[196:199], v5, s[48:51], s90 offen sc1
  s_add_u32 s76, s76, 1024
  s_cmp_eq_u32 s76, s78
  s_cselect_b32 s76, s77, s76
  s_waitcnt vmcnt(25)
  ds_read_b64_tr_b16 v[48:49], v6 offset:8192
  ds_read_b64_tr_b16 v[50:51], v6 offset:9216
  ds_read_b64_tr_b16 v[52:53], v7 offset:8192
  ds_read_b64_tr_b16 v[54:55], v7 offset:9216
  s_waitcnt lgkmcnt(8)
  v_mfma_f32_32x32x16_bf16 v[64:79], v[32:35], v[136:139], v[64:79]
  s_mov_b32 s81, s84
  s_add_u32 s82, s81, 114688
  s_mul_i32 s90, s86, 14336
  s_add_u32 s80, s81, s90
  s_add_u32 s90, s80, 0
  s_add_u32 m0, s15, 0
  s_nop 0
  buffer_load_dwordx4 v4, s[40:43], s90 offen lds
  v_mfma_f32_32x32x16_bf16 v[96:111], v[36:39], v[136:139], v[96:111]
  s_add_u32 s90, s80, 7168
  s_add_u32 m0, s15, 1024
  s_nop 0
  buffer_load_dwordx4 v4, s[40:43], s90 offen lds
  s_add_u32 s80, s80, 14336
  s_cmp_eq_u32 s80, s82
  s_cselect_b32 s80, s81, s80
  v_mfma_f32_32x32x16_bf16 v[80:95], v[32:35], v[140:143], v[80:95]
  s_waitcnt vmcnt(16)
  v_cmp_ne_u32 vcc, s74, v13
  s_nop 0
  s_and_b32 s90, vcc_lo, 255
  s_cmp_eq_u32 s90, 0
  s_cbranch_scc1 L_fok_267
  s_mov_b64 s[100:101], exec
  s_mov_b64 exec, 255
  s_mov_b32 s95, 0
L_poll_268:
  buffer_load_dword v10, v11, s[48:51], s83 offen sc1
  s_waitcnt vmcnt(0)
  v_cmp_ne_u32 vcc, s74, v10
  s_add_u32 s95, s95, 1
  s_cmp_eq_u64 vcc, 0
  s_cbranch_scc1 L_polldone_269
  s_sleep 2
  s_cmp_lt_u32 s95, 0x20000
  s_cbranch_scc1 L_poll_268
L_polldone_269:
  s_mov_b64 exec, s[100:101]
L_fok_267:
  s_mov_b32 s77, s85
  s_add_u32 s78, s77, 8192
  s_lshl_b32 s90, s86, 10
  s_add_u32 s76, s77, s90
  buffer_load_dwordx4 v[200:203], v5, s[48:51], s76 offen sc1
  v_mfma_f32_32x32x16_bf16 v[112:127], v[36:39], v[140:143], v[112:127]
  s_add_u32 s90, s76, 114688
  buffer_load_dwordx4 v[204:207], v5, s[48:51], s90 offen sc1
  s_add_u32 s76, s76, 1024
  s_cmp_eq_u32 s76, s78
  s_cselect_b32 s76, s77, s76
  ds_read_b64_tr_b16 v[32:33], v6 offset:10240
  ds_read_b64_tr_b16 v[34:35], v6 offset:11264
  ds_read_b64_tr_b16 v[36:37], v7 offset:10240
  ds_read_b64_tr_b16 v[38:39], v7 offset:11264
  s_waitcnt lgkmcnt(8)
  v_mfma_f32_32x32x16_bf16 v[64:79], v[40:43], v[144:147], v[64:79]
  s_add_u32 s90, s80, 0
  s_add_u32 m0, s15, 2048
  s_nop 0
  buffer_load_dwordx4 v4, s[40:43], s90 offen lds
  v_mfma_f32_32x32x16_bf16 v[96:111], v[44:47], v[144:147], v[96:111]
  s_add_u32 s90, s80, 7168
  s_add_u32 m0, s15, 3072
  s_nop 0
  buffer_load_dwordx4 v4, s[40:43], s90 offen lds
  s_add_u32 s80, s80, 14336
  s_cmp_eq_u32 s80, s82
  s_cselect_b32 s80, s81, s80
  v_mfma_f32_32x32x16_bf16 v[80:95], v[40:43], v[148:151], v[80:95]
  buffer_load_dwordx4 v[208:211], v5, s[48:51], s76 offen sc1
  v_mfma_f32_32x32x16_bf16 v[112:127], v[44:47], v[148:151], v[112:127]
  s_add_u32 s90, s76, 114688
  buffer_load_dwordx4 v[212:215], v5, s[48:51], s90 offen sc1
  s_add_u32 s76, s76, 1024
  s_cmp_eq_u32 s76, s78
  s_cselect_b32 s76, s77, s76
  ds_read_b64_tr_b16 v[40:41], v6 offset:12288
  ds_read_b64_tr_b16 v[42:43], v6 offset:13312
  ds_read_b64_tr_b16 v[44:45], v7 offset:12288
  ds_read_b64_tr_b16 v[46:47], v7 offset:13312
  s_waitcnt lgkmcnt(8)
  v_mfma_f32_32x32x16_bf16 v[64:79], v[48:51], v[152:155], v[64:79]
  s_add_u32 s90, s80, 0
  s_add_u32 m0, s15, 4096
  s_nop 0
  buffer_load_dwordx4 v4, s[40:43], s90 offen lds
  v_mfma_f32_32x32x16_bf16 v[96:111], v[52:55], v[152:155], v[96:111]
  s_add_u32 s90, s80, 7168
  s_add_u32 m0, s15, 5120
  s_nop 0
  buffer_load_dwordx4 v4, s[40:43], s90 offen lds
  s_add_u32 s80, s80, 14336
  s_cmp_eq_u32 s80, s82
  s_cselect_b32 s80, s81, s80
  v_mfma_f32_32x32x16_bf16 v[80:95], v[48:51], v[156:159], v[80:95]
  buffer_load_dwordx4 v[128:131], v5, s[48:51], s76 offen sc1
  v_mfma_f32_32x32x16_bf16 v[112:127], v[52:55], v[156:159], v[112:127]
  s_add_u32 s90, s76, 114688
  buffer_load_dwordx4 v[132:135], v5, s[48:51], s90 offen sc1
  s_add_u32 s76, s76, 1024
  s_cmp_eq_u32 s76, s78
  s_cselect_b32 s76, s77, s76
  s_waitcnt vmcnt(22)
  ds_read_b64_tr_b16 v[48:49], v6 offset:14336
  ds_read_b64_tr_b16 v[50:51], v6 offset:15360
  ds_read_b64_tr_b16 v[52:53], v7 offset:14336
  ds_read_b64_tr_b16 v[54:55], v7 offset:15360
  s_waitcnt lgkmcnt(8)
  v_mfma_f32_32x32x16_bf16 v[64:79], v[32:35], v[160:163], v[64:79]
  s_add_u32 s90, s80, 0
  s_add_u32 m0, s15, 6144
  s_nop 0
  buffer_load_dwordx4 v4, s[40:43], s90 offen lds
  v_mfma_f32_32x32x16_bf16 v[96:111], v[36:39], v[160:163], v[96:111]
  s_add_u32 s90, s80, 7168
  s_add_u32 m0, s15, 7168
  s_nop 0
  buffer_load_dwordx4 v4, s[40:43], s90 offen lds
  s_add_u32 s80, s80, 14336
  s_cmp_eq_u32 s80, s82
  s_cselect_b32 s80, s81, s80
  v_mfma_f32_32x32x16_bf16 v[80:95], v[32:35], v[164:167], v[80:95]
  buffer_load_dwordx4 v[136:139], v5, s[48:51], s76 offen sc1
  v_mfma_f32_32x32x16_bf16 v[112:127], v[36:39], v[164:167], v[112:127]
  s_add_u32 s90, s76, 114688
  buffer_load_dwordx4 v[140:143], v5, s[48:51], s90 offen sc1
  s_add_u32 s76, s76, 1024
  s_cmp_eq_u32 s76, s78
  s_cselect_b32 s76, s77, s76
  s_waitcnt vmcnt(22)
  ds_read_b64_tr_b16 v[32:33], v6 offset:16384
  ds_read_b64_tr_b16 v[34:35], v6 offset:17408
  ds_read_b64_tr_b16 v[36:37], v7 offset:16384
  ds_read_b64_tr_b16 v[38:39], v7 offset:17408
  s_waitcnt lgkmcnt(8)
  v_mfma_f32_32x32x16_bf16 v[64:79], v[40:43], v[168:171], v[64:79]
  s_add_u32 s90, s80, 0
  s_add_u32 m0, s15, 8192
  s_nop 0
  buffer_load_dwordx4 v4, s[40:43], s90 offen lds
  v_mfma_f32_32x32x16_bf16 v[96:111], v[44:47], v[168:171], v[96:111]
  s_add_u32 s90, s80, 7168
  s_add_u32 m0, s15, 9216
  s_nop 0
  buffer_load_dwordx4 v4, s[40:43], s90 offen lds
  s_add_u32 s80, s80, 14336
  s_cmp_eq_u32 s80, s82
  s_cselect_b32 s80, s81, s80
  v_mfma_f32_32x32x16_bf16 v[80:95], v[40:43], v[172:175], v[80:95]
  buffer_load_dwordx4 v[144:147], v5, s[48:51], s76 offen sc1
  v_mfma_f32_32x32x16_bf16 v[112:127], v[44:47], v[172:175], v[112:127]
  s_add_u32 s90, s76, 114688
  buffer_load_dwordx4 v[148:151], v5, s[48:51], s90 offen sc1
  s_add_u32 s76, s76, 1024
  s_cmp_eq_u32 s76, s78
  s_cselect_b32 s76, s77, s76
  s_waitcnt vmcnt(22)
  ds_read_b64_tr_b16 v[40:41], v6 offset:18432
  ds_read_b64_tr_b16 v[42:43], v6 offset:19456
  ds_read_b64_tr_b16 v[44:45], v7 offset:18432
  ds_read_b64_tr_b16 v[46:47], v7 offset:19456
  s_waitcnt lgkmcnt(8)
  v_mfma_f32_32x32x16_bf16 v[64:79], v[48:51], v[176:179], v[64:79]
  s_add_u32 s90, s80, 0
  s_add_u32 m0, s15, 10240
  s_nop 0
  buffer_load_dwordx4 v4, s[40:43], s90 offen lds
  v_mfma_f32_32x32x16_bf16 v[96:111], v[52:55], v[176:179], v[96:111]
  s_add_u32 s90, s80, 7168
  s_add_u32 m0, s15, 11264
  s_nop 0
  buffer_load_dwordx4 v4, s[40:43], s90 offen lds
  s_add_u32 s80, s80, 14336
  s_cmp_eq_u32 s80, s82
  s_cselect_b32 s80, s81, s80
  v_mfma_f32_32x32x16_bf16 v[80:95], v[48:51], v[180:183], v[80:95]
  buffer_load_dwordx4 v[152:155], v5, s[48:51], s76 offen sc1
  v_mfma_f32_32x32x16_bf16 v[112:127], v[52:55], v[180:183], v[112:127]
  s_add_u32 s90, s76, 114688
  buffer_load_dwordx4 v[156:159], v5, s[48:51], s90 offen sc1
  s_add_u32 s76, s76, 1024
  s_cmp_eq_u32 s76, s78
  s_cselect_b32 s76, s77, s76
  s_waitcnt vmcnt(22)
  ds_read_b64_tr_b16 v[48:49], v6 offset:0
  ds_read_b64_tr_b16 v[50:51], v6 offset:1024
  ds_read_b64_tr_b16 v[52:53], v7 offset:0
  ds_read_b64_tr_b16 v[54:55], v7 offset:1024
  s_waitcnt lgkmcnt(8)
  v_mfma_f32_32x32x16_bf16 v[64:79], v[32:35], v[184:187], v[64:79]
  s_add_u32 s90, s80, 0
  s_add_u32 m0, s15, 12288
  s_nop 0
  buffer_load_dwordx4 v4, s[40:43], s90 offen lds
  v_mfma_f32_32x32x16_bf16 v[96:111], v[36:39], v[184:187], v[96:111]
  s_add_u32 s90, s80, 7168
  s_add_u32 m0, s15, 13312
  s_nop 0
  buffer_load_dwordx4 v4, s[40:43], s90 offen lds
  s_add_u32 s80, s80, 14336
  s_cmp_eq_u32 s80, s82
  s_cselect_b32 s80, s81, s80
  v_mfma_f32_32x32x16_bf16 v[80:95], v[32:35], v[188:191], v[80:95]
  buffer_load_dwordx4 v[160:163], v5, s[48:51], s76 offen sc1
  v_mfma_f32_32x32x16_bf16 v[112:127], v[36:39], v[188:191], v[112:127]
  s_add_u32 s90, s76, 114688
  buffer_load_dwordx4 v[164:167], v5, s[48:51], s90 offen sc1
  s_add_u32 s76, s76, 1024
  s_cmp_eq_u32 s76, s78
  s_cselect_b32 s76, s77, s76
  s_waitcnt vmcnt(22)
  ds_read_b64_tr_b16 v[32:33], v6 offset:2048
  ds_read_b64_tr_b16 v[34:35], v6 offset:3072
  ds_read_b64_tr_b16 v[36:37], v7 offset:2048
  ds_read_b64_tr_b16 v[38:39], v7 offset:3072
  s_waitcnt lgkmcnt(8)
  v_mfma_f32_32x32x16_bf16 v[64:79], v[40:43], v[192:195], v[64:79]
  s_add_u32 s90, s80, 0
  s_add_u32 m0, s15, 14336
  s_nop 0
  buffer_load_dwordx4 v4, s[40:43], s90 offen lds
  v_mfma_f32_32x32x16_bf16 v[96:111], v[44:47], v[192:195], v[96:111]
  s_add_u32 s90, s80, 7168
  s_add_u32 m0, s15, 15360
  s_nop 0
  buffer_load_dwordx4 v4, s[40:43], s90 offen lds
  s_add_u32 s80, s80, 14336
  s_cmp_eq_u32 s80, s82
  s_cselect_b32 s80, s81, s80
  v_mfma_f32_32x32x16_bf16 v[80:95], v[40:43], v[196:199], v[80:95]
  buffer_load_dwordx4 v[168:171], v5, s[48:51], s76 offen sc1
  v_mfma_f32_32x32x16_bf16 v[112:127], v[44:47], v[196:199], v[112:127]
  s_add_u32 s90, s76, 114688
  buffer_load_dwordx4 v[172:175], v5, s[48:51], s90 offen sc1
  s_add_u32 s76, s76, 1024
  s_cmp_eq_u32 s76, s78
  s_cselect_b32 s76, s77, s76
  s_waitcnt vmcnt(22)
  ds_read_b64_tr_b16 v[40:41], v6 offset:4096
  ds_read_b64_tr_b16 v[42:43], v6 offset:5120
  ds_read_b64_tr_b16 v[44:45], v7 offset:4096
  ds_read_b64_tr_b16 v[46:47], v7 offset:5120
  s_waitcnt lgkmcnt(8)
  v_mfma_f32_32x32x16_bf16 v[64:79], v[48:51], v[200:203], v[64:79]
  v_mfma_f32_32x32x16_bf16 v[96:111], v[52:55], v[200:203], v[96:111]
  v_mfma_f32_32x32x16_bf16 v[80:95], v[48:51], v[204:207], v[80:95]
  v_mfma_f32_32x32x16_bf16 v[112:127], v[52:55], v[204:207], v[112:127]
  s_waitcnt vmcnt(18)
  ds_read_b64_tr_b16 v[48:49], v6 offset:6144
  ds_read_b64_tr_b16 v[50:51], v6 offset:7168
  ds_read_b64_tr_b16 v[52:53], v7 offset:6144
  ds_read_b64_tr_b16 v[54:55], v7 offset:7168
  s_waitcnt lgkmcnt(8)
  v_mfma_f32_32x32x16_bf16 v[64:79], v[32:35], v[208:211], v[64:79]
  v_mfma_f32_32x32x16_bf16 v[96:111], v[36:39], v[208:211], v[96:111]
  v_mfma_f32_32x32x16_bf16 v[80:95], v[32:35], v[212:215], v[80:95]
  v_mfma_f32_32x32x16_bf16 v[112:127], v[36:39], v[212:215], v[112:127]
  s_waitcnt vmcnt(14)
  ds_read_b64_tr_b16 v[32:33], v6 offset:8192
  ds_read_b64_tr_b16 v[34:35], v6 offset:9216
  ds_read_b64_tr_b16 v[36:37], v7 offset:8192
  ds_read_b64_tr_b16 v[38:39], v7 offset:9216
  s_waitcnt lgkmcnt(8)
  v_mfma_f32_32x32x16_bf16 v[64:79], v[40:43], v[128:131], v[64:79]
  v_mfma_f32_32x32x16_bf16 v[96:111], v[44:47], v[128:131], v[96:111]
  v_mfma_f32_32x32x16_bf16 v[80:95], v[40:43], v[132:135], v[80:95]
  v_mfma_f32_32x32x16_bf16 v[112:127], v[44:47], v[132:135], v[112:127]
  s_waitcnt vmcnt(10)
  ds_read_b64_tr_b16 v[40:41], v6 offset:10240
  ds_read_b64_tr_b16 v[42:43], v6 offset:11264
  ds_read_b64_tr_b16 v[44:45], v7 offset:10240
  ds_read_b64_tr_b16 v[46:47], v7 offset:11264
  s_waitcnt lgkmcnt(8)
  v_mfma_f32_32x32x16_bf16 v[64:79], v[48:51], v[136:139], v[64:79]
  v_mfma_f32_32x32x16_bf16 v[96:111], v[52:55], v[136:139], v[96:111]
  v_mfma_f32_32x32x16_bf16 v[80:95], v[48:51], v[140:143], v[80:95]
  v_mfma_f32_32x32x16_bf16 v[112:127], v[52:55], v[140:143], v[112:127]
  s_waitcnt vmcnt(6)
  ds_read_b64_tr_b16 v[48:49], v6 offset:12288
  ds_read_b64_tr_b16 v[50:51], v6 offset:13312
  ds_read_b64_tr_b16 v[52:53], v7 offset:12288
  ds_read_b64_tr_b16 v[54:55], v7 offset:13312
  s_waitcnt lgkmcnt(8)
  v_mfma_f32_32x32x16_bf16 v[64:79], v[32:35], v[144:147], v[64:79]
  v_mfma_f32_32x32x16_bf16 v[96:111], v[36:39], v[144:147], v[96:111]
  v_mfma_f32_32x32x16_bf16 v[80:95], v[32:35], v[148:151], v[80:95]
  v_mfma_f32_32x32x16_bf16 v[112:127], v[36:39], v[148:151], v[112:127]
  s_waitcnt vmcnt(2)
  ds_read_b64_tr_b16 v[32:33], v6 offset:14336
  ds_read_b64_tr_b16 v[34:35], v6 offset:15360
  ds_read_b64_tr_b16 v[36:37], v7 offset:14336
  ds_read_b64_tr_b16 v[38:39], v7 offset:15360
  s_waitcnt lgkmcnt(8)
  v_mfma_f32_32x32x16_bf16 v[64:79], v[40:43], v[152:155], v[64:79]
  v_mfma_f32_32x32x16_bf16 v[96:111], v[44:47], v[152:155], v[96:111]
  v_mfma_f32_32x32x16_bf16 v[80:95], v[40:43], v[156:159], v[80:95]
  v_mfma_f32_32x32x16_bf16 v[112:127], v[44:47], v[156:159], v[112:127]
  s_waitcnt lgkmcnt(4)
  v_mfma_f32_32x32x16_bf16 v[64:79], v[48:51], v[160:163], v[64:79]
  v_mfma_f32_32x32x16_bf16 v[96:111], v[52:55], v[160:163], v[96:111]
  v_mfma_f32_32x32x16_bf16 v[80:95], v[48:51], v[164:167], v[80:95]
  v_mfma_f32_32x32x16_bf16 v[112:127], v[52:55], v[164:167], v[112:127]
  s_waitcnt vmcnt(0)
  s_waitcnt lgkmcnt(0)
  v_mfma_f32_32x32x16_bf16 v[64:79], v[32:35], v[168:171], v[64:79]
  v_mfma_f32_32x32x16_bf16 v[96:111], v[36:39], v[168:171], v[96:111]
  v_mfma_f32_32x32x16_bf16 v[80:95], v[32:35], v[172:175], v[80:95]
  v_mfma_f32_32x32x16_bf16 v[112:127], v[36:39], v[172:175], v[112:127]
  v_mul_u32_u24 v9, 144, v2
  v_lshl_add_u32 v9, v3, 3, v9
  v_add_u32 v9, s15, v9
  s_nop 5
  v_cvt_pk_bf16_f32 v64, v64, v65
  v_cvt_pk_bf16_f32 v65, v66, v67
  v_cvt_pk_bf16_f32 v66, v68, v69
  v_cvt_pk_bf16_f32 v67, v70, v71
  v_cvt_pk_bf16_f32 v68, v72, v73
  v_cvt_pk_bf16_f32 v69, v74, v75
  v_cvt_pk_bf16_f32 v70, v76, v77
  v_cvt_pk_bf16_f32 v71, v78, v79
  ds_write_b64 v9, v[64:65] offset:0
  ds_write_b64 v9, v[66:67] offset:16
  ds_write_b64 v9, v[68:69] offset:32
  ds_write_b64 v9, v[70:71] offset:48
  v_cvt_pk_bf16_f32 v80, v80, v81
  v_cvt_pk_bf16_f32 v81, v82, v83
  v_cvt_pk_bf16_f32 v82, v84, v85
  v_cvt_pk_bf16_f32 v83, v86, v87
  v_cvt_pk_bf16_f32 v84, v88, v89
  v_cvt_pk_bf16_f32 v85, v90, v91
  v_cvt_pk_bf16_f32 v86, v92, v93
  v_cvt_pk_bf16_f32 v87, v94, v95
  ds_write_b64 v9, v[80:81] offset:4608
  ds_write_b64 v9, v[82:83] offset:4624
  ds_write_b64 v9, v[84:85] offset:4640
  ds_write_b64 v9, v[86:87] offset:4656
  v_cvt_pk_bf16_f32 v96, v96, v97
  v_cvt_pk_bf16_f32 v97, v98, v99
  v_cvt_pk_bf16_f32 v98, v100, v101
  v_cvt_pk_bf16_f32 v99, v102, v103
  v_cvt_pk_bf16_f32 v100, v104, v105
  v_cvt_pk_bf16_f32 v101, v106, v107
  v_cvt_pk_bf16_f32 v102, v108, v109
  v_cvt_pk_bf16_f32 v103, v110, v111
  ds_write_b64 v9, v[96:97] offset:64
  ds_write_b64 v9, v[98:99] offset:80
  ds_write_b64 v9, v[100:101] offset:96
  ds_write_b64 v9, v[102:103] offset:112
  s_waitcnt lgkmcnt(0)
  v_cvt_pk_bf16_f32 v112, v112, v113
  v_cvt_pk_bf16_f32 v113, v114, v115
  v_cvt_pk_bf16_f32 v114, v116, v117
  v_cvt_pk_bf16_f32 v115, v118, v119
  v_cvt_pk_bf16_f32 v116, v120, v121
  v_cvt_pk_bf16_f32 v117, v122, v123
  v_cvt_pk_bf16_f32 v118, v124, v125
  v_cvt_pk_bf16_f32 v119, v126, v127
  ds_write_b64 v9, v[112:113] offset:4672
  ds_write_b64 v9, v[114:115] offset:4688
  ds_write_b64 v9, v[116:117] offset:4704
  ds_write_b64 v9, v[118:119] offset:4720
  s_waitcnt lgkmcnt(0)
  s_waitcnt vmcnt(0)
  v_mov_b32 v9, 151640
  v_mov_b32 v10, 1
  s_mov_b64 s[100:101], exec
  s_mov_b64 exec, 1
  ds_add_u32 v9, v10
  s_mov_b64 exec, s[100:101]
  s_mov_b32 s95, 0
L_gw_270:
  ds_read_b32 v10, v9
  s_waitcnt lgkmcnt(0)
  v_readfirstlane_b32 s90, v10
  s_add_u32 s95, s95, 1
  s_cmp_ge_u32 s90, 4
  s_cbranch_scc1 L_gwd_271
  s_cmp_lt_u32 s95, 0x400000
  s_cbranch_scc1 L_gw_270
L_gwd_271:
  v_lshrrev_b32 v11, 3, v1
  s_lshl_b32 s90, s70, 3
  v_add_u32 v11, s90, v11
  v_mul_u32_u24 v11, 144, v11
  v_and_b32 v10, 7, v1
  v_lshl_add_u32 v11, v10, 4, v11
  v_add_u32 v12, 4608, v11
  ds_read_b128 v[128:131], v11 offset:0
  ds_read_b128 v[132:135], v11 offset:20480
  ds_read_b128 v[136:139], v11 offset:40960
  ds_read_b128 v[140:143], v11 offset:61440
  ds_read_b128 v[144:147], v12 offset:0
  ds_read_b128 v[148:151], v12 offset:20480
  ds_read_b128 v[152:155], v12 offset:40960
  ds_read_b128 v[156:159], v12 offset:61440
  s_mov_b32 s90, 0x00003f80
  s_mov_b32 s91, 0x3f800000
  s_mov_b32 s92, 0xbfb8aa3b
  s_mov_b32 s93, 0xffff0000
  v_lshlrev_b32 v192, 16, v252
  v_and_b32 v193, s93, v252
  v_lshlrev_b32 v194, 16, v253
  v_and_b32 v195, s93, v253
  v_lshlrev_b32 v196, 16, v254
  v_and_b32 v197, s93, v254
  v_lshlrev_b32 v198, 16, v255
  v_and_b32 v199, s93, v255
  s_waitcnt lgkmcnt(7)
  v_dot2c_f32_bf16 v192, s90, v128
  v_dot2c_f32_bf16 v193, s91, v128
  v_dot2c_f32_bf16 v194, s90, v129
  v_dot2c_f32_bf16 v195, s91, v129
  v_dot2c_f32_bf16 v196, s90, v130
  v_dot2c_f32_bf16 v197, s91, v130
  v_dot2c_f32_bf16 v198, s90, v131
  v_dot2c_f32_bf16 v199, s91, v131
  s_waitcnt lgkmcnt(6)
  v_dot2c_f32_bf16 v192, s90, v132
  v_dot2c_f32_bf16 v193, s91, v132
  v_dot2c_f32_bf16 v194, s90, v133
  v_dot2c_f32_bf16 v195, s91, v133
  v_dot2c_f32_bf16 v196, s90, v134
  v_dot2c_f32_bf16 v197, s91, v134
  v_dot2c_f32_bf16 v198, s90, v135
  v_dot2c_f32_bf16 v199, s91, v135
  s_waitcnt lgkmcnt(5)
  v_dot2c_f32_bf16 v192, s90, v136
  v_dot2c_f32_bf16 v193, s91, v136
  v_dot2c_f32_bf16 v194, s90, v137
  v_dot2c_f32_bf16 v195, s91, v137
  v_dot2c_f32_bf16 v196, s90, v138
  v_dot2c_f32_bf16 v197, s91, v138
  v_dot2c_f32_bf16 v198, s90, v139
  v_dot2c_f32_bf16 v199, s91, v139
  s_waitcnt lgkmcnt(4)
  v_dot2c_f32_bf16 v192, s90, v140
  v_dot2c_f32_bf16 v193, s91, v140
  v_dot2c_f32_bf16 v194, s90, v141
  v_dot2c_f32_bf16 v195, s91, v141
  v_dot2c_f32_bf16 v196, s90, v142
  v_dot2c_f32_bf16 v197, s91, v142
  v_dot2c_f32_bf16 v198, s90, v143
  v_dot2c_f32_bf16 v199, s91, v143
  v_mul_f32 v216, s92, v192
  v_mul_f32 v217, s92, v193
  v_mul_f32 v218, s92, v194
  v_mul_f32 v219, s92, v195
  v_mul_f32 v220, s92, v196
  v_mul_f32 v221, s92, v197
  v_mul_f32 v222, s92, v198
  v_mul_f32 v223, s92, v199
  v_exp_f32 v216, v216
  v_exp_f32 v217, v217
  v_exp_f32 v218, v218
  v_exp_f32 v219, v219
  v_exp_f32 v220, v220
  v_exp_f32 v221, v221
  v_exp_f32 v222, v222
  v_exp_f32 v223, v223
  v_add_f32 v216, 1.0, v216
  v_add_f32 v217, 1.0, v217
  v_add_f32 v218, 1.0, v218
  v_add_f32 v219, 1.0, v219
  v_add_f32 v220, 1.0, v220
  v_add_f32 v221, 1.0, v221
  v_add_f32 v222, 1.0, v222
  v_add_f32 v223, 1.0, v223
  v_rcp_f32 v216, v216
  v_rcp_f32 v217, v217
  v_rcp_f32 v218, v218
  v_rcp_f32 v219, v219
  v_rcp_f32 v220, v220
  v_rcp_f32 v221, v221
  v_rcp_f32 v222, v222
  v_rcp_f32 v223, v223
  v_mul_f32 v216, v216, v192
  v_mul_f32 v217, v217, v193
  v_mul_f32 v218, v218, v194
  v_mul_f32 v219, v219, v195
  v_mul_f32 v220, v220, v196
  v_mul_f32 v221, v221, v197
  v_mul_f32 v222, v222, v198
  v_mul_f32 v223, v223, v199
  v_lshlrev_b32 v200, 16, v252
  v_and_b32 v201, s93, v252
  v_lshlrev_b32 v202, 16, v253
  v_and_b32 v203, s93, v253
  v_lshlrev_b32 v204, 16, v254
  v_and_b32 v205, s93, v254
  v_lshlrev_b32 v206, 16, v255
  v_and_b32 v207, s93, v255
  s_waitcnt lgkmcnt(3)
  v_dot2c_f32_bf16 v200, s90, v144
  v_dot2c_f32_bf16 v201, s91, v144
  v_dot2c_f32_bf16 v202, s90, v145
  v_dot2c_f32_bf16 v203, s91, v145
  v_dot2c_f32_bf16 v204, s90, v146
  v_dot2c_f32_bf16 v205, s91, v146
  v_dot2c_f32_bf16 v206, s90, v147
  v_dot2c_f32_bf16 v207, s91, v147
  s_waitcnt lgkmcnt(2)
  v_dot2c_f32_bf16 v200, s90, v148
  v_dot2c_f32_bf16 v201, s91, v148
  v_dot2c_f32_bf16 v202, s90, v149
  v_dot2c_f32_bf16 v203, s91, v149
  v_dot2c_f32_bf16 v204, s90, v150
  v_dot2c_f32_bf16 v205, s91, v150
  v_dot2c_f32_bf16 v206, s90, v151
  v_dot2c_f32_bf16 v207, s91, v151
  s_waitcnt lgkmcnt(1)
  v_dot2c_f32_bf16 v200, s90, v152
  v_dot2c_f32_bf16 v201, s91, v152
  v_dot2c_f32_bf16 v202, s90, v153
  v_dot2c_f32_bf16 v203, s91, v153
  v_dot2c_f32_bf16 v204, s90, v154
  v_dot2c_f32_bf16 v205, s91, v154
  v_dot2c_f32_bf16 v206, s90, v155
  v_dot2c_f32_bf16 v207, s91, v155
  s_waitcnt lgkmcnt(0)
  v_dot2c_f32_bf16 v200, s90, v156
  v_dot2c_f32_bf16 v201, s91, v156
  v_dot2c_f32_bf16 v202, s90, v157
  v_dot2c_f32_bf16 v203, s91, v157
  v_dot2c_f32_bf16 v204, s90, v158
  v_dot2c_f32_bf16 v205, s91, v158
  v_dot2c_f32_bf16 v206, s90, v159
  v_dot2c_f32_bf16 v207, s91, v159
  v_mul_f32 v224, s92, v200
  v_mul_f32 v225, s92, v201
  v_mul_f32 v226, s92, v202
  v_mul_f32 v227, s92, v203
  v_mul_f32 v228, s92, v204
  v_mul_f32 v229, s92, v205
  v_mul_f32 v230, s92, v206
  v_mul_f32 v231, s92, v207
  v_exp_f32 v224, v224
  v_exp_f32 v225, v225
  v_exp_f32 v226, v226
  v_exp_f32 v227, v227
  v_exp_f32 v228, v228
  v_exp_f32 v229, v229
  v_exp_f32 v230, v230
  v_exp_f32 v231, v231
  v_add_f32 v224, 1.0, v224
  v_add_f32 v225, 1.0, v225
  v_add_f32 v226, 1.0, v226
  v_add_f32 v227, 1.0, v227
  v_add_f32 v228, 1.0, v228
  v_add_f32 v229, 1.0, v229
  v_add_f32 v230, 1.0, v230
  v_add_f32 v231, 1.0, v231
  v_rcp_f32 v224, v224
  v_rcp_f32 v225, v225
  v_rcp_f32 v226, v226
  v_rcp_f32 v227, v227
  v_rcp_f32 v228, v228
  v_rcp_f32 v229, v229
  v_rcp_f32 v230, v230
  v_rcp_f32 v231, v231
  v_mul_f32 v224, v224, v200
  v_mul_f32 v225, v225, v201
  v_mul_f32 v226, v226, v202
  v_mul_f32 v227, v227, v203
  v_mul_f32 v228, v228, v204
  v_mul_f32 v229, v229, v205
  v_mul_f32 v230, v230, v206
  v_mul_f32 v231, v231, v207
  v_lshlrev_b32 v9, 5, v1
  v_add_u32 v9, s15, v9
  ds_write_b128 v9, v[224:227] offset:10240
  ds_write_b128 v9, v[228:231] offset:10256
  s_waitcnt lgkmcnt(0)
  s_branch L_FINAL_F
L_RED:
  s_lshr_b32 s90, s2, 3
  s_sub_u32 s90, s90, 28
  s_and_b32 s91, s2, 7
  s_lshl_b32 s91, s91, 2
  s_add_u32 s90, s90, s91
  s_and_b32 s91, s90, 1
  s_lshr_b32 s87, s90, 1
  s_mov_b32 s94, s90
  s_lshl_b32 s90, s87, 17
  s_lshl_b32 s91, s91, 12
  s_add_u32 s90, s90, s91
  s_lshl_b32 s91, s71, 10
  s_add_u32 s90, s90, s91
  s_add_u32 s83, s90, 262144
  v_lshlrev_b32 v9, 13, v1
  v_add_u32 v9, 1020, v9
  s_mov_b64 s[100:101], exec
  s_mov_b64 exec, 65535
  s_mov_b32 s95, 0
L_poll_272:
  buffer_load_dword v10, v9, s[48:51], s83 offen sc1
  s_waitcnt vmcnt(0)
  v_cmp_ne_u32 vcc, s74, v10
  s_add_u32 s95, s95, 1
  s_cmp_eq_u64 vcc, 0
  s_cbranch_scc1 L_polldone_273
  s_sleep 1
  s_cmp_lt_u32 s95, 0x20000
  s_cbranch_scc1 L_poll_272
L_polldone_273:
  s_mov_b64 exec, s[100:101]
  v_lshlrev_b32 v9, 4, v1
  s_mov_b32 s92, 0x00003f80
  s_mov_b32 s93, 0x3f800000
  s_mov_b32 s95, 0
  s_mov_b32 s86, 0
L_rl_274:
  s_mov_b32 s90, s83
  buffer_load_dwordx4 v[128:131], v9, s[48:51], s90 offen sc1
  s_add_u32 s90, s90, 8192
  buffer_load_dwordx4 v[132:135], v9, s[48:51], s90 offen sc1
  s_add_u32 s90, s90, 8192
  buffer_load_dwordx4 v[136:139], v9, s[48:51], s90 offen sc1
  s_add_u32 s90, s90, 8192
  buffer_load_dwordx4 v[140:143], v9, s[48:51], s90 offen sc1
  s_add_u32 s90, s90, 8192
  buffer_load_dwordx4 v[144:147], v9, s[48:51], s90 offen sc1
  s_add_u32 s90, s90, 8192
  buffer_load_dwordx4 v[148:151], v9, s[48:51], s90 offen sc1
  s_add_u32 s90, s90, 8192
  buffer_load_dwordx4 v[152:155], v9, s[48:51], s90 offen sc1
  s_add_u32 s90, s90, 8192
  buffer_load_dwordx4 v[156:159], v9, s[48:51], s90 offen sc1
  s_add_u32 s90, s90, 8192
  buffer_load_dwordx4 v[160:163], v9, s[48:51], s90 offen sc1
  s_add_u32 s90, s90, 8192
  buffer_load_dwordx4 v[164:167], v9, s[48:51], s90 offen sc1
  s_add_u32 s90, s90, 8192
  buffer_load_dwordx4 v[168:171], v9, s[48:51], s90 offen sc1
  s_add_u32 s90, s90, 8192
  buffer_load_dwordx4 v[172:175], v9, s[48:51], s90 offen sc1
  s_add_u32 s90, s90, 8192
  buffer_load_dwordx4 v[176:179], v9, s[48:51], s90 offen sc1
  s_add_u32 s90, s90, 8192
  buffer_load_dwordx4 v[180:183], v9, s[48:51], s90 offen sc1
  s_add_u32 s90, s90, 8192
  buffer_load_dwordx4 v[184:187], v9, s[48:51], s90 offen sc1
  s_add_u32 s90, s90, 8192
  buffer_load_dwordx4 v[188:191], v9, s[48:51], s90 offen sc1
  v_mov_b32 v64, 0
  v_mov_b32 v65, 0
  v_mov_b32 v66, 0
  v_mov_b32 v67, 0
  v_mov_b32 v72, s74
  v_mov_b32 v73, s74
  s_waitcnt vmcnt(15)
  v_dot2c_f32_bf16 v64, s92, v128
  v_max3_u32 v72, v72, v129, v131
  v_dot2c_f32_bf16 v65, s93, v128
  v_min3_u32 v73, v73, v129, v131
  v_dot2c_f32_bf16 v66, s92, v130
  v_dot2c_f32_bf16 v67, s93, v130
  s_waitcnt vmcnt(14)
  v_dot2c_f32_bf16 v64, s92, v132
  v_max3_u32 v72, v72, v133, v135
  v_dot2c_f32_bf16 v65, s93, v132
  v_min3_u32 v73, v73, v133, v135
  v_dot2c_f32_bf16 v66, s92, v134
  v_dot2c_f32_bf16 v67, s93, v134
  s_waitcnt vmcnt(13)
  v_dot2c_f32_bf16 v64, s92, v136
  v_max3_u32 v72, v72, v137, v139
  v_dot2c_f32_bf16 v65, s93, v136
  v_min3_u32 v73, v73, v137, v139
  v_dot2c_f32_bf16 v66, s92, v138
  v_dot2c_f32_bf16 v67, s93, v138
  s_waitcnt vmcnt(12)
  v_dot2c_f32_bf16 v64, s92, v140
  v_max3_u32 v72, v72, v141, v143
  v_dot2c_f32_bf16 v65, s93, v140
  v_min3_u32 v73, v73, v141, v143
  v_dot2c_f32_bf16 v66, s92, v142
  v_dot2c_f32_bf16 v67, s93, v142
  s_waitcnt vmcnt(11)
  v_dot2c_f32_bf16 v64, s92, v144
  v_max3_u32 v72, v72, v145, v147
  v_dot2c_f32_bf16 v65, s93, v144
  v_min3_u32 v73, v73, v145, v147
  v_dot2c_f32_bf16 v66, s92, v146
  v_dot2c_f32_bf16 v67, s93, v146
  s_waitcnt vmcnt(10)
  v_dot2c_f32_bf16 v64, s92, v148
  v_max3_u32 v72, v72, v149, v151
  v_dot2c_f32_bf16 v65, s93, v148
  v_min3_u32 v73, v73, v149, v151
  v_dot2c_f32_bf16 v66, s92, v150
  v_dot2c_f32_bf16 v67, s93, v150
  s_waitcnt vmcnt(9)
  v_dot2c_f32_bf16 v64, s92, v152
  v_max3_u32 v72, v72, v153, v155
  v_dot2c_f32_bf16 v65, s93, v152
  v_min3_u32 v73, v73, v153, v155
  v_dot2c_f32_bf16 v66, s92, v154
  v_dot2c_f32_bf16 v67, s93, v154
  s_waitcnt vmcnt(8)
  v_dot2c_f32_bf16 v64, s92, v156
  v_max3_u32 v72, v72, v157, v159
  v_dot2c_f32_bf16 v65, s93, v156
  v_min3_u32 v73, v73, v157, v159
  v_dot2c_f32_bf16 v66, s92, v158
  v_dot2c_f32_bf16 v67, s93, v158
  s_waitcnt vmcnt(7)
  v_dot2c_f32_bf16 v64, s92, v160
  v_max3_u32 v72, v72, v161, v163
  v_dot2c_f32_bf16 v65, s93, v160
  v_min3_u32 v73, v73, v161, v163
  v_dot2c_f32_bf16 v66, s92, v162
  v_dot2c_f32_bf16 v67, s93, v162
  s_waitcnt vmcnt(6)
  v_dot2c_f32_bf16 v64, s92, v164
  v_max3_u32 v72, v72, v165, v167
  v_dot2c_f32_bf16 v65, s93, v164
  v_min3_u32 v73, v73, v165, v167
  v_dot2c_f32_bf16 v66, s92, v166
  v_dot2c_f32_bf16 v67, s93, v166
  s_waitcnt vmcnt(5)
  v_dot2c_f32_bf16 v64, s92, v168
  v_max3_u32 v72, v72, v169, v171
  v_dot2c_f32_bf16 v65, s93, v168
  v_min3_u32 v73, v73, v169, v171
  v_dot2c_f32_bf16 v66, s92, v170
  v_dot2c_f32_bf16 v67, s93, v170
  s_waitcnt vmcnt(4)
  v_dot2c_f32_bf16 v64, s92, v172
  v_max3_u32 v72, v72, v173, v175
  v_dot2c_f32_bf16 v65, s93, v172
  v_min3_u32 v73, v73, v173, v175
  v_dot2c_f32_bf16 v66, s92, v174
  v_dot2c_f32_bf16 v67, s93, v174
  s_waitcnt vmcnt(3)
  v_dot2c_f32_bf16 v64, s92, v176
  v_max3_u32 v72, v72, v177, v179
  v_dot2c_f32_bf16 v65, s93, v176
  v_min3_u32 v73, v73, v177, v179
  v_dot2c_f32_bf16 v66, s92, v178
  v_dot2c_f32_bf16 v67, s93, v178
  s_waitcnt vmcnt(2)
  v_dot2c_f32_bf16 v64, s92, v180
  v_max3_u32 v72, v72, v181, v183
  v_dot2c_f32_bf16 v65, s93, v180
  v_min3_u32 v73, v73, v181, v183
  v_dot2c_f32_bf16 v66, s92, v182
  v_dot2c_f32_bf16 v67, s93, v182
  s_waitcnt vmcnt(1)
  v_dot2c_f32_bf16 v64, s92, v184
  v_max3_u32 v72, v72, v185, v187
  v_dot2c_f32_bf16 v65, s93, v184
  v_min3_u32 v73, v73, v185, v187
  v_dot2c_f32_bf16 v66, s92, v186
  v_dot2c_f32_bf16 v67, s93, v186
  s_waitcnt vmcnt(0)
  v_dot2c_f32_bf16 v64, s92, v188
  v_max3_u32 v72, v72, v189, v191
  v_dot2c_f32_bf16 v65, s93, v188
  v_min3_u32 v73, v73, v189, v191
  v_dot2c_f32_bf16 v66, s92, v190
  v_dot2c_f32_bf16 v67, s93, v190
  v_cmp_ne_u32 s[84:85], v72, v73
  v_cmp_ne_u32 vcc, s74, v72
  s_nop 0
  s_or_b64 s[84:85], s[84:85], vcc
  s_cmp_eq_u64 s[84:85], 0
  s_cbranch_scc1 L_rok_275
  s_add_u32 s95, s95, 1
  s_sleep 2
  s_cmp_lt_u32 s95, 0x20000
  s_cbranch_scc1 L_rl_274
L_rok_275:
  v_cvt_pk_bf16_f32 v68, v64, v65
  v_cvt_pk_bf16_f32 v70, v66, v67
  v_mov_b32 v69, s74
  v_mov_b32 v71, s74
  s_cmp_lg_u32 s71, 3
  s_cbranch_scc1 L_nz_276
  v_mov_b32 v10, 0
  v_cndmask_b32 v68, v68, v10, s[4:5]
  v_cndmask_b32 v70, v70, v10, s[4:5]
L_nz_276:
  s_lshl_b32 s90, s94, 12
  s_lshl_b32 s91, s71, 10
  s_add_u32 s90, s90, s91
  s_add_u32 s90, s90, 2359296
  buffer_store_dwordx4 v[68:71], v9, s[48:51], s90 offen sc1
  s_branch L_FIN
L_S2_TQ:
  s_setprio 3
  s_cmp_lg_u32 s74, 0
  s_cbranch_scc1 L_tagok_277
  s_mov_b32 s95, 0
L_tagloop_278:
  v_mov_b32 v9, 0
  buffer_load_dword v10, v9, s[60:63], 0 offen sc1
  s_waitcnt vmcnt(0)
  v_readfirstlane_b32 s74, v10
  s_add_u32 s95, s95, 1
  s_cmp_lg_u32 s74, 0
  s_cbranch_scc1 L_tagok_277
  s_cmp_lt_u32 s95, 0x40000
  s_cbranch_scc1 L_tagloop_278
L_tagok_277:
  s_lshr_b32 s90, s2, 3
  s_mul_i32 s91, s90, 37
  s_lshr_b32 s91, s91, 8
  s_mul_i32 s92, s91, 7
  s_sub_u32 s92, s90, s92
  s_and_b32 s93, s2, 7
  s_lshl_b32 s93, s93, 2
  s_add_u32 s93, s93, s91
  s_and_b32 s91, s93, 1
  s_mov_b32 s12, s91
  s_mov_b32 s13, s92
  s_mov_b32 s14, s93
  s_lshr_b32 s19, s93, 1
  s_mul_i32 s90, s71, 15360
  v_lshlrev_b32 v9, 4, v1
  v_add_u32 v9, s90, v9
  v_add_u32 v9, 81920, v9
  ds_read_b128 v[224:227], v9 offset:0
  ds_read_b128 v[228:231], v9 offset:1024
  ds_read_b128 v[232:235], v9 offset:2048
  ds_read_b128 v[236:239], v9 offset:3072
  s_waitcnt lgkmcnt(0)
  s_cmp_lg_u32 s71, 0
  s_cbranch_scc1 L_spo_279
  v_lshlrev_b32 v9, 10, v1
  v_add_u32 v9, 1020, v9
  s_lshl_b32 s90, s73, 14
  s_add_u32 s90, s90, 2359296
  s_mov_b64 s[100:101], exec
  s_mov_b64 exec, 65535
  s_mov_b32 s95, 0
L_poll_281:
  buffer_load_dword v10, v9, s[48:51], s90 offen sc1
  s_waitcnt vmcnt(0)
  v_cmp_ne_u32 vcc, s74, v10
  s_add_u32 s95, s95, 1
  s_cmp_eq_u64 vcc, 0
  s_cbranch_scc1 L_polldone_282
  s_sleep 1
  s_cmp_lt_u32 s95, 0x20000
  s_cbranch_scc1 L_poll_281
L_polldone_282:
  s_mov_b64 exec, s[100:101]
  s_lshl_b32 s83, s73, 14
  s_add_u32 s83, s83, 2359296
  v_lshlrev_b32 v9, 4, v1
  s_mov_b32 s95, 0
L_kl_283:
  s_mov_b32 s90, s83
  buffer_load_dwordx4 v[128:131], v9, s[48:51], s90 offen sc1
  s_add_u32 s90, s90, 1024
  buffer_load_dwordx4 v[132:135], v9, s[48:51], s90 offen sc1
  s_add_u32 s90, s90, 1024
  buffer_load_dwordx4 v[136:139], v9, s[48:51], s90 offen sc1
  s_add_u32 s90, s90, 1024
  buffer_load_dwordx4 v[140:143], v9, s[48:51], s90 offen sc1
  s_add_u32 s90, s90, 1024
  buffer_load_dwordx4 v[144:147], v9, s[48:51], s90 offen sc1
  s_add_u32 s90, s90, 1024
  buffer_load_dwordx4 v[148:151], v9, s[48:51], s90 offen sc1
  s_add_u32 s90, s90, 1024
  buffer_load_dwordx4 v[152:155], v9, s[48:51], s90 offen sc1
  s_add_u32 s90, s90, 1024
  buffer_load_dwordx4 v[156:159], v9, s[48:51], s90 offen sc1
  s_add_u32 s90, s90, 1024
  buffer_load_dwordx4 v[160:163], v9, s[48:51], s90 offen sc1
  s_add_u32 s90, s90, 1024
  buffer_load_dwordx4 v[164:167], v9, s[48:51], s90 offen sc1
  s_add_u32 s90, s90, 1024
  buffer_load_dwordx4 v[168:171], v9, s[48:51], s90 offen sc1
  s_add_u32 s90, s90, 1024
  buffer_load_dwordx4 v[172:175], v9, s[48:51], s90 offen sc1
  s_add_u32 s90, s90, 1024
  buffer_load_dwordx4 v[176:179], v9, s[48:51], s90 offen sc1
  s_add_u32 s90, s90, 1024
  buffer_load_dwordx4 v[180:183], v9, s[48:51], s90 offen sc1
  s_add_u32 s90, s90, 1024
  buffer_load_dwordx4 v[184:187], v9, s[48:51], s90 offen sc1
  s_add_u32 s90, s90, 1024
  buffer_load_dwordx4 v[188:191], v9, s[48:51], s90 offen sc1
  v_mov_b32 v64, s74
  v_mov_b32 v65, s74
  s_waitcnt vmcnt(15)
  v_max3_u32 v64, v64, v129, v131
  v_min3_u32 v65, v65, v129, v131
  v_mov_b32 v129, v130
  s_waitcnt vmcnt(14)
  v_max3_u32 v64, v64, v133, v135
  v_min3_u32 v65, v65, v133, v135
  v_mov_b32 v133, v134
  s_waitcnt vmcnt(13)
  v_max3_u32 v64, v64, v137, v139
  v_min3_u32 v65, v65, v137, v139
  v_mov_b32 v137, v138
  s_waitcnt vmcnt(12)
  v_max3_u32 v64, v64, v141, v143
  v_min3_u32 v65, v65, v141, v143
  v_mov_b32 v141, v142
  s_waitcnt vmcnt(11)
  v_max3_u32 v64, v64, v145, v147
  v_min3_u32 v65, v65, v145, v147
  v_mov_b32 v145, v146
  s_waitcnt vmcnt(10)
  v_max3_u32 v64, v64, v149, v151
  v_min3_u32 v65, v65, v149, v151
  v_mov_b32 v149, v150
  s_waitcnt vmcnt(9)
  v_max3_u32 v64, v64, v153, v155
  v_min3_u32 v65, v65, v153, v155
  v_mov_b32 v153, v154
  s_waitcnt vmcnt(8)
  v_max3_u32 v64, v64, v157, v159
  v_min3_u32 v65, v65, v157, v159
  v_mov_b32 v157, v158
  s_waitcnt vmcnt(7)
  v_max3_u32 v64, v64, v161, v163
  v_min3_u32 v65, v65, v161, v163
  v_mov_b32 v161, v162
  s_waitcnt vmcnt(6)
  v_max3_u32 v64, v64, v165, v167
  v_min3_u32 v65, v65, v165, v167
  v_mov_b32 v165, v166
  s_waitcnt vmcnt(5)
  v_max3_u32 v64, v64, v169, v171
  v_min3_u32 v65, v65, v169, v171
  v_mov_b32 v169, v170
  s_waitcnt vmcnt(4)
  v_max3_u32 v64, v64, v173, v175
  v_min3_u32 v65, v65, v173, v175
  v_mov_b32 v173, v174
  s_waitcnt vmcnt(3)
  v_max3_u32 v64, v64, v177, v179
  v_min3_u32 v65, v65, v177, v179
  v_mov_b32 v177, v178
  s_waitcnt vmcnt(2)
  v_max3_u32 v64, v64, v181, v183
  v_min3_u32 v65, v65, v181, v183
  v_mov_b32 v181, v182
  s_waitcnt vmcnt(1)
  v_max3_u32 v64, v64, v185, v187
  v_min3_u32 v65, v65, v185, v187
  v_mov_b32 v185, v186
  s_waitcnt vmcnt(0)
  v_max3_u32 v64, v64, v189, v191
  v_min3_u32 v65, v65, v189, v191
  v_mov_b32 v189, v190
  v_cmp_ne_u32 s[84:85], v64, v65
  v_cmp_ne_u32 vcc, s74, v64
  s_nop 0
  s_or_b64 s[84:85], s[84:85], vcc
  s_cmp_eq_u64 s[84:85], 0
  s_cbranch_scc1 L_kok_284
  s_add_u32 s95, s95, 1
  s_sleep 2
  s_cmp_lt_u32 s95, 0x20000
  s_cbranch_scc1 L_kl_283
L_kok_284:
  v_lshlrev_b32 v9, 3, v1
  v_add_u32 v9, 151808, v9
  ds_write_b64 v9, v[128:129] offset:0
  ds_write_b64 v9, v[132:133] offset:512
  ds_write_b64 v9, v[136:137] offset:1024
  ds_write_b64 v9, v[140:141] offset:1536
  ds_write_b64 v9, v[144:145] offset:2048
  ds_write_b64 v9, v[148:149] offset:2560
  ds_write_b64 v9, v[152:153] offset:3072
  ds_write_b64 v9, v[156:157] offset:3584
  s_waitcnt lgkmcnt(0)
  ds_write_b64 v9, v[160:161] offset:4096
  ds_write_b64 v9, v[164:165] offset:4608
  ds_write_b64 v9, v[168:169] offset:5120
  ds_write_b64 v9, v[172:173] offset:5632
  ds_write_b64 v9, v[176:177] offset:6144
  ds_write_b64 v9, v[180:181] offset:6656
  ds_write_b64 v9, v[184:185] offset:7168
  ds_write_b64 v9, v[188:189] offset:7680
  s_waitcnt lgkmcnt(0)
  v_mov_b32 v9, 151624
  v_mov_b32 v10, 1
  ds_write_b32 v9, v10
  s_branch L_spd_280
L_spo_279:
  v_mov_b32 v9, 151624
  s_mov_b32 s95, 0
L_spl_285:
  ds_read_b32 v10, v9
  s_waitcnt lgkmcnt(0)
  v_readfirstlane_b32 s90, v10
  s_add_u32 s95, s95, 1
  s_cmp_lg_u32 s90, 0
  s_cbranch_scc1 L_spd_280
  s_sleep 2
  s_cmp_lt_u32 s95, 0x400000
  s_cbranch_scc1 L_spl_285
L_spd_280:
  s_waitcnt vmcnt(0) lgkmcnt(0)
  v_lshlrev_b32 v9, 3, v1
  v_add_u32 v9, 151808, v9
  ds_read_b64 v[128:129], v9 offset:0
  ds_read_b64 v[130:131], v9 offset:512
  ds_read_b64 v[132:133], v9 offset:1024
  ds_read_b64 v[134:135], v9 offset:1536
  ds_read_b64 v[136:137], v9 offset:2048
  ds_read_b64 v[138:139], v9 offset:2560
  ds_read_b64 v[140:141], v9 offset:3072
  ds_read_b64 v[142:143], v9 offset:3584
  s_waitcnt lgkmcnt(0)
  ds_read_b64 v[144:145], v9 offset:4096
  ds_read_b64 v[146:147], v9 offset:4608
  ds_read_b64 v[148:149], v9 offset:5120
  ds_read_b64 v[150:151], v9 offset:5632
  ds_read_b64 v[152:153], v9 offset:6144
  ds_read_b64 v[154:155], v9 offset:6656
  ds_read_b64 v[156:157], v9 offset:7168
  ds_read_b64 v[158:159], v9 offset:7680
  s_lshl_b32 s91, s68, 2
  s_add_u32 s91, s91, s71
  s_lshl_b32 s91, s91, 4
  s_lshl_b32 s92, s73, 1
  s_add_u32 s91, s91, s92
  s_lshl_b32 s91, s91, 11
  s_add_u32 s91, s91, 2490368
  v_lshlrev_b32 v5, 4, v1
  v_mfma_f32_32x32x16_bf16 v[64:79], v[128:131], v[224:227], 0
  v_mfma_f32_32x32x16_bf16 v[64:79], v[132:135], v[228:231], v[64:79]
  v_mfma_f32_32x32x16_bf16 v[64:79], v[136:139], v[232:235], v[64:79]
  v_mfma_f32_32x32x16_bf16 v[64:79], v[140:143], v[236:239], v[64:79]
  s_waitcnt lgkmcnt(0)
  v_mfma_f32_32x32x16_bf16 v[80:95], v[144:147], v[240:243], 0
  v_mfma_f32_32x32x16_bf16 v[80:95], v[148:151], v[244:247], v[80:95]
  v_mfma_f32_32x32x16_bf16 v[80:95], v[152:155], v[248:251], v[80:95]
  v_mfma_f32_32x32x16_bf16 v[80:95], v[156:159], v[252:255], v[80:95]
  s_nop 6
  v_mov_b32 v9, v76
  v_mov_b32 v10, v76
  s_nop 1
  v_permlane32_swap_b32 v9, v10
  v_add_f32 v10, 0x358637bd, v10
  v_rcp_f32 v10, v10
  s_nop 0
  v_mul_f32 v64, v64, v10
  v_mul_f32 v65, v65, v10
  v_mul_f32 v66, v66, v10
  v_mul_f32 v67, v67, v10
  v_mul_f32 v68, v68, v10
  v_mul_f32 v69, v69, v10
  v_mul_f32 v70, v70, v10
  v_mul_f32 v71, v71, v10
  v_mul_f32 v72, v72, v10
  v_mul_f32 v73, v73, v10
  v_mul_f32 v74, v74, v10
  v_mul_f32 v75, v75, v10
  v_mul_f32 v76, v76, v10
  v_mul_f32 v77, v77, v10
  v_mul_f32 v78, v78, v10
  v_mul_f32 v79, v79, v10
  v_cvt_pk_bf16_f32 v96, v64, v65
  v_cvt_pk_bf16_f32 v97, v66, v67
  v_cvt_pk_bf16_f32 v98, v68, v69
  v_cvt_pk_bf16_f32 v99, v70, v71
  v_cvt_pk_bf16_f32 v100, v72, v73
  v_cvt_pk_bf16_f32 v101, v74, v75
  v_cvt_pk_bf16_f32 v102, v76, v77
  v_cvt_pk_bf16_f32 v103, v78, v79
  v_mov_b32 v9, 0
  v_cndmask_b32 v102, v102, v9, s[4:5]
  v_cndmask_b32 v103, v103, v9, s[4:5]
  buffer_store_dwordx4 v[96:99], v5, s[48:51], s91 offen offset:0 sc1
  buffer_store_dwordx4 v[100:103], v5, s[48:51], s91 offen offset:1024 sc1
  v_mov_b32 v9, v92
  v_mov_b32 v10, v92
  s_nop 1
  v_permlane32_swap_b32 v9, v10
  v_add_f32 v10, 0x358637bd, v10
  v_rcp_f32 v10, v10
  s_nop 0
  v_mul_f32 v80, v80, v10
  v_mul_f32 v81, v81, v10
  v_mul_f32 v82, v82, v10
  v_mul_f32 v83, v83, v10
  v_mul_f32 v84, v84, v10
  v_mul_f32 v85, v85, v10
  v_mul_f32 v86, v86, v10
  v_mul_f32 v87, v87, v10
  v_mul_f32 v88, v88, v10
  v_mul_f32 v89, v89, v10
  v_mul_f32 v90, v90, v10
  v_mul_f32 v91, v91, v10
  v_mul_f32 v92, v92, v10
  v_mul_f32 v93, v93, v10
  v_mul_f32 v94, v94, v10
  v_mul_f32 v95, v95, v10
  v_cvt_pk_bf16_f32 v104, v80, v81
  v_cvt_pk_bf16_f32 v105, v82, v83
  v_cvt_pk_bf16_f32 v106, v84, v85
  v_cvt_pk_bf16_f32 v107, v86, v87
  v_cvt_pk_bf16_f32 v108, v88, v89
  v_cvt_pk_bf16_f32 v109, v90, v91
  v_cvt_pk_bf16_f32 v110, v92, v93
  v_cvt_pk_bf16_f32 v111, v94, v95
  v_mov_b32 v9, 0
  v_cndmask_b32 v110, v110, v9, s[4:5]
  v_cndmask_b32 v111, v111, v9, s[4:5]
  buffer_store_dwordx4 v[104:107], v5, s[48:51], s91 offen offset:2048 sc1
  buffer_store_dwordx4 v[108:111], v5, s[48:51], s91 offen offset:3072 sc1
  s_waitcnt vmcnt(0)
  v_mov_b32 v9, 151628
  v_mov_b32 v10, 1
  s_mov_b64 s[100:101], exec
  s_mov_b64 exec, 1
  ds_add_rtn_u32 v10, v9, v10
  s_mov_b64 exec, s[100:101]
  s_waitcnt lgkmcnt(0)
  v_readfirstlane_b32 s90, v10
  s_nop 0
  s_cmp_lg_u32 s90, 3
  s_cbranch_scc1 L_notlast_286
  s_lshl_b32 s90, s68, 3
  s_add_u32 s90, s90, s73
  s_lshl_b32 s90, s90, 7
  s_add_u32 s90, s90, 118784
  v_mov_b32 v9, 0
  v_mov_b32 v10, s74
  s_mov_b64 s[100:101], exec
  s_mov_b64 exec, 1
  buffer_store_dword v10, v9, s[48:51], s90 offen sc1
  s_mov_b64 exec, s[100:101]
L_notlast_286:
  s_cmp_ge_u32 s2, 224
  s_cbranch_scc0 L_T_DOWO
  s_branch L_FIN
L_T_DOWO:
  s_setprio 1
  v_and_b32 v9, 7, v1
  v_lshrrev_b32 v10, 2, v1
  v_and_b32 v10, 4, v10
  v_xor_b32 v9, v9, v10
  v_lshlrev_b32 v9, 4, v9
  v_lshrrev_b32 v10, 3, v1
  s_movk_i32 s90, 896
  v_mad_u32_u24 v4, v10, s90, v9
  s_mul_i32 s91, s71, 100352
  s_lshl_b32 s92, s13, 7
  s_add_u32 s91, s91, s92
  s_mul_i32 s92, s71, 15360
  s_add_u32 s90, s91, 0
  s_add_u32 m0, s92, 81920
  s_nop 0
  buffer_load_dwordx4 v4, s[44:47], s90 offen lds
  s_add_u32 s90, s91, 7168
  s_add_u32 m0, s92, 82944
  s_nop 0
  buffer_load_dwordx4 v4, s[44:47], s90 offen lds
  s_add_u32 s90, s91, 14336
  s_add_u32 m0, s92, 83968
  s_nop 0
  buffer_load_dwordx4 v4, s[44:47], s90 offen lds
  s_add_u32 s90, s91, 21504
  s_add_u32 m0, s92, 84992
  s_nop 0
  buffer_load_dwordx4 v4, s[44:47], s90 offen lds
  s_add_u32 s90, s91, 28672
  s_add_u32 m0, s92, 86016
  s_nop 0
  buffer_load_dwordx4 v4, s[44:47], s90 offen lds
  s_add_u32 s90, s91, 35840
  s_add_u32 m0, s92, 87040
  s_nop 0
  buffer_load_dwordx4 v4, s[44:47], s90 offen lds
  s_add_u32 s90, s91, 43008
  s_add_u32 m0, s92, 88064
  s_nop 0
  buffer_load_dwordx4 v4, s[44:47], s90 offen lds
  s_add_u32 s90, s91, 50176
  s_add_u32 m0, s92, 89088
  s_nop 0
  buffer_load_dwordx4 v4, s[44:47], s90 offen lds
  s_add_u32 s90, s91, 57344
  s_add_u32 m0, s92, 90112
  s_nop 0
  buffer_load_dwordx4 v4, s[44:47], s90 offen lds
  s_add_u32 s90, s91, 64512
  s_add_u32 m0, s92, 91136
  s_nop 0
  buffer_load_dwordx4 v4, s[44:47], s90 offen lds
  s_add_u32 s90, s91, 71680
  s_add_u32 m0, s92, 92160
  s_nop 0
  buffer_load_dwordx4 v4, s[44:47], s90 offen lds
  s_add_u32 s90, s91, 78848
  s_add_u32 m0, s92, 93184
  s_nop 0
  buffer_load_dwordx4 v4, s[44:47], s90 offen lds
  s_add_u32 s90, s91, 86016
  s_add_u32 m0, s92, 94208
  s_nop 0
  buffer_load_dwordx4 v4, s[44:47], s90 offen lds
  s_add_u32 s90, s91, 93184
  s_add_u32 m0, s92, 95232
  s_nop 0
  buffer_load_dwordx4 v4, s[44:47], s90 offen lds
  s_add_u32 s90, s91, 100352
  s_add_u32 m0, s92, 96256
  s_nop 0
  buffer_load_dwordx4 v4, s[44:47], s90 offen lds
  s_branch L_T_WO
L_S2_TK:
  s_cmp_ge_u32 s2, 224
  s_cbranch_scc0 L_S2_TK2
  s_branch L_FIN
L_S2_TK2:
  s_cmp_lg_u32 s74, 0
  s_cbranch_scc1 L_tagok_287
  s_mov_b32 s95, 0
L_tagloop_288:
  v_mov_b32 v9, 0
  buffer_load_dword v10, v9, s[60:63], 0 offen sc1
  s_waitcnt vmcnt(0)
  v_readfirstlane_b32 s74, v10
  s_add_u32 s95, s95, 1
  s_cmp_lg_u32 s74, 0
  s_cbranch_scc1 L_tagok_287
  s_cmp_lt_u32 s95, 0x40000
  s_cbranch_scc1 L_tagloop_288
L_tagok_287:
  s_lshr_b32 s90, s2, 3
  s_mul_i32 s91, s90, 37
  s_lshr_b32 s91, s91, 8
  s_mul_i32 s92, s91, 7
  s_sub_u32 s92, s90, s92
  s_and_b32 s93, s2, 7
  s_lshl_b32 s93, s93, 2
  s_add_u32 s93, s93, s91
  s_and_b32 s91, s93, 1
  s_mov_b32 s83, s92
  s_mov_b32 s84, s93
  v_and_b32 v9, 7, v1
  v_lshrrev_b32 v10, 2, v1
  v_and_b32 v10, 4, v10
  v_xor_b32 v9, v9, v10
  v_lshlrev_b32 v9, 4, v9
  v_lshrrev_b32 v10, 3, v1
  s_movk_i32 s90, 896
  v_mad_u32_u24 v4, v10, s90, v9
  s_mul_i32 s87, s71, 100352
  s_lshl_b32 s92, s83, 7
  s_add_u32 s87, s87, s92
  s_mul_i32 s85, s71, 15360
  s_add_u32 s90, s87, 0
  s_add_u32 m0, s85, 81920
  s_nop 0
  buffer_load_dwordx4 v4, s[44:47], s90 offen lds
  s_add_u32 s90, s87, 7168
  s_add_u32 m0, s85, 82944
  s_nop 0
  buffer_load_dwordx4 v4, s[44:47], s90 offen lds
  s_add_u32 s90, s87, 14336
  s_add_u32 m0, s85, 83968
  s_nop 0
  buffer_load_dwordx4 v4, s[44:47], s90 offen lds
  s_add_u32 s90, s87, 21504
  s_add_u32 m0, s85, 84992
  s_nop 0
  buffer_load_dwordx4 v4, s[44:47], s90 offen lds
  s_add_u32 s90, s87, 28672
  s_add_u32 m0, s85, 86016
  s_nop 0
  buffer_load_dwordx4 v4, s[44:47], s90 offen lds
  s_add_u32 s90, s87, 35840
  s_add_u32 m0, s85, 87040
  s_nop 0
  buffer_load_dwordx4 v4, s[44:47], s90 offen lds
  s_add_u32 s90, s87, 43008
  s_add_u32 m0, s85, 88064
  s_nop 0
  buffer_load_dwordx4 v4, s[44:47], s90 offen lds
  s_add_u32 s90, s87, 50176
  s_add_u32 m0, s85, 89088
  s_nop 0
  buffer_load_dwordx4 v4, s[44:47], s90 offen lds
  s_add_u32 s90, s87, 57344
  s_add_u32 m0, s85, 90112
  s_nop 0
  buffer_load_dwordx4 v4, s[44:47], s90 offen lds
  s_add_u32 s90, s87, 64512
  s_add_u32 m0, s85, 91136
  s_nop 0
  buffer_load_dwordx4 v4, s[44:47], s90 offen lds
  s_add_u32 s90, s87, 71680
  s_add_u32 m0, s85, 92160
  s_nop 0
  buffer_load_dwordx4 v4, s[44:47], s90 offen lds
  s_add_u32 s90, s87, 78848
  s_add_u32 m0, s85, 93184
  s_nop 0
  buffer_load_dwordx4 v4, s[44:47], s90 offen lds
  s_add_u32 s90, s87, 86016
  s_add_u32 m0, s85, 94208
  s_nop 0
  buffer_load_dwordx4 v4, s[44:47], s90 offen lds
  s_add_u32 s90, s87, 93184
  s_add_u32 m0, s85, 95232
  s_nop 0
  buffer_load_dwordx4 v4, s[44:47], s90 offen lds
  s_add_u32 s90, s87, 100352
  s_add_u32 m0, s85, 96256
  s_nop 0
  buffer_load_dwordx4 v4, s[44:47], s90 offen lds
  s_lshr_b32 s90, s2, 3
  s_mul_i32 s91, s90, 37
  s_lshr_b32 s91, s91, 8
  s_mul_i32 s92, s91, 7
  s_sub_u32 s92, s90, s92
  s_and_b32 s93, s2, 7
  s_lshl_b32 s93, s93, 2
  s_add_u32 s93, s93, s91
  s_and_b32 s91, s93, 1
  s_mov_b32 s12, s91
  s_mov_b32 s13, s92
  s_mov_b32 s14, s93
  s_lshr_b32 s19, s93, 1
L_T_WO:
  s_lshl_b32 s90, s14, 6
  s_lshl_b32 s91, s70, 3
  s_add_u32 s90, s90, s91
  s_mul_i32 s90, s90, 896
  s_lshl_b32 s91, s13, 7
  s_add_u32 s18, s90, s91
  v_lshrrev_b32 v9, 3, v1
  s_movk_i32 s90, 896
  v_mul_u32_u24 v9, s90, v9
  v_and_b32 v10, 7, v1
  v_lshlrev_b32 v10, 4, v10
  v_add_u32 v8, v9, v10
  buffer_load_dwordx4 v[248:251], v8, s[28:31], s18 offen
  s_mov_b32 s56, s20
  s_and_b32 s57, s21, 0xffff
  s_mov_b32 s58, 896
  s_mov_b32 s59, 0x20000
  s_lshl_b32 s91, s13, 7
  buffer_load_dwordx4 v[252:255], v10, s[56:59], s91 offen
  v_lshrrev_b32 v9, 4, v1
  v_and_b32 v9, 1, v9
  v_lshlrev_b32 v9, 5, v9
  v_and_b32 v10, 3, v1
  v_lshl_add_u32 v9, v10, 3, v9
  v_lshlrev_b32 v10, 3, v1
  v_and_b32 v10, 64, v10
  v_xor_b32 v9, v9, v10
  v_lshrrev_b32 v10, 2, v1
  v_and_b32 v10, 3, v10
  v_mad_u32_u24 v6, v3, 4, v10
  v_lshl_add_u32 v6, v6, 7, v9
  v_lshrrev_b32 v9, 4, v1
  v_and_b32 v9, 1, v9
  v_lshlrev_b32 v9, 5, v9
  v_and_b32 v10, 3, v1
  v_lshl_add_u32 v9, v10, 3, v9
  v_add_u32 v9, 64, v9
  v_lshlrev_b32 v10, 3, v1
  v_and_b32 v10, 64, v10
  v_xor_b32 v9, v9, v10
  v_lshrrev_b32 v10, 2, v1
  v_and_b32 v10, 3, v10
  v_mad_u32_u24 v7, v3, 4, v10
  v_lshl_add_u32 v7, v7, 7, v9
  s_mul_i32 s15, s71, 15360
  s_add_u32 s15, s15, 81920
  v_add_u32 v6, s15, v6
  v_add_u32 v7, s15, v7
  v_lshlrev_b32 v5, 4, v1
  s_waitcnt vmcnt(0)
  ds_read_b64_tr_b16 v[192:193], v6 offset:0
  ds_read_b64_tr_b16 v[194:195], v6 offset:1024
  ds_read_b64_tr_b16 v[196:197], v7 offset:0
  ds_read_b64_tr_b16 v[198:199], v7 offset:1024
  ds_read_b64_tr_b16 v[200:201], v6 offset:2048
  ds_read_b64_tr_b16 v[202:203], v6 offset:3072
  ds_read_b64_tr_b16 v[204:205], v7 offset:2048
  ds_read_b64_tr_b16 v[206:207], v7 offset:3072
  ds_read_b64_tr_b16 v[208:209], v6 offset:3584
  ds_read_b64_tr_b16 v[210:211], v6 offset:4608
  ds_read_b64_tr_b16 v[212:213], v7 offset:3584
  ds_read_b64_tr_b16 v[214:215], v7 offset:4608
  s_waitcnt lgkmcnt(0)
  ds_read_b64_tr_b16 v[216:217], v6 offset:5632
  ds_read_b64_tr_b16 v[218:219], v6 offset:6656
  ds_read_b64_tr_b16 v[220:221], v7 offset:5632
  ds_read_b64_tr_b16 v[222:223], v7 offset:6656
  ds_read_b64_tr_b16 v[224:225], v6 offset:7168
  ds_read_b64_tr_b16 v[226:227], v6 offset:8192
  ds_read_b64_tr_b16 v[228:229], v7 offset:7168
  ds_read_b64_tr_b16 v[230:231], v7 offset:8192
  ds_read_b64_tr_b16 v[232:233], v6 offset:9216
  ds_read_b64_tr_b16 v[234:235], v6 offset:10240
  ds_read_b64_tr_b16 v[236:237], v7 offset:9216
  ds_read_b64_tr_b16 v[238:239], v7 offset:10240
  s_waitcnt lgkmcnt(0)
  ds_read_b64_tr_b16 v[240:241], v6 offset:10752
  ds_read_b64_tr_b16 v[242:243], v6 offset:11776
  ds_read_b64_tr_b16 v[244:245], v7 offset:10752
  ds_read_b64_tr_b16 v[246:247], v7 offset:11776
  ds_read_b64_tr_b16 v[32:33], v6 offset:12800
  ds_read_b64_tr_b16 v[34:35], v6 offset:13824
  ds_read_b64_tr_b16 v[36:37], v7 offset:12800
  ds_read_b64_tr_b16 v[38:39], v7 offset:13824
  s_waitcnt lgkmcnt(0)
  s_setprio 3
  s_cmp_lg_u32 s71, 0
  s_cbranch_scc1 L_spo_289
  v_lshlrev_b32 v9, 7, v1
  s_lshl_b32 s90, s19, 10
  s_add_u32 s90, s90, 118784
  s_mov_b64 s[100:101], exec
  s_mov_b64 exec, 255
  s_mov_b32 s95, 0
L_poll_291:
  buffer_load_dword v10, v9, s[48:51], s90 offen sc1
  s_waitcnt vmcnt(0)
  v_cmp_ne_u32 vcc, s74, v10
  s_add_u32 s95, s95, 1
  s_cmp_eq_u64 vcc, 0
  s_cbranch_scc1 L_polldone_292
  s_sleep 2
  s_cmp_lt_u32 s95, 0x20000
  s_cbranch_scc1 L_poll_291
L_polldone_292:
  s_mov_b64 exec, s[100:101]
  v_mov_b32 v9, 151632
  v_mov_b32 v10, 1
  ds_write_b32 v9, v10
  s_branch L_spd_290
L_spo_289:
  v_mov_b32 v9, 151632
  s_mov_b32 s95, 0
L_spl_293:
  ds_read_b32 v10, v9
  s_waitcnt lgkmcnt(0)
  v_readfirstlane_b32 s90, v10
  s_add_u32 s95, s95, 1
  s_cmp_lg_u32 s90, 0
  s_cbranch_scc1 L_spd_290
  s_sleep 2
  s_cmp_lt_u32 s95, 0x400000
  s_cbranch_scc1 L_spl_293
L_spd_290:
  s_waitcnt vmcnt(0) lgkmcnt(0)
  s_lshl_b32 s90, s14, 5
  s_lshl_b32 s91, s71, 2
  s_add_u32 s90, s90, s91
  s_lshl_b32 s90, s90, 11
  s_add_u32 s90, s90, 2490368
  s_add_u32 s91, s90, 32768
  buffer_load_dwordx4 v[128:131], v5, s[48:51], s90 offen offset:0 sc1
  buffer_load_dwordx4 v[136:139], v5, s[48:51], s90 offen offset:1024 sc1
  buffer_load_dwordx4 v[144:147], v5, s[48:51], s90 offen offset:2048 sc1
  buffer_load_dwordx4 v[152:155], v5, s[48:51], s90 offen offset:3072 sc1
  s_add_u32 s90, s90, 4096
  buffer_load_dwordx4 v[160:163], v5, s[48:51], s90 offen offset:0 sc1
  buffer_load_dwordx4 v[168:171], v5, s[48:51], s90 offen offset:1024 sc1
  buffer_load_dwordx4 v[176:179], v5, s[48:51], s90 offen offset:2048 sc1
  buffer_load_dwordx4 v[184:187], v5, s[48:51], s90 offen offset:3072 sc1
  buffer_load_dwordx4 v[132:135], v5, s[48:51], s91 offen offset:0 sc1
  buffer_load_dwordx4 v[140:143], v5, s[48:51], s91 offen offset:1024 sc1
  buffer_load_dwordx4 v[148:151], v5, s[48:51], s91 offen offset:2048 sc1
  buffer_load_dwordx4 v[156:159], v5, s[48:51], s91 offen offset:3072 sc1
  s_add_u32 s91, s91, 4096
  buffer_load_dwordx4 v[164:167], v5, s[48:51], s91 offen offset:0 sc1
  buffer_load_dwordx4 v[172:175], v5, s[48:51], s91 offen offset:1024 sc1
  buffer_load_dwordx4 v[180:183], v5, s[48:51], s91 offen offset:2048 sc1
  buffer_load_dwordx4 v[188:191], v5, s[48:51], s91 offen offset:3072 sc1
  v_mul_u32_u24 v9, 144, v2
  v_lshl_add_u32 v9, v3, 3, v9
  v_add_u32 v9, s15, v9
  s_waitcnt vmcnt(15)
  v_mfma_f32_32x32x16_bf16 v[64:79], v[192:195], v[128:131], 0
  v_mfma_f32_32x32x16_bf16 v[96:111], v[196:199], v[128:131], 0
  s_waitcnt vmcnt(14)
  v_mfma_f32_32x32x16_bf16 v[64:79], v[200:203], v[136:139], v[64:79]
  v_mfma_f32_32x32x16_bf16 v[96:111], v[204:207], v[136:139], v[96:111]
  s_waitcnt vmcnt(13)
  v_mfma_f32_32x32x16_bf16 v[64:79], v[208:211], v[144:147], v[64:79]
  v_mfma_f32_32x32x16_bf16 v[96:111], v[212:215], v[144:147], v[96:111]
  s_waitcnt vmcnt(12)
  v_mfma_f32_32x32x16_bf16 v[64:79], v[216:219], v[152:155], v[64:79]
  v_mfma_f32_32x32x16_bf16 v[96:111], v[220:223], v[152:155], v[96:111]
  s_waitcnt vmcnt(11)
  v_mfma_f32_32x32x16_bf16 v[64:79], v[224:227], v[160:163], v[64:79]
  v_mfma_f32_32x32x16_bf16 v[96:111], v[228:231], v[160:163], v[96:111]
  s_waitcnt vmcnt(10)
  v_mfma_f32_32x32x16_bf16 v[64:79], v[232:235], v[168:171], v[64:79]
  v_mfma_f32_32x32x16_bf16 v[96:111], v[236:239], v[168:171], v[96:111]
  s_waitcnt vmcnt(9)
  v_mfma_f32_32x32x16_bf16 v[64:79], v[240:243], v[176:179], v[64:79]
  v_mfma_f32_32x32x16_bf16 v[96:111], v[244:247], v[176:179], v[96:111]
  s_waitcnt vmcnt(8)
  v_mfma_f32_32x32x16_bf16 v[64:79], v[32:35], v[184:187], v[64:79]
  v_mfma_f32_32x32x16_bf16 v[96:111], v[36:39], v[184:187], v[96:111]
  s_waitcnt vmcnt(7)
  v_mfma_f32_32x32x16_bf16 v[80:95], v[192:195], v[132:135], 0
  v_mfma_f32_32x32x16_bf16 v[112:127], v[196:199], v[132:135], 0
  s_waitcnt vmcnt(6)
  v_mfma_f32_32x32x16_bf16 v[80:95], v[200:203], v[140:143], v[80:95]
  s_nop 5
  v_cvt_pk_bf16_f32 v64, v64, v65
  v_cvt_pk_bf16_f32 v65, v66, v67
  v_mfma_f32_32x32x16_bf16 v[112:127], v[204:207], v[140:143], v[112:127]
  v_cvt_pk_bf16_f32 v66, v68, v69
  v_cvt_pk_bf16_f32 v67, v70, v71
  s_waitcnt vmcnt(5)
  v_mfma_f32_32x32x16_bf16 v[80:95], v[208:211], v[148:151], v[80:95]
  v_cvt_pk_bf16_f32 v68, v72, v73
  v_cvt_pk_bf16_f32 v69, v74, v75
  v_mfma_f32_32x32x16_bf16 v[112:127], v[212:215], v[148:151], v[112:127]
  v_cvt_pk_bf16_f32 v70, v76, v77
  v_cvt_pk_bf16_f32 v71, v78, v79
  s_waitcnt vmcnt(4)
  v_mfma_f32_32x32x16_bf16 v[80:95], v[216:219], v[156:159], v[80:95]
  ds_write_b64 v9, v[64:65] offset:0
  ds_write_b64 v9, v[66:67] offset:16
  v_mfma_f32_32x32x16_bf16 v[112:127], v[220:223], v[156:159], v[112:127]
  ds_write_b64 v9, v[68:69] offset:32
  ds_write_b64 v9, v[70:71] offset:48
  s_waitcnt vmcnt(3)
  v_mfma_f32_32x32x16_bf16 v[80:95], v[224:227], v[164:167], v[80:95]
  v_cvt_pk_bf16_f32 v96, v96, v97
  v_cvt_pk_bf16_f32 v97, v98, v99
  v_mfma_f32_32x32x16_bf16 v[112:127], v[228:231], v[164:167], v[112:127]
  v_cvt_pk_bf16_f32 v98, v100, v101
  v_cvt_pk_bf16_f32 v99, v102, v103
  s_waitcnt vmcnt(2)
  v_mfma_f32_32x32x16_bf16 v[80:95], v[232:235], v[172:175], v[80:95]
  v_cvt_pk_bf16_f32 v100, v104, v105
  v_cvt_pk_bf16_f32 v101, v106, v107
  v_mfma_f32_32x32x16_bf16 v[112:127], v[236:239], v[172:175], v[112:127]
  v_cvt_pk_bf16_f32 v102, v108, v109
  v_cvt_pk_bf16_f32 v103, v110, v111
  s_waitcnt vmcnt(1)
  v_mfma_f32_32x32x16_bf16 v[80:95], v[240:243], v[180:183], v[80:95]
  ds_write_b64 v9, v[96:97] offset:64
  ds_write_b64 v9, v[98:99] offset:80
  v_mfma_f32_32x32x16_bf16 v[112:127], v[244:247], v[180:183], v[112:127]
  ds_write_b64 v9, v[100:101] offset:96
  ds_write_b64 v9, v[102:103] offset:112
  s_waitcnt vmcnt(0)
  v_mfma_f32_32x32x16_bf16 v[80:95], v[32:35], v[188:191], v[80:95]
  v_mfma_f32_32x32x16_bf16 v[112:127], v[36:39], v[188:191], v[112:127]
  s_waitcnt lgkmcnt(0)
  s_nop 9
  v_cvt_pk_bf16_f32 v80, v80, v81
  v_cvt_pk_bf16_f32 v81, v82, v83
  v_cvt_pk_bf16_f32 v82, v84, v85
  v_cvt_pk_bf16_f32 v83, v86, v87
  v_cvt_pk_bf16_f32 v84, v88, v89
  v_cvt_pk_bf16_f32 v85, v90, v91
  v_cvt_pk_bf16_f32 v86, v92, v93
  v_cvt_pk_bf16_f32 v87, v94, v95
  ds_write_b64 v9, v[80:81] offset:4608
  ds_write_b64 v9, v[82:83] offset:4624
  ds_write_b64 v9, v[84:85] offset:4640
  ds_write_b64 v9, v[86:87] offset:4656
  v_cvt_pk_bf16_f32 v112, v112, v113
  v_cvt_pk_bf16_f32 v113, v114, v115
  v_cvt_pk_bf16_f32 v114, v116, v117
  v_cvt_pk_bf16_f32 v115, v118, v119
  v_cvt_pk_bf16_f32 v116, v120, v121
  v_cvt_pk_bf16_f32 v117, v122, v123
  v_cvt_pk_bf16_f32 v118, v124, v125
  v_cvt_pk_bf16_f32 v119, v126, v127
  ds_write_b64 v9, v[112:113] offset:4672
  ds_write_b64 v9, v[114:115] offset:4688
  ds_write_b64 v9, v[116:117] offset:4704
  ds_write_b64 v9, v[118:119] offset:4720
  s_waitcnt lgkmcnt(0)
L_FINAL:
  s_waitcnt vmcnt(0) lgkmcnt(0)
  v_lshrrev_b32 v9, 3, v1
  s_lshl_b32 s90, s70, 3
  v_add_u32 v9, s90, v9
  v_mul_u32_u24 v9, 144, v9
  v_and_b32 v10, 7, v1
  v_lshl_add_u32 v9, v10, 4, v9
  v_add_u32 v10, 81920, v9
  s_mov_b32 s90, 0x00003f80
  s_mov_b32 s91, 0x3f800000
  s_mov_b32 s93, 0xffff0000
  v_lshlrev_b32 v208, 16, v248
  v_and_b32 v209, s93, v248
  v_lshlrev_b32 v210, 16, v249
  v_and_b32 v211, s93, v249
  v_lshlrev_b32 v212, 16, v250
  v_and_b32 v213, s93, v250
  v_lshlrev_b32 v214, 16, v251
  v_and_b32 v215, s93, v251
  s_mul_i32 s92, s71, 20480
  v_lshlrev_b32 v9, 5, v1
  v_add_u32 v9, s92, v9
  s_barrier
  ds_read_b128 v[216:219], v9 offset:10240
  ds_read_b128 v[220:223], v9 offset:10256
  s_branch L_FINAL_C
L_FINAL_F:
  s_waitcnt vmcnt(0) lgkmcnt(0)
  v_lshrrev_b32 v9, 3, v1
  s_lshl_b32 s90, s70, 3
  v_add_u32 v9, s90, v9
  v_mul_u32_u24 v9, 144, v9
  v_and_b32 v10, 7, v1
  v_lshl_add_u32 v9, v10, 4, v9
  v_add_u32 v10, 81920, v9
  s_mov_b32 s90, 0x00003f80
  s_mov_b32 s91, 0x3f800000
  s_mov_b32 s93, 0xffff0000
  v_lshlrev_b32 v208, 16, v248
  v_and_b32 v209, s93, v248
  v_lshlrev_b32 v210, 16, v249
  v_and_b32 v211, s93, v249
  v_lshlrev_b32 v212, 16, v250
  v_and_b32 v213, s93, v250
  v_lshlrev_b32 v214, 16, v251
  v_and_b32 v215, s93, v251
  s_barrier
L_FINAL_C:
  ds_read_b128 v[128:131], v10 offset:0
  ds_read_b128 v[132:135], v10 offset:15360
  ds_read_b128 v[136:139], v10 offset:30720
  ds_read_b128 v[140:143], v10 offset:46080
  s_waitcnt lgkmcnt(3)
  v_lshlrev_b32 v200, 16, v128
  v_and_b32 v201, s93, v128
  v_lshlrev_b32 v202, 16, v129
  v_and_b32 v203, s93, v129
  v_lshlrev_b32 v204, 16, v130
  v_and_b32 v205, s93, v130
  v_lshlrev_b32 v206, 16, v131
  v_and_b32 v207, s93, v131
  s_waitcnt lgkmcnt(2)
  v_dot2c_f32_bf16 v200, s90, v132
  v_dot2c_f32_bf16 v201, s91, v132
  v_dot2c_f32_bf16 v202, s90, v133
  v_dot2c_f32_bf16 v203, s91, v133
  v_dot2c_f32_bf16 v204, s90, v134
  v_dot2c_f32_bf16 v205, s91, v134
  v_dot2c_f32_bf16 v206, s90, v135
  v_dot2c_f32_bf16 v207, s91, v135
  s_waitcnt lgkmcnt(1)
  v_dot2c_f32_bf16 v200, s90, v136
  v_dot2c_f32_bf16 v201, s91, v136
  v_dot2c_f32_bf16 v202, s90, v137
  v_dot2c_f32_bf16 v203, s91, v137
  v_dot2c_f32_bf16 v204, s90, v138
  v_dot2c_f32_bf16 v205, s91, v138
  v_dot2c_f32_bf16 v206, s90, v139
  v_dot2c_f32_bf16 v207, s91, v139
  s_waitcnt lgkmcnt(0)
  v_dot2c_f32_bf16 v200, s90, v140
  v_dot2c_f32_bf16 v201, s91, v140
  v_dot2c_f32_bf16 v202, s90, v141
  v_dot2c_f32_bf16 v203, s91, v141
  v_dot2c_f32_bf16 v204, s90, v142
  v_dot2c_f32_bf16 v205, s91, v142
  v_dot2c_f32_bf16 v206, s90, v143
  v_dot2c_f32_bf16 v207, s91, v143
  v_fmac_f32 v208, v216, v200
  v_fmac_f32 v209, v217, v201
  v_fmac_f32 v210, v218, v202
  v_fmac_f32 v211, v219, v203
  v_fmac_f32 v212, v220, v204
  v_fmac_f32 v213, v221, v205
  v_fmac_f32 v214, v222, v206
  v_fmac_f32 v215, v223, v207
  v_cvt_pk_bf16_f32 v232, v208, v209
  v_cvt_pk_bf16_f32 v233, v210, v211
  v_cvt_pk_bf16_f32 v234, v212, v213
  v_cvt_pk_bf16_f32 v235, v214, v215
  buffer_store_dwordx4 v[232:235], v8, s[52:55], s18 offen sc1
L_FIN:
L_END:
  s_endpgm
L_CODE_END:

.section .rodata,"a"
.p2align 6
.amdhsa_kernel recurrent_scan__linear_kernel_hedgehog__dense_activation_squared_relu__prompt_kernel
  .amdhsa_next_free_vgpr 256
  .amdhsa_next_free_sgpr 102
  .amdhsa_accum_offset 256
  .amdhsa_group_segment_fixed_size 0
  .amdhsa_kernarg_size 96
  .amdhsa_user_sgpr_count 2
  .amdhsa_user_sgpr_kernarg_segment_ptr 1
  .amdhsa_system_sgpr_workgroup_id_x 1
.end_amdhsa_kernel
```
